```python
import torch

def _softmax(x, axis=-1):
    return torch.softmax(x, dim=axis)

def _gelu(x):
    return torch.nn.functional.gelu(x, approximate='tanh')

def _silu(x):
    return torch.nn.functional.silu(x)

def _sigmoid(x):
    return torch.sigmoid(x)

def _layernorm(x, axis=-1, eps=1e-05):
    m = x.mean(dim=axis, keepdim=True)
    v = x.var(dim=axis, keepdim=True, unbiased=False)
    return (x - m) / torch.sqrt(v + eps)

def _scatter_add(tgt, idx, src, axis=0):
    return tgt.clone().index_add_(axis, idx, src)

def _segment_sum(src, seg, n):
    out = torch.zeros((n,) + src.shape[1:], dtype=src.dtype)
    return out.index_add_(0, seg, src)

def _pad(x, pw):
    flat = tuple((v for pair in reversed(pw) for v in pair))
    return torch.nn.functional.pad(x, flat)
kernel_name = 'interleave_layers__sliding_local_dilated__mixer_gmlp__prompt'

def setup_inputs():

    _w = lambda a: (lambda t: t.to(torch.bfloat16) if t.is_floating_point() else t)(torch.as_tensor(a))

    def _A_setup():
        B, S, D = (1, 2048, 640)
        return {'x': _w((lambda *s: torch.randn(*s, dtype=torch.bfloat16) * 0.05)(B, S, D)), 'wqkv': _w((lambda *s: torch.randn(*s, dtype=torch.bfloat16) * 0.1)(D, 3 * D)), 'wo': _w((lambda *s: torch.randn(*s, dtype=torch.bfloat16) * 0.1)(D, D))}
    _A_in = _A_setup()

    def _B_setup():
        B, S, D, F = (1, 2048, 640, 1728)
        Fh = F // 2
        return {'x': _w((lambda *s: torch.randn(*s, dtype=torch.bfloat16) * 0.05)(B, S, D)), 'w_in': _w((lambda *s: torch.randn(*s, dtype=torch.bfloat16) * 0.8)(D, 2 * Fh)), 'w_sp': _w(0.01 * (lambda *s: torch.randn(*s, dtype=torch.bfloat16) * 0.8)(S, S)), 'b_sp': _w(1.0 + 0.01 * (lambda *s: torch.randn(*s, dtype=torch.bfloat16) * 0.05)(S)), 'w_out': _w((lambda *s: torch.randn(*s, dtype=torch.bfloat16) * 0.05)(Fh, D))}
    _B_in = _B_setup()
    return {'A_x': _A_in['x'], 'A_wqkv': _A_in['wqkv'], 'A_wo': _A_in['wo'], 'B_x': _B_in['x'], 'B_w_in': _B_in['w_in'], 'B_w_sp': _B_in['w_sp'], 'B_b_sp': _B_in['b_sp'], 'B_w_out': _B_in['w_out']}

def reference(A_x, A_wqkv, A_wo, B_x, B_w_in, B_w_sp, B_b_sp, B_w_out):

    def _A_ref(x, wqkv, wo):
        B, S, D = x.shape
        H = 32
        Dh = D // H
        W, dil = (8, 2)
        qkv = (lambda x, *d: x.permute(*d))((x @ wqkv).reshape(B, S, 3, H, Dh), 2, 0, 3, 1, 4)
        q, k, v = (qkv[0], qkv[1], qkv[2])
        scale = Dh ** (-0.5)
        pos = torch.arange(S)
        off = torch.arange(W) * dil
        idx = pos[:, None] - off[None, :]
        mask = idx >= 0
        idx_c = torch.where(mask, idx, 0).reshape(-1)
        kg = k[:, :, idx_c, :].reshape(B, H, S, W, Dh)
        vg = v[:, :, idx_c, :].reshape(B, H, S, W, Dh)
        logits = torch.einsum('bhsd,bhswd->bhsw', q, kg) * scale
        logits = torch.where(mask[None, None, :, :], logits, -1000000000.0)
        attn = _softmax(logits, axis=-1)
        o = torch.einsum('bhsw,bhswd->bhsd', attn, vg)
        return (lambda x, *d: x.permute(*d))(o, 0, 2, 1, 3).reshape(B, S, D) @ wo

    def _B_ref(x, w_in, w_sp, b_sp, w_out):
        B, S, D = x.shape
        F = w_in.shape[-1]
        Fh = F // 2
        z = _gelu(torch.einsum('bsd,df->bsf', x, w_in))
        z1 = z[..., :Fh].clone()
        z2 = _layernorm(z[..., Fh:], axis=-1)
        g = torch.einsum('ts,bsf->btf', w_sp, z2) + b_sp[None, :, None]
        return torch.einsum('bsf,fd->bsd', z1 * g, w_out)
    x = A_x
    x = x + _A_ref(_layernorm(x, axis=-1), A_wqkv, A_wo)
    x = x + _B_ref(_layernorm(x, axis=-1), B_w_in, B_w_sp, B_b_sp, B_w_out)
    x = x + _A_ref(_layernorm(x, axis=-1), A_wqkv, A_wo)
    x = x + _B_ref(_layernorm(x, axis=-1), B_w_in, B_w_sp, B_b_sp, B_w_out)
    return x
```

```asm
; @launch kernel=k0_kernel grid=(230,1,1) block=(256,1,1) lds=40960
; @launch kernel=main_kernel grid=(256,1,1) block=(512,1,1) lds=163840
.amdgcn_target "amdgcn-amd-amdhsa--gfx950"
.text
.globl k0_kernel
.p2align 8
.type k0_kernel,@function
k0_kernel:
    s_cmp_ge_u32 s2, 230
    s_cbranch_scc1 K0_end
    s_load_dwordx16 s[16:31], s[0:1], 0
    s_load_dwordx2 s[32:33], s[0:1], 80
    v_lshrrev_b32 v1, 6, v0
    v_and_b32 v0, 63, v0
    v_readfirstlane_b32 s13, v1
    v_lshrrev_b32 v2, 4, v0
    v_and_b32 v3, 15, v0
    v_lshlrev_b32 v4, 4, v0
    s_waitcnt lgkmcnt(0)
    s_mov_b32 s4, s32
    s_and_b32 s5, s33, 0xffff
    s_mov_b32 s6, 268435456
    s_mov_b32 s7, 0x00020000
    s_mov_b32 s11, 0x00020000
    s_cmp_ge_u32 s2, 228
    s_cbranch_scc1 K0_zero
    s_cmp_ge_u32 s2, 164
    s_cbranch_scc1 K0_x
    v_lshrrev_b32 v5, 3, v0
    v_and_b32 v6, 7, v0
    v_lshrrev_b32 v7, 1, v5
    v_and_b32 v7, 3, v7
    v_lshlrev_b32 v7, 1, v7
    v_xor_b32 v6, v6, v7
    v_lshlrev_b32 v6, 4, v6
    s_cmp_ge_u32 s2, 134
    s_cbranch_scc1 K0_wout
    s_cmp_ge_u32 s2, 114
    s_cbranch_scc1 K0_wo
    s_cmp_ge_u32 s2, 60
    s_cbranch_scc1 K0_win
    s_mov_b32 s8, s18
    s_and_b32 s9, s19, 0xffff
    s_mov_b32 s10, 2457600
    s_lshr_b32 s50, s2, 1
    s_and_b32 s51, s2, 1
    s_lshl_b32 s35, s50, 7
    s_mul_i32 s36, s51, 320
    s_mov_b32 s34, 3840
    v_mul_lo_u32 v8, v5, s34
    v_add_u32 v8, v8, v6
    s_lshl_b32 s48, s13, 3
    s_add_u32 s48, s48, s36
    s_lshl_b32 s49, s13, 10
    s_mov_b32 s42, s48
    s_mov_b32 m0, s49
    s_add_u32 s48, s48, 320
KD_1:
    s_lshr_b32 s44, s42, 4
    s_lshr_b32 s45, s44, 2
    s_add_u32 s45, s45, s44
    s_mul_i32 s46, s44, 5
    s_sub_u32 s46, s46, 156
    s_cmp_lt_u32 s44, 32
    s_cselect_b32 s45, s45, s46
    s_lshl_b32 s45, s45, 4
    s_and_b32 s46, s42, 8
    s_add_u32 s43, s45, s46
    s_mul_i32 s43, s43, 3840
    s_add_u32 s43, s43, s35
    buffer_load_dwordx4 v8, s[8:11], s43 offen nt lds
    s_add_u32 s42, s42, 32
    s_add_u32 s49, s49, 4096
    s_mov_b32 m0, s49
    s_cmp_lt_u32 s42, s48
    s_cbranch_scc1 KD_1
    s_mul_i32 s52, s50, 26
    s_lshr_b32 s52, s52, 8
    s_mul_i32 s53, s52, 640
    s_lshl_b32 s54, s50, 6
    s_sub_u32 s54, s54, s53
    s_lshl_b32 s53, s13, 4
    s_add_u32 s54, s54, s53
    v_add_u32 v10, s54, v3
    v_mul_u32_u24 v11, 1639, v10
    v_lshrrev_b32 v11, 16, v11
    v_mul_u32_u24 v12, 40, v11
    v_sub_u32 v12, v10, v12
    v_add_u32 v13, 80, v12
    v_cmp_le_u32 vcc, 20, v12
    s_nop 1
    v_cndmask_b32 v14, 0, 1, vcc
    v_mul_u32_u24 v15, 20, v14
    v_sub_u32 v15, v12, v15
    s_lshl_b32 s53, s52, 4
    v_lshl_add_u32 v16, v14, 5, v15
    v_add_u32 v16, s53, v16
    s_lshl_b32 s53, s52, 3
    s_add_u32 s53, s53, 48
    v_lshl_add_u32 v17, v14, 2, v15
    v_add_u32 v17, s53, v17
    v_cmp_gt_u32 vcc, 16, v15
    s_nop 1
    v_cndmask_b32 v16, v17, v16, vcc
    s_cmp_eq_u32 s52, 2
    s_cselect_b64 vcc, -1, 0
    v_cndmask_b32 v16, v16, v13, vcc
    v_lshrrev_b32 v13, 4, v16
    v_and_b32 v14, 15, v16
    v_lshlrev_b32 v13, 10, v13
    v_lshl_add_u32 v13, v14, 4, v13
    v_lshl_add_u32 v13, v2, 8, v13
    s_mov_b32 s53, 163840
    v_mul_lo_u32 v9, v11, s53
    v_add_u32 v9, v9, v13
    v_lshl_add_u32 v18, v11, 7, v16
    v_lshlrev_b32 v18, 2, v18
    s_mul_i32 s38, s51, 81920
    s_add_u32 s38, s38, 0
    s_mov_b32 s39, 8192
    s_mov_b32 s40, 10
    s_lshl_b32 s41, s51, 13
    s_add_u32 s41, s41, 6848512
    s_branch K0_common
K0_win:
    s_mov_b32 s8, s24
    s_and_b32 s9, s25, 0xffff
    s_mov_b32 s10, 2211840
    s_sub_u32 s50, s2, 60
    s_and_b32 s51, s50, 1
    s_lshr_b32 s50, s50, 1
    s_lshl_b32 s35, s50, 7
    s_mul_i32 s36, s51, 320
    s_mov_b32 s34, 3456
    v_mul_lo_u32 v8, v5, s34
    v_add_u32 v8, v8, v6
    s_lshl_b32 s48, s13, 3
    s_add_u32 s48, s48, s36
    s_lshl_b32 s49, s13, 10
    s_mov_b32 s42, s48
    s_mov_b32 m0, s49
    s_add_u32 s48, s48, 320
KD_2:
    s_lshr_b32 s44, s42, 4
    s_lshr_b32 s45, s44, 2
    s_add_u32 s45, s45, s44
    s_mul_i32 s46, s44, 5
    s_sub_u32 s46, s46, 156
    s_cmp_lt_u32 s44, 32
    s_cselect_b32 s45, s45, s46
    s_lshl_b32 s45, s45, 4
    s_and_b32 s46, s42, 8
    s_add_u32 s43, s45, s46
    s_mul_i32 s43, s43, 3456
    s_add_u32 s43, s43, s35
    buffer_load_dwordx4 v8, s[8:11], s43 offen nt lds
    s_add_u32 s42, s42, 32
    s_add_u32 s49, s49, 4096
    s_mov_b32 m0, s49
    s_cmp_lt_u32 s42, s48
    s_cbranch_scc1 KD_2
    s_lshl_b32 s52, s50, 2
    s_add_u32 s52, s52, s13
    s_cmp_ge_u32 s52, 54
    s_cselect_b32 s53, 54, 0
    s_cselect_b32 s54, 8, 0
    s_sub_u32 s52, s52, s53
    s_cmp_ge_u32 s52, 27
    s_cselect_b32 s53, 27, 0
    s_cselect_b32 s55, 4, 0
    s_sub_u32 s52, s52, s53
    s_add_u32 s54, s54, s55
    s_mul_i32 s53, s52, 37
    s_lshr_b32 s53, s53, 8
    s_add_u32 s54, s54, s53
    s_mul_i32 s53, s53, 7
    s_sub_u32 s52, s52, s53
    s_mul_i32 s38, s54, 143360
    s_lshl_b32 s53, s52, 10
    s_add_u32 s38, s38, s53
    s_mul_i32 s53, s51, 71680
    s_add_u32 s38, s38, s53
    s_add_u32 s38, s38, 3440640
    s_mov_b32 s39, 7168
    s_mov_b32 s40, 10
    v_mov_b32 v9, v4
    v_lshlrev_b32 v18, 2, v3
    s_lshl_b32 s41, s51, 13
    s_lshl_b32 s53, s54, 9
    s_add_u32 s41, s41, s53
    s_lshl_b32 s53, s52, 6
    s_add_u32 s41, s41, s53
    s_add_u32 s41, s41, 6864896
    s_branch K0_common
K0_wo:
    s_mov_b32 s8, s20
    s_and_b32 s9, s21, 0xffff
    s_mov_b32 s10, 819200
    s_sub_u32 s50, s2, 114
    s_and_b32 s51, s50, 1
    s_lshr_b32 s50, s50, 1
    s_lshl_b32 s35, s50, 7
    s_mul_i32 s36, s51, 320
    s_mov_b32 s34, 1280
    v_mul_lo_u32 v8, v5, s34
    v_add_u32 v8, v8, v6
    s_lshl_b32 s48, s13, 3
    s_add_u32 s48, s48, s36
    s_lshl_b32 s49, s13, 10
    s_mov_b32 s42, s48
    s_mov_b32 m0, s49
    s_add_u32 s48, s48, 320
KD_3:
    s_lshr_b32 s44, s42, 5
    s_lshl_b32 s44, s44, 3
    s_add_u32 s44, s44, s42
    s_mul_i32 s45, s42, 5
    s_sub_u32 s45, s45, 2528
    s_cmp_lt_u32 s42, 512
    s_cselect_b32 s43, s44, s45
    s_mul_i32 s43, s43, 1280
    s_add_u32 s43, s43, s35
    buffer_load_dwordx4 v8, s[8:11], s43 offen nt lds
    s_add_u32 s42, s42, 32
    s_add_u32 s49, s49, 4096
    s_mov_b32 m0, s49
    s_cmp_lt_u32 s42, s48
    s_cbranch_scc1 KD_3
    s_lshl_b32 s52, s50, 2
    s_add_u32 s52, s52, s13
    s_mul_i32 s54, s52, 52
    s_lshr_b32 s54, s54, 8
    s_mul_i32 s53, s54, 5
    s_sub_u32 s52, s52, s53
    s_mul_i32 s38, s54, 102400
    s_lshl_b32 s53, s52, 10
    s_add_u32 s38, s38, s53
    s_mul_i32 s53, s51, 51200
    s_add_u32 s38, s38, s53
    s_add_u32 s38, s38, 2621440
    s_mov_b32 s39, 5120
    s_mov_b32 s40, 10
    v_mov_b32 v9, v4
    v_mov_b32 v18, 0
    s_mov_b32 s41, -1
    s_branch K0_common
K0_wout:
    s_mov_b32 s8, s30
    s_and_b32 s9, s31, 0xffff
    s_mov_b32 s10, 1105920
    s_sub_u32 s51, s2, 134
    s_mul_i32 s50, s51, 86
    s_lshr_b32 s50, s50, 8
    s_mul_i32 s53, s50, 3
    s_sub_u32 s51, s51, s53
    s_lshl_b32 s35, s50, 7
    s_mul_i32 s36, s51, 288
    s_mov_b32 s34, 1280
    v_mul_lo_u32 v8, v5, s34
    v_add_u32 v8, v8, v6
    s_lshl_b32 s48, s13, 3
    s_add_u32 s48, s48, s36
    s_lshl_b32 s49, s13, 10
    s_mov_b32 s42, s48
    s_mov_b32 m0, s49
    s_add_u32 s48, s48, 288
KD_4:
    s_lshr_b32 s44, s42, 4
    s_mul_i32 s45, s44, 43
    s_lshr_b32 s45, s45, 8
    s_add_u32 s46, s44, s45
    s_lshr_b32 s45, s45, 2
    s_sub_u32 s46, s46, s45
    s_sub_u32 s47, s44, 48
    s_cmp_ge_u32 s44, 51
    s_cselect_b32 s45, 1, 0
    s_add_u32 s47, s47, s45
    s_mul_i32 s47, s47, 7
    s_sub_u32 s47, s47, s45
    s_add_u32 s47, s47, 6
    s_cmp_lt_u32 s44, 48
    s_cselect_b32 s45, s46, s47
    s_lshl_b32 s45, s45, 4
    s_and_b32 s46, s42, 8
    s_add_u32 s43, s45, s46
    s_mul_i32 s43, s43, 1280
    s_add_u32 s43, s43, s35
    buffer_load_dwordx4 v8, s[8:11], s43 offen nt lds
    s_add_u32 s42, s42, 32
    s_add_u32 s49, s49, 4096
    s_mov_b32 m0, s49
    s_cmp_lt_u32 s42, s48
    s_cbranch_scc1 KD_4
    s_lshl_b32 s52, s50, 2
    s_add_u32 s52, s52, s13
    s_mul_i32 s54, s52, 52
    s_lshr_b32 s54, s54, 8
    s_mul_i32 s53, s54, 5
    s_sub_u32 s52, s52, s53
    s_mul_i32 s38, s54, 138240
    s_lshl_b32 s53, s52, 10
    s_add_u32 s38, s38, s53
    s_mul_i32 s53, s51, 46080
    s_add_u32 s38, s38, s53
    s_add_u32 s38, s38, 5734400
    s_mov_b32 s39, 5120
    s_mov_b32 s40, 9
    v_mov_b32 v9, v4
    v_mov_b32 v18, 0
    s_mov_b32 s41, -1
K0_common:
    s_nop 3
    v_lshrrev_b32 v21, 2, v3
    v_lshl_add_u32 v21, v2, 2, v21
    v_lshrrev_b32 v22, 1, v21
    v_and_b32 v22, 3, v22
    v_lshlrev_b32 v22, 1, v22
    v_bfe_u32 v23, v3, 1, 1
    s_lshl_b32 s53, s13, 1
    v_add_u32 v23, s53, v23
    v_xor_b32 v23, v23, v22
    v_lshlrev_b32 v20, 7, v21
    v_lshl_add_u32 v20, v23, 4, v20
    v_and_b32 v23, 1, v3
    v_lshl_add_u32 v20, v23, 3, v20
    v_mov_b32 v19, 0
    v_mov_b32 v24, 0x3f803f80
    s_getpc_b64 s[64:65]
CPF_5:
    s_add_u32 s64, s64, main_kernel-CPF_5
    s_addc_u32 s65, s65, 0
    s_lshr_b32 s66, s2, 3
    s_lshl_b32 s66, s66, 2
    s_add_u32 s66, s66, s13
    s_mul_i32 s66, s66, 1024
    v_and_b32 v25, 7, v0
    v_lshlrev_b32 v25, 7, v25
    v_add_u32 v25, s66, v25
    v_min_u32 v25, MAIN_END-main_kernel-4, v25
    global_load_dword v26, v25, s[64:65]
    s_waitcnt vmcnt(0)
    s_barrier
    ds_read_b64_tr_b16 v[32:33], v20 offset:0
    ds_read_b64_tr_b16 v[34:35], v20 offset:2048
    ds_read_b64_tr_b16 v[36:37], v20 offset:4096
    ds_read_b64_tr_b16 v[38:39], v20 offset:6144
    ds_read_b64_tr_b16 v[40:41], v20 offset:8192
    ds_read_b64_tr_b16 v[42:43], v20 offset:10240
    ds_read_b64_tr_b16 v[44:45], v20 offset:12288
    ds_read_b64_tr_b16 v[46:47], v20 offset:14336
    ds_read_b64_tr_b16 v[48:49], v20 offset:16384
    ds_read_b64_tr_b16 v[50:51], v20 offset:18432
    ds_read_b64_tr_b16 v[52:53], v20 offset:20480
    ds_read_b64_tr_b16 v[54:55], v20 offset:22528
    ds_read_b64_tr_b16 v[56:57], v20 offset:24576
    ds_read_b64_tr_b16 v[58:59], v20 offset:26624
    ds_read_b64_tr_b16 v[60:61], v20 offset:28672
    ds_read_b64_tr_b16 v[62:63], v20 offset:30720
    ds_read_b64_tr_b16 v[64:65], v20 offset:32768
    ds_read_b64_tr_b16 v[66:67], v20 offset:34816
    ds_read_b64_tr_b16 v[68:69], v20 offset:36864
    ds_read_b64_tr_b16 v[70:71], v20 offset:38912
    s_waitcnt lgkmcnt(15)
    buffer_store_dwordx4 v[32:35], v9, s[4:7], s38 offen sc1
    s_add_u32 s38, s38, s39
    v_dot2_f32_bf16 v19, v32, v24, v19
    v_dot2_f32_bf16 v19, v33, v24, v19
    v_dot2_f32_bf16 v19, v34, v24, v19
    v_dot2_f32_bf16 v19, v35, v24, v19
    s_waitcnt lgkmcnt(15)
    buffer_store_dwordx4 v[36:39], v9, s[4:7], s38 offen sc1
    s_add_u32 s38, s38, s39
    v_dot2_f32_bf16 v19, v36, v24, v19
    v_dot2_f32_bf16 v19, v37, v24, v19
    v_dot2_f32_bf16 v19, v38, v24, v19
    v_dot2_f32_bf16 v19, v39, v24, v19
    s_waitcnt lgkmcnt(14)
    buffer_store_dwordx4 v[40:43], v9, s[4:7], s38 offen sc1
    s_add_u32 s38, s38, s39
    v_dot2_f32_bf16 v19, v40, v24, v19
    v_dot2_f32_bf16 v19, v41, v24, v19
    v_dot2_f32_bf16 v19, v42, v24, v19
    v_dot2_f32_bf16 v19, v43, v24, v19
    s_waitcnt lgkmcnt(12)
    buffer_store_dwordx4 v[44:47], v9, s[4:7], s38 offen sc1
    s_add_u32 s38, s38, s39
    v_dot2_f32_bf16 v19, v44, v24, v19
    v_dot2_f32_bf16 v19, v45, v24, v19
    v_dot2_f32_bf16 v19, v46, v24, v19
    v_dot2_f32_bf16 v19, v47, v24, v19
    s_waitcnt lgkmcnt(10)
    buffer_store_dwordx4 v[48:51], v9, s[4:7], s38 offen sc1
    s_add_u32 s38, s38, s39
    v_dot2_f32_bf16 v19, v48, v24, v19
    v_dot2_f32_bf16 v19, v49, v24, v19
    v_dot2_f32_bf16 v19, v50, v24, v19
    v_dot2_f32_bf16 v19, v51, v24, v19
    s_waitcnt lgkmcnt(8)
    buffer_store_dwordx4 v[52:55], v9, s[4:7], s38 offen sc1
    s_add_u32 s38, s38, s39
    v_dot2_f32_bf16 v19, v52, v24, v19
    v_dot2_f32_bf16 v19, v53, v24, v19
    v_dot2_f32_bf16 v19, v54, v24, v19
    v_dot2_f32_bf16 v19, v55, v24, v19
    s_waitcnt lgkmcnt(6)
    buffer_store_dwordx4 v[56:59], v9, s[4:7], s38 offen sc1
    s_add_u32 s38, s38, s39
    v_dot2_f32_bf16 v19, v56, v24, v19
    v_dot2_f32_bf16 v19, v57, v24, v19
    v_dot2_f32_bf16 v19, v58, v24, v19
    v_dot2_f32_bf16 v19, v59, v24, v19
    s_waitcnt lgkmcnt(4)
    buffer_store_dwordx4 v[60:63], v9, s[4:7], s38 offen sc1
    s_add_u32 s38, s38, s39
    v_dot2_f32_bf16 v19, v60, v24, v19
    v_dot2_f32_bf16 v19, v61, v24, v19
    v_dot2_f32_bf16 v19, v62, v24, v19
    v_dot2_f32_bf16 v19, v63, v24, v19
    s_waitcnt lgkmcnt(2)
    buffer_store_dwordx4 v[64:67], v9, s[4:7], s38 offen sc1
    s_add_u32 s38, s38, s39
    v_dot2_f32_bf16 v19, v64, v24, v19
    v_dot2_f32_bf16 v19, v65, v24, v19
    v_dot2_f32_bf16 v19, v66, v24, v19
    v_dot2_f32_bf16 v19, v67, v24, v19
    s_cmp_lt_u32 s40, 10
    s_cbranch_scc1 K0_end
    s_waitcnt lgkmcnt(0)
    buffer_store_dwordx4 v[68:71], v9, s[4:7], s38 offen sc1
    s_add_u32 s38, s38, s39
    v_dot2_f32_bf16 v19, v68, v24, v19
    v_dot2_f32_bf16 v19, v69, v24, v19
    v_dot2_f32_bf16 v19, v70, v24, v19
    v_dot2_f32_bf16 v19, v71, v24, v19
    s_cmp_eq_u32 s41, -1
    s_cbranch_scc1 K0_end
    s_nop 0
    v_mov_b32 v21, v19
    s_nop 1
    v_permlane32_swap_b32 v21, v19
    v_add_f32 v19, v19, v21
    v_mov_b32 v21, v19
    s_nop 1
    v_permlane16_swap_b32 v21, v19
    v_add_f32 v19, v19, v21
    s_mov_b64 exec, 0xffff
    buffer_store_dword v19, v18, s[4:7], s41 offen
    s_endpgm
K0_x:
    s_mov_b32 s8, s16
    s_and_b32 s9, s17, 0xffff
    s_mov_b32 s10, 2621440
    s_sub_u32 s50, s2, 164
    s_mul_i32 s35, s50, 40960
    s_lshl_b32 s49, s13, 10
    s_lshl_b32 s48, s13, 6
    v_add_u32 v5, s48, v0
    s_add_u32 s48, s49, 40960
K0_xl:
    v_mul_u32_u24 v7, 52429, v5
    v_lshrrev_b32 v7, 22, v7
    s_mov_b32 m0, s49
    v_and_b32 v8, 15, v7
    v_xor_b32 v8, v8, v5
    v_lshlrev_b32 v8, 4, v8
    v_add_u32 v5, 256, v5
    buffer_load_dwordx4 v8, s[8:11], s35 offen nt lds
    s_add_u32 s49, s49, 4096
    s_cmp_lt_u32 s49, s48
    s_cbranch_scc1 K0_xl
    s_and_b32 s51, s13, 1
    s_lshr_b32 s52, s13, 1
    s_lshl_b32 s53, s51, 4
    v_add_u32 v9, s53, v3
    v_mul_u32_u24 v10, 1280, v9
    v_and_b32 v11, 1, v2
    v_lshl_add_u32 v10, v11, 3, v10
    v_lshrrev_b32 v11, 1, v2
    v_xor_b32 v11, v11, v3
    v_lshlrev_b32 v11, 4, v11
    v_mov_b32 v18, 0
    v_mov_b32 v19, 0
    v_mov_b32 v24, 0x3f803f80
    s_mul_i32 s38, s52, 1310720
    s_lshl_b32 s53, s50, 11
    s_add_u32 s38, s38, s53
    s_lshl_b32 s53, s51, 10
    s_add_u32 s38, s38, s53
    s_add_u32 s38, s38, 15339520
    s_mul_i32 s54, s52, 20
    s_sub_u32 s53, 4, s52
    v_lshlrev_b32 v13, s53, v0
    s_mul_i32 s53, s52, 504
    s_add_u32 s53, s53, 8
    v_add_u32 v14, s53, v13
    s_getpc_b64 s[64:65]
CPF_6:
    s_add_u32 s64, s64, main_kernel-CPF_6
    s_addc_u32 s65, s65, 0
    s_lshr_b32 s66, s2, 3
    s_lshl_b32 s66, s66, 2
    s_add_u32 s66, s66, s13
    s_mul_i32 s66, s66, 1024
    v_and_b32 v25, 7, v0
    v_lshlrev_b32 v25, 7, v25
    v_add_u32 v25, s66, v25
    v_min_u32 v25, MAIN_END-main_kernel-4, v25
    global_load_dword v26, v25, s[64:65]
    s_cmp_eq_u32 s52, 0
    s_cbranch_scc0 K0_xa1
    v_xor_b32 v72, 0, v11
    v_add3_u32 v72, v72, v10, 0
    v_xor_b32 v73, 32, v11
    v_add3_u32 v73, v73, v10, 0
    v_xor_b32 v74, 64, v11
    v_add3_u32 v74, v74, v10, 0
    v_xor_b32 v75, 96, v11
    v_add3_u32 v75, v75, v10, 0
    v_xor_b32 v76, 160, v11
    v_add3_u32 v76, v76, v10, 0
    v_xor_b32 v77, 192, v11
    v_add3_u32 v77, v77, v10, 0
    v_xor_b32 v78, 224, v11
    v_add3_u32 v78, v78, v10, 0
    v_xor_b32 v79, 256, v11
    v_add_u32 v79, v79, v10
    v_xor_b32 v80, 320, v11
    v_add_u32 v80, v80, v10
    v_xor_b32 v81, 352, v11
    v_add_u32 v81, v81, v10
    v_xor_b32 v82, 384, v11
    v_add_u32 v82, v82, v10
    v_xor_b32 v83, 416, v11
    v_add_u32 v83, v83, v10
    v_xor_b32 v84, 480, v11
    v_add_u32 v84, v84, v10
    v_xor_b32 v85, 512, v11
    v_add_u32 v85, v85, v10
    v_xor_b32 v86, 544, v11
    v_add_u32 v86, v86, v10
    v_xor_b32 v87, 576, v11
    v_add_u32 v87, v87, v10
    v_xor_b32 v88, 640, v11
    v_add_u32 v88, v88, v10
    v_xor_b32 v89, 672, v11
    v_add_u32 v89, v89, v10
    v_xor_b32 v90, 704, v11
    v_add_u32 v90, v90, v10
    v_xor_b32 v91, 736, v11
    v_add_u32 v91, v91, v10
    s_branch K0_xa2
K0_xa1:
    v_xor_b32 v72, 800, v11
    v_add_u32 v72, v72, v10
    v_xor_b32 v73, 832, v11
    v_add_u32 v73, v73, v10
    v_xor_b32 v74, 864, v11
    v_add_u32 v74, v74, v10
    v_xor_b32 v75, 896, v11
    v_add_u32 v75, v75, v10
    v_xor_b32 v76, 960, v11
    v_add_u32 v76, v76, v10
    v_xor_b32 v77, 992, v11
    v_add_u32 v77, v77, v10
    v_xor_b32 v78, 1024, v11
    v_add_u32 v78, v78, v10
    v_xor_b32 v79, 1056, v11
    v_add_u32 v79, v79, v10
    v_xor_b32 v80, 1120, v11
    v_add_u32 v80, v80, v10
    v_xor_b32 v81, 1152, v11
    v_add_u32 v81, v81, v10
    v_xor_b32 v82, 1184, v11
    v_add_u32 v82, v82, v10
    v_xor_b32 v83, 1216, v11
    v_add_u32 v83, v83, v10
    v_xor_b32 v84, 128, v11
    v_add3_u32 v84, v84, v10, 0
    v_xor_b32 v85, 288, v11
    v_add_u32 v85, v85, v10
    v_xor_b32 v86, 448, v11
    v_add_u32 v86, v86, v10
    v_xor_b32 v87, 608, v11
    v_add_u32 v87, v87, v10
    v_xor_b32 v88, 768, v11
    v_add_u32 v88, v88, v10
    v_xor_b32 v89, 928, v11
    v_add_u32 v89, v89, v10
    v_xor_b32 v90, 1088, v11
    v_add_u32 v90, v90, v10
    v_xor_b32 v91, 1248, v11
    v_add_u32 v91, v91, v10
K0_xa2:
    s_waitcnt vmcnt(0)
    s_barrier
    ds_read_b64 v[32:33], v72
    ds_read_b64 v[34:35], v73
    ds_read_b64 v[36:37], v74
    ds_read_b64 v[38:39], v75
    ds_read_b64 v[40:41], v76
    ds_read_b64 v[42:43], v77
    ds_read_b64 v[44:45], v78
    ds_read_b64 v[46:47], v79
    ds_read_b64 v[48:49], v80
    ds_read_b64 v[50:51], v81
    ds_read_b64 v[52:53], v82
    ds_read_b64 v[54:55], v83
    ds_read_b64 v[56:57], v84
    ds_read_b64 v[58:59], v85
    ds_read_b64 v[60:61], v86
    ds_read_b64 v[62:63], v87
    ds_read_b64 v[64:65], v88
    ds_read_b64 v[66:67], v89
    ds_read_b64 v[68:69], v90
    ds_read_b64 v[70:71], v91
    s_waitcnt lgkmcnt(15)
    buffer_store_dwordx4 v[32:35], v4, s[4:7], s38 offen sc1
    s_add_u32 s38, s38, 131072
    v_dot2_f32_bf16 v18, v32, v24, v18
    v_dot2_f32_bf16 v19, v32, v32, v19
    v_dot2_f32_bf16 v18, v33, v24, v18
    v_dot2_f32_bf16 v19, v33, v33, v19
    v_dot2_f32_bf16 v18, v34, v24, v18
    v_dot2_f32_bf16 v19, v34, v34, v19
    v_dot2_f32_bf16 v18, v35, v24, v18
    v_dot2_f32_bf16 v19, v35, v35, v19
    s_waitcnt lgkmcnt(15)
    buffer_store_dwordx4 v[36:39], v4, s[4:7], s38 offen sc1
    s_add_u32 s38, s38, 131072
    v_dot2_f32_bf16 v18, v36, v24, v18
    v_dot2_f32_bf16 v19, v36, v36, v19
    v_dot2_f32_bf16 v18, v37, v24, v18
    v_dot2_f32_bf16 v19, v37, v37, v19
    v_dot2_f32_bf16 v18, v38, v24, v18
    v_dot2_f32_bf16 v19, v38, v38, v19
    v_dot2_f32_bf16 v18, v39, v24, v18
    v_dot2_f32_bf16 v19, v39, v39, v19
    s_waitcnt lgkmcnt(14)
    buffer_store_dwordx4 v[40:43], v4, s[4:7], s38 offen sc1
    s_add_u32 s38, s38, 131072
    v_dot2_f32_bf16 v18, v40, v24, v18
    v_dot2_f32_bf16 v19, v40, v40, v19
    v_dot2_f32_bf16 v18, v41, v24, v18
    v_dot2_f32_bf16 v19, v41, v41, v19
    v_dot2_f32_bf16 v18, v42, v24, v18
    v_dot2_f32_bf16 v19, v42, v42, v19
    v_dot2_f32_bf16 v18, v43, v24, v18
    v_dot2_f32_bf16 v19, v43, v43, v19
    s_waitcnt lgkmcnt(12)
    buffer_store_dwordx4 v[44:47], v4, s[4:7], s38 offen sc1
    s_add_u32 s38, s38, 131072
    v_dot2_f32_bf16 v18, v44, v24, v18
    v_dot2_f32_bf16 v19, v44, v44, v19
    v_dot2_f32_bf16 v18, v45, v24, v18
    v_dot2_f32_bf16 v19, v45, v45, v19
    v_dot2_f32_bf16 v18, v46, v24, v18
    v_dot2_f32_bf16 v19, v46, v46, v19
    v_dot2_f32_bf16 v18, v47, v24, v18
    v_dot2_f32_bf16 v19, v47, v47, v19
    s_waitcnt lgkmcnt(10)
    buffer_store_dwordx4 v[48:51], v4, s[4:7], s38 offen sc1
    s_add_u32 s38, s38, 131072
    v_dot2_f32_bf16 v18, v48, v24, v18
    v_dot2_f32_bf16 v19, v48, v48, v19
    v_dot2_f32_bf16 v18, v49, v24, v18
    v_dot2_f32_bf16 v19, v49, v49, v19
    v_dot2_f32_bf16 v18, v50, v24, v18
    v_dot2_f32_bf16 v19, v50, v50, v19
    v_dot2_f32_bf16 v18, v51, v24, v18
    v_dot2_f32_bf16 v19, v51, v51, v19
    s_waitcnt lgkmcnt(8)
    buffer_store_dwordx4 v[52:55], v4, s[4:7], s38 offen sc1
    s_add_u32 s38, s38, 131072
    v_dot2_f32_bf16 v18, v52, v24, v18
    v_dot2_f32_bf16 v19, v52, v52, v19
    v_dot2_f32_bf16 v18, v53, v24, v18
    v_dot2_f32_bf16 v19, v53, v53, v19
    v_dot2_f32_bf16 v18, v54, v24, v18
    v_dot2_f32_bf16 v19, v54, v54, v19
    v_dot2_f32_bf16 v18, v55, v24, v18
    v_dot2_f32_bf16 v19, v55, v55, v19
    s_waitcnt lgkmcnt(6)
    buffer_store_dwordx2 v[56:57], v13, s[4:7], s38 offen
    buffer_store_dwordx2 v[58:59], v14, s[4:7], s38 offen
    s_add_u32 s38, s38, 131072
    v_dot2_f32_bf16 v18, v56, v24, v18
    v_dot2_f32_bf16 v19, v56, v56, v19
    v_dot2_f32_bf16 v18, v57, v24, v18
    v_dot2_f32_bf16 v19, v57, v57, v19
    v_dot2_f32_bf16 v18, v58, v24, v18
    v_dot2_f32_bf16 v19, v58, v58, v19
    v_dot2_f32_bf16 v18, v59, v24, v18
    v_dot2_f32_bf16 v19, v59, v59, v19
    s_waitcnt lgkmcnt(4)
    buffer_store_dwordx2 v[60:61], v13, s[4:7], s38 offen
    buffer_store_dwordx2 v[62:63], v14, s[4:7], s38 offen
    s_add_u32 s38, s38, 131072
    v_dot2_f32_bf16 v18, v60, v24, v18
    v_dot2_f32_bf16 v19, v60, v60, v19
    v_dot2_f32_bf16 v18, v61, v24, v18
    v_dot2_f32_bf16 v19, v61, v61, v19
    v_dot2_f32_bf16 v18, v62, v24, v18
    v_dot2_f32_bf16 v19, v62, v62, v19
    v_dot2_f32_bf16 v18, v63, v24, v18
    v_dot2_f32_bf16 v19, v63, v63, v19
    s_waitcnt lgkmcnt(2)
    buffer_store_dwordx2 v[64:65], v13, s[4:7], s38 offen
    buffer_store_dwordx2 v[66:67], v14, s[4:7], s38 offen
    s_add_u32 s38, s38, 131072
    v_dot2_f32_bf16 v18, v64, v24, v18
    v_dot2_f32_bf16 v19, v64, v64, v19
    v_dot2_f32_bf16 v18, v65, v24, v18
    v_dot2_f32_bf16 v19, v65, v65, v19
    v_dot2_f32_bf16 v18, v66, v24, v18
    v_dot2_f32_bf16 v19, v66, v66, v19
    v_dot2_f32_bf16 v18, v67, v24, v18
    v_dot2_f32_bf16 v19, v67, v67, v19
    s_waitcnt lgkmcnt(0)
    buffer_store_dwordx2 v[68:69], v13, s[4:7], s38 offen
    buffer_store_dwordx2 v[70:71], v14, s[4:7], s38 offen
    s_add_u32 s38, s38, 131072
    v_dot2_f32_bf16 v18, v68, v24, v18
    v_dot2_f32_bf16 v19, v68, v68, v19
    v_dot2_f32_bf16 v18, v69, v24, v18
    v_dot2_f32_bf16 v19, v69, v69, v19
    v_dot2_f32_bf16 v18, v70, v24, v18
    v_dot2_f32_bf16 v19, v70, v70, v19
    v_dot2_f32_bf16 v18, v71, v24, v18
    v_dot2_f32_bf16 v19, v71, v71, v19
    v_lshlrev_b32 v12, 14, v2
    v_lshl_add_u32 v12, v9, 3, v12
    s_lshl_b32 s38, s52, 16
    s_lshl_b32 s53, s50, 8
    s_add_u32 s38, s38, s53
    s_add_u32 s38, s38, 17960960
    buffer_store_dwordx2 v[18:19], v12, s[4:7], s38 offen
    s_endpgm
K0_zero:
    s_mov_b32 s8, s28
    s_and_b32 s9, s29, 0xffff
    s_mov_b32 s10, 4096
    s_lshl_b32 s41, s13, 10
    buffer_load_dwordx4 v[12:15], v4, s[8:11], s41 offen
    v_mov_b32 v8, 0
    v_mov_b32 v9, 0
    v_mov_b32 v10, 0
    v_mov_b32 v11, 0
    s_sub_u32 s50, s2, 228
    s_mul_i32 s38, s50, 19677184
    s_add_u32 s38, s38, 31330304
    s_lshl_b32 s53, s13, 12
    s_add_u32 s38, s38, s53
    s_lshl_b32 s39, s50, 15
    s_add_u32 s39, s39, 6881280
    s_lshl_b32 s53, s13, 13
    s_add_u32 s39, s39, s53
    s_add_u32 s40, s39, 4096
    buffer_store_dwordx4 v[8:11], v4, s[4:7], s38 offen offset:0
    buffer_store_dwordx4 v[8:11], v4, s[4:7], s39 offen offset:0
    buffer_store_dwordx4 v[8:11], v4, s[4:7], s40 offen offset:0
    buffer_store_dwordx4 v[8:11], v4, s[4:7], s38 offen offset:1024
    buffer_store_dwordx4 v[8:11], v4, s[4:7], s39 offen offset:1024
    buffer_store_dwordx4 v[8:11], v4, s[4:7], s40 offen offset:1024
    buffer_store_dwordx4 v[8:11], v4, s[4:7], s38 offen offset:2048
    buffer_store_dwordx4 v[8:11], v4, s[4:7], s39 offen offset:2048
    buffer_store_dwordx4 v[8:11], v4, s[4:7], s40 offen offset:2048
    buffer_store_dwordx4 v[8:11], v4, s[4:7], s38 offen offset:3072
    buffer_store_dwordx4 v[8:11], v4, s[4:7], s39 offen offset:3072
    buffer_store_dwordx4 v[8:11], v4, s[4:7], s40 offen offset:3072
    s_add_u32 s41, s41, 6946816
    s_waitcnt vmcnt(12)
    buffer_store_dwordx4 v[12:15], v4, s[4:7], s41 offen
K0_end:
    s_endpgm
.globl main_kernel
.p2align 8
.type main_kernel,@function
main_kernel:
    s_cmp_ge_u32 s2, 256
    s_cbranch_scc1 END
    s_load_dwordx4 s[20:23], s[0:1], 40
    s_load_dwordx2 s[24:25], s[0:1], 64
    s_load_dwordx2 s[26:27], s[0:1], 80
    v_lshrrev_b32 v1, 6, v0
    v_and_b32 v0, 63, v0
    v_readfirstlane_b32 s13, v1
    v_lshrrev_b32 v1, 4, v0
    v_and_b32 v2, 15, v0
    v_lshlrev_b32 v3, 4, v0
    s_mov_b32 s12, 15339520
    s_mov_b32 s14, 0
    s_mov_b32 s52, 6881280
    s_mov_b32 s62, 0
    s_and_b32 s15, s2, 7
    s_lshr_b32 s53, s2, 3
    s_lshr_b32 s16, s15, 1
    s_and_b32 s17, s15, 1
    s_lshl_b32 s48, s16, 2
    s_lshr_b32 s18, s53, 3
    s_add_u32 s48, s48, s18
    s_lshl_b32 s49, s17, 3
    s_and_b32 s18, s53, 7
    s_add_u32 s49, s49, s18
    s_lshl_b32 s50, s16, 3
    s_lshr_b32 s18, s53, 2
    s_add_u32 s50, s50, s18
    s_lshl_b32 s51, s17, 2
    s_and_b32 s18, s53, 3
    s_add_u32 s51, s51, s18
    s_waitcnt lgkmcnt(0)
    s_mov_b32 s4, s26
    s_and_b32 s5, s27, 0xffff
    s_mov_b32 s6, 268435456
    s_mov_b32 s7, 0x00020000
    s_cmp_ge_u32 s13, 6
    s_cbranch_scc1 LDB
    s_cmp_ge_u32 s13, 4
    s_cbranch_scc1 LDA
C_loop:
    s_nop 1
    s_lshl_b32 s34, s49, 9
    s_add_u32 s34, s34, 6848512
    s_add_u32 s35, s34, 8192
    v_lshlrev_b32 v19, 3, v0
    buffer_load_dwordx2 v[208:209], v19, s[4:7], s34 offen
    buffer_load_dwordx2 v[210:211], v19, s[4:7], s35 offen
    s_lshl_b32 s30, s13, 11
    s_add_u32 s30, s30, 1024
    v_add_u32 v13, s30, v3
    v_add_u32 v4, 20480, v13
    v_add_u32 v5, 86016, v13
    v_add_u32 v6, 20480, v3
    v_add_u32 v7, 86016, v3
    v_add_u32 v8, 98304, v3
    v_add_u32 v252, 20480, v19
    v_add_u32 v11, s30, v252
    s_min_u32 s31, s13, 2
    s_lshl_b32 s32, s31, 1
    s_add_u32 s32, s32, 1
    s_min_u32 s32, s32, 4
    s_add_u32 s33, s31, 5
    s_lshl_b32 s34, s32, 10
    v_add_u32 v9, s34, v8
    s_lshl_b32 s34, s33, 10
    v_add_u32 v10, s34, v8
    s_mov_b32 s40, 0xffff
    s_mov_b32 s41, 0
    s_mov_b32 s42, 0xffff0000
    s_mov_b32 s43, 0
    v_lshlrev_b32 v16, 2, v1
    v_sub_u32 v16, v2, v16
    v_mov_b32 v17, 0xff800000
    v_add_u32 v18, 16, v16
    v_and_b32 v18, 0xfffffff1, v18
    v_cmp_eq_u32 vcc, 0, v18
    s_nop 1
    v_cndmask_b32 v234, v17, 0, vcc
    v_add_u32 v18, 15, v16
    v_and_b32 v18, 0xfffffff1, v18
    v_cmp_eq_u32 vcc, 0, v18
    s_nop 1
    v_cndmask_b32 v235, v17, 0, vcc
    s_cmp_eq_u32 s14, 0
    s_cbranch_scc1 P1_nog
    s_waitcnt vmcnt(2)
    s_barrier
P1_nog:
    v_add_u32 v18, 14, v16
    v_and_b32 v18, 0xfffffff1, v18
    v_cmp_eq_u32 vcc, 0, v18
    s_nop 1
    v_cndmask_b32 v236, v17, 0, vcc
    v_add_u32 v18, 13, v16
    v_and_b32 v18, 0xfffffff1, v18
    v_cmp_eq_u32 vcc, 0, v18
    s_nop 1
    v_cndmask_b32 v237, v17, 0, vcc
    v_add_u32 v18, 0, v16
    v_and_b32 v18, 0xfffffff1, v18
    v_cmp_eq_u32 vcc, 0, v18
    s_nop 1
    v_cndmask_b32 v238, v17, 0, vcc
    v_add_u32 v18, -1, v16
    v_and_b32 v18, 0xfffffff1, v18
    v_cmp_eq_u32 vcc, 0, v18
    s_nop 1
    v_cndmask_b32 v239, v17, 0, vcc
    v_add_u32 v18, -2, v16
    v_and_b32 v18, 0xfffffff1, v18
    v_cmp_eq_u32 vcc, 0, v18
    s_nop 1
    v_cndmask_b32 v240, v17, 0, vcc
    v_add_u32 v18, -3, v16
    v_and_b32 v18, 0xfffffff1, v18
    v_cmp_eq_u32 vcc, 0, v18
    s_nop 1
    v_cndmask_b32 v241, v17, 0, vcc
    s_add_u32 s34, s48, s13
    s_cmp_eq_u32 s34, 0
    s_cselect_b64 s[38:39], -1, 0
    v_cndmask_b32 v242, v234, v17, s[38:39]
    v_mov_b32 v246, 0x3f803f80
    v_cndmask_b32 v243, v235, v17, s[38:39]
    v_mov_b32 v247, 0x3f803f80
    v_cndmask_b32 v244, v236, v17, s[38:39]
    v_mov_b32 v248, 0x3f803f80
    v_cndmask_b32 v245, v237, v17, s[38:39]
    v_mov_b32 v249, 0x3f803f80
    s_mov_b32 s44, 0x3ea52b5c
    s_mov_b32 s45, 0x3ea52b5c
    s_lshl_b32 s46, s49, 17
    s_lshl_b32 s47, s48, 13
    s_lshl_b32 s37, s13, 11
    s_add_u32 s47, s47, s37
    s_add_u32 s47, s47, s12
    s_add_u32 s47, s47, 2752512
    s_add_u32 s46, s46, s47
    s_lshr_b32 s37, s49, 2
    s_add_u32 s37, s37, 16
    s_lshl_b32 s37, s37, 17
    s_add_u32 s47, s47, s37
    s_and_b32 s37, s49, 3
    s_lshl_b32 s37, s37, 8
    s_add_u32 s47, s47, s37
    s_lshl_b32 s36, s13, 7
    v_lshlrev_b32 v18, 2, v2
    v_add_u32 v13, s36, v18
    v_lshlrev_b32 v23, 4, v1
    v_add_u32 v14, s36, v23
    s_lshl_b32 s34, s32, 6
    v_add_u32 v15, s34, v23
    s_lshl_b32 s34, s33, 6
    v_add_u32 v12, s34, v18
    s_lshl_b32 s34, s31, 9
    v_add_u32 v20, s34, v19
    s_mul_i32 s34, s13, 3072
    v_add_u32 v21, s34, v19
    v_or_b32 v22, 256, v21
    s_waitcnt vmcnt(0)
    v_pk_add_f32 v[208:209], v[208:209], v[210:211]
    ds_write_b64 v19, v[208:209] offset:1536
    s_waitcnt lgkmcnt(0)
    s_cmp_eq_u32 s14, 0
    s_cbranch_scc1 P1_nof
    s_cmp_lg_u32 s13, 3
    s_cbranch_scc1 CPL1_ok
    s_lshl_b32 s72, s48, 8
    s_add_u32 s72, s72, 6895488
    s_min_u32 s73, s48, 1
    s_or_b32 exec_lo, s73, 0x10100
    s_mov_b32 exec_hi, 0
    s_mov_b32 s73, 0
    buffer_load_dword v253, v3, s[4:7], s72 offen sc1
    s_sleep 2
    buffer_load_dword v254, v3, s[4:7], s72 offen sc1
    s_sleep 2
CPL1:
    buffer_load_dword v255, v3, s[4:7], s72 offen sc1
    s_waitcnt vmcnt(2)
    v_cmp_ne_u32 vcc, 8, v253
    s_nop 1
    s_cmp_eq_u64 vcc, 0
    s_cbranch_scc1 CPL1_x
    s_sleep 1
    buffer_load_dword v253, v3, s[4:7], s72 offen sc1
    s_waitcnt vmcnt(2)
    v_cmp_ne_u32 vcc, 8, v254
    s_nop 1
    s_cmp_eq_u64 vcc, 0
    s_cbranch_scc1 CPL1_x
    s_sleep 1
    buffer_load_dword v254, v3, s[4:7], s72 offen sc1
    s_waitcnt vmcnt(2)
    v_cmp_ne_u32 vcc, 8, v255
    s_nop 1
    s_cmp_eq_u64 vcc, 0
    s_cbranch_scc1 CPL1_x
    s_sleep 1
    s_add_u32 s73, s73, 1
    s_cmp_lt_u32 s73, 0x20000
    s_cbranch_scc1 CPL1
CPL1_x:
    s_mov_b64 exec, -1
CPL1_ok:
    s_barrier
P1_nof:
    s_barrier
    ds_read_b128 v[104:107], v6 offset:18432
    ds_read_b128 v[108:111], v9 offset:32768
    ds_read_b128 v[112:115], v10 offset:32768
    ds_read_b128 v[116:119], v4 offset:18432
    ds_read_b128 v[120:123], v8 offset:32768
    ds_read_b128 v[124:127], v4 offset:19456
    ds_read_b128 v[128:131], v8 offset:33792
    ds_read_b128 v[132:135], v8 offset:34816
    ds_read_b128 v[136:139], v8 offset:35840
    ds_read_b128 v[140:143], v8 offset:36864
    ds_read_b128 v[144:147], v8 offset:37888
    ds_read_b128 v[148:151], v8 offset:38912
    ds_read_b128 v[152:155], v8 offset:39936
    s_waitcnt lgkmcnt(11)
    v_mfma_f32_16x16x32_bf16 v[96:99], v[108:111], v[104:107], 0
    ds_read_b128 v[156:159], v6 offset:27648
    s_waitcnt lgkmcnt(11)
    v_mfma_f32_16x16x32_bf16 v[100:103], v[104:107], v[112:115], 0
    ds_read_b128 v[160:163], v9 offset:40960
    s_waitcnt lgkmcnt(10)
    v_mfma_f32_16x16x32_bf16 v[32:35], v[120:123], v[116:119], 0
    ds_read_b128 v[164:167], v10 offset:40960
    s_waitcnt lgkmcnt(10)
    v_mfma_f32_16x16x32_bf16 v[36:39], v[120:123], v[124:127], 0
    ds_read_b128 v[168:171], v4 offset:27648
    s_waitcnt lgkmcnt(10)
    v_mfma_f32_16x16x32_bf16 v[40:43], v[128:131], v[116:119], 0
    ds_read_b128 v[172:175], v8 offset:40960
    v_mfma_f32_16x16x32_bf16 v[44:47], v[128:131], v[124:127], 0
    ds_read_b128 v[176:179], v4 offset:28672
    s_waitcnt lgkmcnt(11)
    v_mfma_f32_16x16x32_bf16 v[48:51], v[132:135], v[116:119], 0
    ds_read_b128 v[180:183], v8 offset:41984
    v_mfma_f32_16x16x32_bf16 v[52:55], v[132:135], v[124:127], 0
    ds_read_b128 v[184:187], v8 offset:43008
    s_waitcnt lgkmcnt(12)
    v_mfma_f32_16x16x32_bf16 v[56:59], v[136:139], v[116:119], 0
    ds_read_b128 v[188:191], v8 offset:44032
    ds_read_b128 v[192:195], v8 offset:45056
    ds_read_b128 v[196:199], v8 offset:46080
    ds_read_b128 v[200:203], v8 offset:47104
    ds_read_b128 v[204:207], v8 offset:48128
    s_waitcnt lgkmcnt(0)
    s_barrier
    v_mfma_f32_16x16x32_bf16 v[60:63], v[136:139], v[124:127], 0
    ds_read_b128 v[108:111], v6 offset:36864
    v_mfma_f32_16x16x32_bf16 v[64:67], v[140:143], v[116:119], 0
    ds_read_b128 v[104:107], v9 offset:49152
    v_mfma_f32_16x16x32_bf16 v[68:71], v[140:143], v[124:127], 0
    ds_read_b128 v[112:115], v10 offset:49152
    v_mfma_f32_16x16x32_bf16 v[72:75], v[116:119], v[144:147], 0
    ds_read_b128 v[120:123], v4 offset:36864
    v_mfma_f32_16x16x32_bf16 v[76:79], v[124:127], v[144:147], 0
    ds_read_b128 v[128:131], v8 offset:49152
    v_mfma_f32_16x16x32_bf16 v[80:83], v[116:119], v[148:151], 0
    ds_read_b128 v[132:135], v4 offset:37888
    v_mfma_f32_16x16x32_bf16 v[84:87], v[124:127], v[148:151], 0
    ds_read_b128 v[136:139], v8 offset:50176
    v_mfma_f32_16x16x32_bf16 v[88:91], v[116:119], v[152:155], 0
    ds_read_b128 v[140:143], v8 offset:51200
    v_mfma_f32_16x16x32_bf16 v[92:95], v[124:127], v[152:155], 0
    ds_read_b128 v[144:147], v8 offset:52224
    v_mfma_f32_16x16x32_bf16 v[96:99], v[160:163], v[156:159], v[96:99]
    ds_read_b128 v[148:151], v8 offset:53248
    v_mfma_f32_16x16x32_bf16 v[100:103], v[156:159], v[164:167], v[100:103]
    ds_read_b128 v[116:119], v8 offset:54272
    v_mfma_f32_16x16x32_bf16 v[32:35], v[172:175], v[168:171], v[32:35]
    ds_read_b128 v[124:127], v8 offset:55296
    v_mfma_f32_16x16x32_bf16 v[36:39], v[172:175], v[176:179], v[36:39]
    ds_read_b128 v[152:155], v8 offset:56320
    v_mfma_f32_16x16x32_bf16 v[40:43], v[180:183], v[168:171], v[40:43]
    ds_read_b128 v[160:163], v6 offset:46080
    v_mfma_f32_16x16x32_bf16 v[44:47], v[180:183], v[176:179], v[44:47]
    ds_read_b128 v[156:159], v9 offset:57344
    v_mfma_f32_16x16x32_bf16 v[48:51], v[184:187], v[168:171], v[48:51]
    ds_read_b128 v[164:167], v10 offset:57344
    v_mfma_f32_16x16x32_bf16 v[52:55], v[184:187], v[176:179], v[52:55]
    ds_read_b128 v[172:175], v4 offset:46080
    v_mfma_f32_16x16x32_bf16 v[56:59], v[188:191], v[168:171], v[56:59]
    ds_read_b128 v[180:183], v8 offset:57344
    v_mfma_f32_16x16x32_bf16 v[60:63], v[188:191], v[176:179], v[60:63]
    ds_read_b128 v[184:187], v4 offset:47104
    v_mfma_f32_16x16x32_bf16 v[64:67], v[192:195], v[168:171], v[64:67]
    ds_read_b128 v[188:191], v8 offset:58368
    v_mfma_f32_16x16x32_bf16 v[68:71], v[192:195], v[176:179], v[68:71]
    ds_read_b128 v[192:195], v8 offset:59392
    v_mfma_f32_16x16x32_bf16 v[72:75], v[168:171], v[196:199], v[72:75]
    ds_read_b128 v[216:219], v8 offset:60416
    v_mfma_f32_16x16x32_bf16 v[76:79], v[176:179], v[196:199], v[76:79]
    ds_read_b128 v[196:199], v8 offset:61440
    v_mfma_f32_16x16x32_bf16 v[80:83], v[168:171], v[200:203], v[80:83]
    ds_read_b128 v[220:223], v8 offset:62464
    v_mfma_f32_16x16x32_bf16 v[84:87], v[176:179], v[200:203], v[84:87]
    ds_read_b128 v[200:203], v8 offset:63488
    v_mfma_f32_16x16x32_bf16 v[88:91], v[168:171], v[204:207], v[88:91]
    ds_read_b128 v[168:171], v8 offset:64512
    v_mfma_f32_16x16x32_bf16 v[92:95], v[176:179], v[204:207], v[92:95]
    s_waitcnt lgkmcnt(15)
    v_mfma_f32_16x16x32_bf16 v[96:99], v[104:107], v[108:111], v[96:99]
    v_mfma_f32_16x16x32_bf16 v[100:103], v[108:111], v[112:115], v[100:103]
    v_mfma_f32_16x16x32_bf16 v[32:35], v[128:131], v[120:123], v[32:35]
    v_mfma_f32_16x16x32_bf16 v[36:39], v[128:131], v[132:135], v[36:39]
    v_mfma_f32_16x16x32_bf16 v[40:43], v[136:139], v[120:123], v[40:43]
    v_mfma_f32_16x16x32_bf16 v[44:47], v[136:139], v[132:135], v[44:47]
    v_mfma_f32_16x16x32_bf16 v[48:51], v[140:143], v[120:123], v[48:51]
    v_mfma_f32_16x16x32_bf16 v[52:55], v[140:143], v[132:135], v[52:55]
    v_mfma_f32_16x16x32_bf16 v[56:59], v[144:147], v[120:123], v[56:59]
    s_waitcnt lgkmcnt(0)
    s_barrier
    v_mfma_f32_16x16x32_bf16 v[60:63], v[144:147], v[132:135], v[60:63]
    ds_read_b128 v[104:107], v6 offset:55296
    v_mfma_f32_16x16x32_bf16 v[64:67], v[148:151], v[120:123], v[64:67]
    ds_read_b128 v[108:111], v9 offset:0
    v_mfma_f32_16x16x32_bf16 v[68:71], v[148:151], v[132:135], v[68:71]
    ds_read_b128 v[112:115], v10 offset:0
    v_mfma_f32_16x16x32_bf16 v[72:75], v[120:123], v[116:119], v[72:75]
    ds_read_b128 v[128:131], v4 offset:55296
    v_mfma_f32_16x16x32_bf16 v[76:79], v[132:135], v[116:119], v[76:79]
    ds_read_b128 v[136:139], v8 offset:0
    v_mfma_f32_16x16x32_bf16 v[80:83], v[120:123], v[124:127], v[80:83]
    ds_read_b128 v[140:143], v4 offset:56320
    v_mfma_f32_16x16x32_bf16 v[84:87], v[132:135], v[124:127], v[84:87]
    ds_read_b128 v[144:147], v8 offset:1024
    v_mfma_f32_16x16x32_bf16 v[88:91], v[120:123], v[152:155], v[88:91]
    ds_read_b128 v[148:151], v8 offset:2048
    v_mfma_f32_16x16x32_bf16 v[92:95], v[132:135], v[152:155], v[92:95]
    ds_read_b128 v[116:119], v8 offset:3072
    v_mfma_f32_16x16x32_bf16 v[96:99], v[156:159], v[160:163], v[96:99]
    ds_read_b128 v[124:127], v8 offset:4096
    v_mfma_f32_16x16x32_bf16 v[100:103], v[160:163], v[164:167], v[100:103]
    ds_read_b128 v[120:123], v8 offset:5120
    v_mfma_f32_16x16x32_bf16 v[32:35], v[180:183], v[172:175], v[32:35]
    ds_read_b128 v[132:135], v8 offset:6144
    v_mfma_f32_16x16x32_bf16 v[36:39], v[180:183], v[184:187], v[36:39]
    ds_read_b128 v[152:155], v8 offset:7168
    v_mfma_f32_16x16x32_bf16 v[40:43], v[188:191], v[172:175], v[40:43]
    ds_read_b128 v[176:179], v6 offset:64512
    v_mfma_f32_16x16x32_bf16 v[44:47], v[188:191], v[184:187], v[44:47]
    ds_read_b128 v[204:207], v9 offset:8192
    v_mfma_f32_16x16x32_bf16 v[48:51], v[192:195], v[172:175], v[48:51]
    ds_read_b128 v[156:159], v10 offset:8192
    v_mfma_f32_16x16x32_bf16 v[52:55], v[192:195], v[184:187], v[52:55]
    ds_read_b128 v[160:163], v4 offset:64512
    v_mfma_f32_16x16x32_bf16 v[56:59], v[216:219], v[172:175], v[56:59]
    ds_read_b128 v[164:167], v8 offset:8192
    v_mfma_f32_16x16x32_bf16 v[60:63], v[216:219], v[184:187], v[60:63]
    ds_read_b128 v[180:183], v5 offset:0
    v_mfma_f32_16x16x32_bf16 v[64:67], v[196:199], v[172:175], v[64:67]
    ds_read_b128 v[188:191], v8 offset:9216
    v_mfma_f32_16x16x32_bf16 v[68:71], v[196:199], v[184:187], v[68:71]
    ds_read_b128 v[192:195], v8 offset:10240
    v_mfma_f32_16x16x32_bf16 v[72:75], v[172:175], v[220:223], v[72:75]
    ds_read_b128 v[196:199], v8 offset:11264
    v_mfma_f32_16x16x32_bf16 v[76:79], v[184:187], v[220:223], v[76:79]
    ds_read_b128 v[224:227], v8 offset:12288
    v_mfma_f32_16x16x32_bf16 v[80:83], v[172:175], v[200:203], v[80:83]
    ds_read_b128 v[228:231], v8 offset:13312
    v_mfma_f32_16x16x32_bf16 v[84:87], v[184:187], v[200:203], v[84:87]
    ds_read_b128 v[200:203], v8 offset:14336
    v_mfma_f32_16x16x32_bf16 v[88:91], v[172:175], v[168:171], v[88:91]
    ds_read_b128 v[172:175], v8 offset:15360
    v_mfma_f32_16x16x32_bf16 v[92:95], v[184:187], v[168:171], v[92:95]
    s_waitcnt lgkmcnt(15)
    v_mfma_f32_16x16x32_bf16 v[96:99], v[108:111], v[104:107], v[96:99]
    v_mfma_f32_16x16x32_bf16 v[100:103], v[104:107], v[112:115], v[100:103]
    v_mfma_f32_16x16x32_bf16 v[32:35], v[136:139], v[128:131], v[32:35]
    v_mfma_f32_16x16x32_bf16 v[36:39], v[136:139], v[140:143], v[36:39]
    v_mfma_f32_16x16x32_bf16 v[40:43], v[144:147], v[128:131], v[40:43]
    v_mfma_f32_16x16x32_bf16 v[44:47], v[144:147], v[140:143], v[44:47]
    v_mfma_f32_16x16x32_bf16 v[48:51], v[148:151], v[128:131], v[48:51]
    v_mfma_f32_16x16x32_bf16 v[52:55], v[148:151], v[140:143], v[52:55]
    v_mfma_f32_16x16x32_bf16 v[56:59], v[116:119], v[128:131], v[56:59]
    s_waitcnt lgkmcnt(0)
    s_barrier
    v_mfma_f32_16x16x32_bf16 v[60:63], v[116:119], v[140:143], v[60:63]
    ds_read_b128 v[108:111], v6 offset:0
    v_mfma_f32_16x16x32_bf16 v[64:67], v[124:127], v[128:131], v[64:67]
    ds_read_b128 v[104:107], v9 offset:16384
    v_mfma_f32_16x16x32_bf16 v[68:71], v[124:127], v[140:143], v[68:71]
    ds_read_b128 v[112:115], v10 offset:16384
    v_mfma_f32_16x16x32_bf16 v[72:75], v[128:131], v[120:123], v[72:75]
    ds_read_b128 v[136:139], v4 offset:0
    v_mfma_f32_16x16x32_bf16 v[76:79], v[140:143], v[120:123], v[76:79]
    ds_read_b128 v[144:147], v8 offset:16384
    v_mfma_f32_16x16x32_bf16 v[80:83], v[128:131], v[132:135], v[80:83]
    ds_read_b128 v[148:151], v4 offset:1024
    v_mfma_f32_16x16x32_bf16 v[84:87], v[140:143], v[132:135], v[84:87]
    ds_read_b128 v[116:119], v8 offset:17408
    v_mfma_f32_16x16x32_bf16 v[88:91], v[128:131], v[152:155], v[88:91]
    ds_read_b128 v[124:127], v8 offset:18432
    v_mfma_f32_16x16x32_bf16 v[92:95], v[140:143], v[152:155], v[92:95]
    ds_read_b128 v[120:123], v8 offset:19456
    v_mfma_f32_16x16x32_bf16 v[96:99], v[204:207], v[176:179], v[96:99]
    ds_read_b128 v[132:135], v8 offset:20480
    v_mfma_f32_16x16x32_bf16 v[100:103], v[176:179], v[156:159], v[100:103]
    ds_read_b128 v[128:131], v8 offset:21504
    v_mfma_f32_16x16x32_bf16 v[32:35], v[164:167], v[160:163], v[32:35]
    ds_read_b128 v[140:143], v8 offset:22528
    v_mfma_f32_16x16x32_bf16 v[36:39], v[164:167], v[180:183], v[36:39]
    ds_read_b128 v[152:155], v8 offset:23552
    v_mfma_f32_16x16x32_bf16 v[40:43], v[188:191], v[160:163], v[40:43]
    ds_read_b128 v[184:187], v6 offset:9216
    v_mfma_f32_16x16x32_bf16 v[44:47], v[188:191], v[180:183], v[44:47]
    ds_read_b128 v[168:171], v9 offset:24576
    v_mfma_f32_16x16x32_bf16 v[48:51], v[192:195], v[160:163], v[48:51]
    ds_read_b128 v[204:207], v10 offset:24576
    v_mfma_f32_16x16x32_bf16 v[52:55], v[192:195], v[180:183], v[52:55]
    ds_read_b128 v[176:179], v4 offset:9216
    v_mfma_f32_16x16x32_bf16 v[56:59], v[196:199], v[160:163], v[56:59]
    ds_read_b128 v[156:159], v8 offset:24576
    v_mfma_f32_16x16x32_bf16 v[60:63], v[196:199], v[180:183], v[60:63]
    ds_read_b128 v[164:167], v4 offset:10240
    v_mfma_f32_16x16x32_bf16 v[64:67], v[224:227], v[160:163], v[64:67]
    ds_read_b128 v[188:191], v8 offset:25600
    v_mfma_f32_16x16x32_bf16 v[68:71], v[224:227], v[180:183], v[68:71]
    ds_read_b128 v[192:195], v8 offset:26624
    v_mfma_f32_16x16x32_bf16 v[72:75], v[160:163], v[228:231], v[72:75]
    ds_read_b128 v[196:199], v8 offset:27648
    v_mfma_f32_16x16x32_bf16 v[76:79], v[180:183], v[228:231], v[76:79]
    ds_read_b128 v[24:27], v8 offset:28672
    v_mfma_f32_16x16x32_bf16 v[80:83], v[160:163], v[200:203], v[80:83]
    ds_read_b128 v[28:31], v8 offset:29696
    v_mfma_f32_16x16x32_bf16 v[84:87], v[180:183], v[200:203], v[84:87]
    ds_read_b128 v[200:203], v8 offset:30720
    v_mfma_f32_16x16x32_bf16 v[88:91], v[160:163], v[172:175], v[88:91]
    ds_read_b128 v[160:163], v8 offset:31744
    v_mfma_f32_16x16x32_bf16 v[92:95], v[180:183], v[172:175], v[92:95]
    s_waitcnt lgkmcnt(15)
    v_mfma_f32_16x16x32_bf16 v[96:99], v[104:107], v[108:111], v[96:99]
    v_mfma_f32_16x16x32_bf16 v[100:103], v[108:111], v[112:115], v[100:103]
    v_mfma_f32_16x16x32_bf16 v[32:35], v[144:147], v[136:139], v[32:35]
    v_mfma_f32_16x16x32_bf16 v[36:39], v[144:147], v[148:151], v[36:39]
    v_mfma_f32_16x16x32_bf16 v[40:43], v[116:119], v[136:139], v[40:43]
    v_mfma_f32_16x16x32_bf16 v[44:47], v[116:119], v[148:151], v[44:47]
    v_mfma_f32_16x16x32_bf16 v[48:51], v[124:127], v[136:139], v[48:51]
    v_mfma_f32_16x16x32_bf16 v[52:55], v[124:127], v[148:151], v[52:55]
    v_mfma_f32_16x16x32_bf16 v[56:59], v[120:123], v[136:139], v[56:59]
    s_waitcnt lgkmcnt(0)
    s_barrier
    v_mfma_f32_16x16x32_bf16 v[60:63], v[120:123], v[148:151], v[60:63]
    ds_read_b128 v[104:107], v6 offset:18432
    v_mfma_f32_16x16x32_bf16 v[64:67], v[132:135], v[136:139], v[64:67]
    ds_read_b128 v[108:111], v9 offset:32768
    v_mfma_f32_16x16x32_bf16 v[68:71], v[132:135], v[148:151], v[68:71]
    ds_read_b128 v[112:115], v10 offset:32768
    v_mfma_f32_16x16x32_bf16 v[72:75], v[136:139], v[128:131], v[72:75]
    ds_read_b128 v[144:147], v4 offset:18432
    v_mfma_f32_16x16x32_bf16 v[76:79], v[148:151], v[128:131], v[76:79]
    ds_read_b128 v[116:119], v8 offset:32768
    v_mfma_f32_16x16x32_bf16 v[80:83], v[136:139], v[140:143], v[80:83]
    ds_read_b128 v[124:127], v4 offset:19456
    v_mfma_f32_16x16x32_bf16 v[84:87], v[148:151], v[140:143], v[84:87]
    ds_read_b128 v[120:123], v8 offset:33792
    v_mfma_f32_16x16x32_bf16 v[88:91], v[136:139], v[152:155], v[88:91]
    ds_read_b128 v[132:135], v8 offset:34816
    v_mfma_f32_16x16x32_bf16 v[92:95], v[148:151], v[152:155], v[92:95]
    ds_read_b128 v[128:131], v8 offset:35840
    v_mfma_f32_16x16x32_bf16 v[96:99], v[168:171], v[184:187], v[96:99]
    ds_read_b128 v[140:143], v8 offset:36864
    v_mfma_f32_16x16x32_bf16 v[100:103], v[184:187], v[204:207], v[100:103]
    ds_read_b128 v[136:139], v8 offset:37888
    v_mfma_f32_16x16x32_bf16 v[32:35], v[156:159], v[176:179], v[32:35]
    ds_read_b128 v[148:151], v8 offset:38912
    v_mfma_f32_16x16x32_bf16 v[36:39], v[156:159], v[164:167], v[36:39]
    ds_read_b128 v[152:155], v8 offset:39936
    v_mfma_f32_16x16x32_bf16 v[40:43], v[188:191], v[176:179], v[40:43]
    ds_read_b128 v[180:183], v6 offset:27648
    v_mfma_f32_16x16x32_bf16 v[44:47], v[188:191], v[164:167], v[44:47]
    ds_read_b128 v[172:175], v9 offset:40960
    v_mfma_f32_16x16x32_bf16 v[48:51], v[192:195], v[176:179], v[48:51]
    ds_read_b128 v[168:171], v10 offset:40960
    v_mfma_f32_16x16x32_bf16 v[52:55], v[192:195], v[164:167], v[52:55]
    ds_read_b128 v[184:187], v4 offset:27648
    v_mfma_f32_16x16x32_bf16 v[56:59], v[196:199], v[176:179], v[56:59]
    ds_read_b128 v[204:207], v8 offset:40960
    v_mfma_f32_16x16x32_bf16 v[60:63], v[196:199], v[164:167], v[60:63]
    ds_read_b128 v[156:159], v4 offset:28672
    v_mfma_f32_16x16x32_bf16 v[64:67], v[24:27], v[176:179], v[64:67]
    ds_read_b128 v[188:191], v8 offset:41984
    v_mfma_f32_16x16x32_bf16 v[68:71], v[24:27], v[164:167], v[68:71]
    ds_read_b128 v[192:195], v8 offset:43008
    v_mfma_f32_16x16x32_bf16 v[72:75], v[176:179], v[28:31], v[72:75]
    ds_read_b128 v[196:199], v8 offset:44032
    v_mfma_f32_16x16x32_bf16 v[76:79], v[164:167], v[28:31], v[76:79]
    ds_read_b128 v[216:219], v8 offset:45056
    v_mfma_f32_16x16x32_bf16 v[80:83], v[176:179], v[200:203], v[80:83]
    ds_read_b128 v[220:223], v8 offset:46080
    v_mfma_f32_16x16x32_bf16 v[84:87], v[164:167], v[200:203], v[84:87]
    ds_read_b128 v[200:203], v8 offset:47104
    v_mfma_f32_16x16x32_bf16 v[88:91], v[176:179], v[160:163], v[88:91]
    ds_read_b128 v[176:179], v8 offset:48128
    v_mfma_f32_16x16x32_bf16 v[92:95], v[164:167], v[160:163], v[92:95]
    s_waitcnt lgkmcnt(15)
    v_mfma_f32_16x16x32_bf16 v[96:99], v[108:111], v[104:107], v[96:99]
    v_mfma_f32_16x16x32_bf16 v[100:103], v[104:107], v[112:115], v[100:103]
    v_mfma_f32_16x16x32_bf16 v[32:35], v[116:119], v[144:147], v[32:35]
    v_mfma_f32_16x16x32_bf16 v[36:39], v[116:119], v[124:127], v[36:39]
    v_mfma_f32_16x16x32_bf16 v[40:43], v[120:123], v[144:147], v[40:43]
    v_mfma_f32_16x16x32_bf16 v[44:47], v[120:123], v[124:127], v[44:47]
    v_mfma_f32_16x16x32_bf16 v[48:51], v[132:135], v[144:147], v[48:51]
    v_mfma_f32_16x16x32_bf16 v[52:55], v[132:135], v[124:127], v[52:55]
    v_mfma_f32_16x16x32_bf16 v[56:59], v[128:131], v[144:147], v[56:59]
    s_waitcnt lgkmcnt(0)
    s_barrier
    v_mfma_f32_16x16x32_bf16 v[60:63], v[128:131], v[124:127], v[60:63]
    ds_read_b128 v[108:111], v6 offset:36864
    v_mfma_f32_16x16x32_bf16 v[64:67], v[140:143], v[144:147], v[64:67]
    ds_read_b128 v[104:107], v9 offset:49152
    v_mfma_f32_16x16x32_bf16 v[68:71], v[140:143], v[124:127], v[68:71]
    ds_read_b128 v[112:115], v10 offset:49152
    v_mfma_f32_16x16x32_bf16 v[72:75], v[144:147], v[136:139], v[72:75]
    ds_read_b128 v[116:119], v4 offset:36864
    v_mfma_f32_16x16x32_bf16 v[76:79], v[124:127], v[136:139], v[76:79]
    ds_read_b128 v[120:123], v8 offset:49152
    v_mfma_f32_16x16x32_bf16 v[80:83], v[144:147], v[148:151], v[80:83]
    ds_read_b128 v[132:135], v4 offset:37888
    v_mfma_f32_16x16x32_bf16 v[84:87], v[124:127], v[148:151], v[84:87]
    ds_read_b128 v[128:131], v8 offset:50176
    v_mfma_f32_16x16x32_bf16 v[88:91], v[144:147], v[152:155], v[88:91]
    ds_read_b128 v[140:143], v8 offset:51200
    v_mfma_f32_16x16x32_bf16 v[92:95], v[124:127], v[152:155], v[92:95]
    ds_read_b128 v[136:139], v8 offset:52224
    v_mfma_f32_16x16x32_bf16 v[96:99], v[172:175], v[180:183], v[96:99]
    ds_read_b128 v[148:151], v8 offset:53248
    v_mfma_f32_16x16x32_bf16 v[100:103], v[180:183], v[168:171], v[100:103]
    ds_read_b128 v[144:147], v8 offset:54272
    v_mfma_f32_16x16x32_bf16 v[32:35], v[204:207], v[184:187], v[32:35]
    ds_read_b128 v[124:127], v8 offset:55296
    v_mfma_f32_16x16x32_bf16 v[36:39], v[204:207], v[156:159], v[36:39]
    ds_read_b128 v[152:155], v8 offset:56320
    v_mfma_f32_16x16x32_bf16 v[40:43], v[188:191], v[184:187], v[40:43]
    ds_read_b128 v[164:167], v6 offset:46080
    v_mfma_f32_16x16x32_bf16 v[44:47], v[188:191], v[156:159], v[44:47]
    ds_read_b128 v[160:163], v9 offset:57344
    v_mfma_f32_16x16x32_bf16 v[48:51], v[192:195], v[184:187], v[48:51]
    ds_read_b128 v[172:175], v10 offset:57344
    v_mfma_f32_16x16x32_bf16 v[52:55], v[192:195], v[156:159], v[52:55]
    ds_read_b128 v[180:183], v4 offset:46080
    v_mfma_f32_16x16x32_bf16 v[56:59], v[196:199], v[184:187], v[56:59]
    ds_read_b128 v[168:171], v8 offset:57344
    v_mfma_f32_16x16x32_bf16 v[60:63], v[196:199], v[156:159], v[60:63]
    ds_read_b128 v[204:207], v4 offset:47104
    v_mfma_f32_16x16x32_bf16 v[64:67], v[216:219], v[184:187], v[64:67]
    ds_read_b128 v[188:191], v8 offset:58368
    v_mfma_f32_16x16x32_bf16 v[68:71], v[216:219], v[156:159], v[68:71]
    ds_read_b128 v[192:195], v8 offset:59392
    v_mfma_f32_16x16x32_bf16 v[72:75], v[184:187], v[220:223], v[72:75]
    ds_read_b128 v[196:199], v8 offset:60416
    v_mfma_f32_16x16x32_bf16 v[76:79], v[156:159], v[220:223], v[76:79]
    ds_read_b128 v[224:227], v8 offset:61440
    v_mfma_f32_16x16x32_bf16 v[80:83], v[184:187], v[200:203], v[80:83]
    ds_read_b128 v[228:231], v8 offset:62464
    v_mfma_f32_16x16x32_bf16 v[84:87], v[156:159], v[200:203], v[84:87]
    ds_read_b128 v[200:203], v8 offset:63488
    v_mfma_f32_16x16x32_bf16 v[88:91], v[184:187], v[176:179], v[88:91]
    ds_read_b128 v[184:187], v8 offset:64512
    v_mfma_f32_16x16x32_bf16 v[92:95], v[156:159], v[176:179], v[92:95]
    s_waitcnt lgkmcnt(15)
    v_mfma_f32_16x16x32_bf16 v[96:99], v[104:107], v[108:111], v[96:99]
    v_mfma_f32_16x16x32_bf16 v[100:103], v[108:111], v[112:115], v[100:103]
    v_mfma_f32_16x16x32_bf16 v[32:35], v[120:123], v[116:119], v[32:35]
    v_mfma_f32_16x16x32_bf16 v[36:39], v[120:123], v[132:135], v[36:39]
    v_mfma_f32_16x16x32_bf16 v[40:43], v[128:131], v[116:119], v[40:43]
    v_mfma_f32_16x16x32_bf16 v[44:47], v[128:131], v[132:135], v[44:47]
    v_mfma_f32_16x16x32_bf16 v[48:51], v[140:143], v[116:119], v[48:51]
    v_mfma_f32_16x16x32_bf16 v[52:55], v[140:143], v[132:135], v[52:55]
    v_mfma_f32_16x16x32_bf16 v[56:59], v[136:139], v[116:119], v[56:59]
    s_waitcnt lgkmcnt(0)
    s_barrier
    v_mfma_f32_16x16x32_bf16 v[60:63], v[136:139], v[132:135], v[60:63]
    ds_read_b128 v[104:107], v6 offset:55296
    v_mfma_f32_16x16x32_bf16 v[64:67], v[148:151], v[116:119], v[64:67]
    ds_read_b128 v[108:111], v9 offset:0
    v_mfma_f32_16x16x32_bf16 v[68:71], v[148:151], v[132:135], v[68:71]
    ds_read_b128 v[112:115], v10 offset:0
    v_mfma_f32_16x16x32_bf16 v[72:75], v[116:119], v[144:147], v[72:75]
    ds_read_b128 v[120:123], v4 offset:55296
    v_mfma_f32_16x16x32_bf16 v[76:79], v[132:135], v[144:147], v[76:79]
    ds_read_b128 v[128:131], v8 offset:0
    v_mfma_f32_16x16x32_bf16 v[80:83], v[116:119], v[124:127], v[80:83]
    ds_read_b128 v[140:143], v4 offset:56320
    v_mfma_f32_16x16x32_bf16 v[84:87], v[132:135], v[124:127], v[84:87]
    ds_read_b128 v[136:139], v8 offset:1024
    v_mfma_f32_16x16x32_bf16 v[88:91], v[116:119], v[152:155], v[88:91]
    ds_read_b128 v[148:151], v8 offset:2048
    v_mfma_f32_16x16x32_bf16 v[92:95], v[132:135], v[152:155], v[92:95]
    ds_read_b128 v[144:147], v8 offset:3072
    v_mfma_f32_16x16x32_bf16 v[96:99], v[160:163], v[164:167], v[96:99]
    ds_read_b128 v[124:127], v8 offset:4096
    v_mfma_f32_16x16x32_bf16 v[100:103], v[164:167], v[172:175], v[100:103]
    ds_read_b128 v[116:119], v8 offset:5120
    v_mfma_f32_16x16x32_bf16 v[32:35], v[168:171], v[180:183], v[32:35]
    ds_read_b128 v[132:135], v8 offset:6144
    v_mfma_f32_16x16x32_bf16 v[36:39], v[168:171], v[204:207], v[36:39]
    ds_read_b128 v[152:155], v8 offset:7168
    v_mfma_f32_16x16x32_bf16 v[40:43], v[188:191], v[180:183], v[40:43]
    ds_read_b128 v[156:159], v6 offset:64512
    v_mfma_f32_16x16x32_bf16 v[44:47], v[188:191], v[204:207], v[44:47]
    ds_read_b128 v[176:179], v9 offset:8192
    v_mfma_f32_16x16x32_bf16 v[48:51], v[192:195], v[180:183], v[48:51]
    ds_read_b128 v[160:163], v10 offset:8192
    v_mfma_f32_16x16x32_bf16 v[52:55], v[192:195], v[204:207], v[52:55]
    ds_read_b128 v[164:167], v4 offset:64512
    v_mfma_f32_16x16x32_bf16 v[56:59], v[196:199], v[180:183], v[56:59]
    ds_read_b128 v[172:175], v8 offset:8192
    v_mfma_f32_16x16x32_bf16 v[60:63], v[196:199], v[204:207], v[60:63]
    ds_read_b128 v[168:171], v5 offset:0
    v_mfma_f32_16x16x32_bf16 v[64:67], v[224:227], v[180:183], v[64:67]
    ds_read_b128 v[188:191], v8 offset:9216
    v_mfma_f32_16x16x32_bf16 v[68:71], v[224:227], v[204:207], v[68:71]
    ds_read_b128 v[192:195], v8 offset:10240
    v_mfma_f32_16x16x32_bf16 v[72:75], v[180:183], v[228:231], v[72:75]
    ds_read_b128 v[196:199], v8 offset:11264
    v_mfma_f32_16x16x32_bf16 v[76:79], v[204:207], v[228:231], v[76:79]
    ds_read_b128 v[24:27], v8 offset:12288
    v_mfma_f32_16x16x32_bf16 v[80:83], v[180:183], v[200:203], v[80:83]
    ds_read_b128 v[28:31], v8 offset:13312
    v_mfma_f32_16x16x32_bf16 v[84:87], v[204:207], v[200:203], v[84:87]
    ds_read_b128 v[200:203], v8 offset:14336
    v_mfma_f32_16x16x32_bf16 v[88:91], v[180:183], v[184:187], v[88:91]
    ds_read_b128 v[180:183], v8 offset:15360
    v_mfma_f32_16x16x32_bf16 v[92:95], v[204:207], v[184:187], v[92:95]
    s_waitcnt lgkmcnt(15)
    v_mfma_f32_16x16x32_bf16 v[96:99], v[108:111], v[104:107], v[96:99]
    v_mfma_f32_16x16x32_bf16 v[100:103], v[104:107], v[112:115], v[100:103]
    v_mfma_f32_16x16x32_bf16 v[32:35], v[128:131], v[120:123], v[32:35]
    v_mfma_f32_16x16x32_bf16 v[36:39], v[128:131], v[140:143], v[36:39]
    v_mfma_f32_16x16x32_bf16 v[40:43], v[136:139], v[120:123], v[40:43]
    v_mfma_f32_16x16x32_bf16 v[44:47], v[136:139], v[140:143], v[44:47]
    v_mfma_f32_16x16x32_bf16 v[48:51], v[148:151], v[120:123], v[48:51]
    v_mfma_f32_16x16x32_bf16 v[52:55], v[148:151], v[140:143], v[52:55]
    v_mfma_f32_16x16x32_bf16 v[56:59], v[144:147], v[120:123], v[56:59]
    s_waitcnt lgkmcnt(0)
    s_barrier
    v_mfma_f32_16x16x32_bf16 v[60:63], v[144:147], v[140:143], v[60:63]
    ds_read_b128 v[108:111], v6 offset:0
    v_mfma_f32_16x16x32_bf16 v[64:67], v[124:127], v[120:123], v[64:67]
    ds_read_b128 v[104:107], v9 offset:16384
    v_mfma_f32_16x16x32_bf16 v[68:71], v[124:127], v[140:143], v[68:71]
    ds_read_b128 v[112:115], v10 offset:16384
    v_mfma_f32_16x16x32_bf16 v[72:75], v[120:123], v[116:119], v[72:75]
    ds_read_b128 v[128:131], v4 offset:0
    v_mfma_f32_16x16x32_bf16 v[76:79], v[140:143], v[116:119], v[76:79]
    ds_read_b128 v[136:139], v8 offset:16384
    v_mfma_f32_16x16x32_bf16 v[80:83], v[120:123], v[132:135], v[80:83]
    ds_read_b128 v[148:151], v4 offset:1024
    v_mfma_f32_16x16x32_bf16 v[84:87], v[140:143], v[132:135], v[84:87]
    ds_read_b128 v[144:147], v8 offset:17408
    v_mfma_f32_16x16x32_bf16 v[88:91], v[120:123], v[152:155], v[88:91]
    ds_read_b128 v[124:127], v8 offset:18432
    v_mfma_f32_16x16x32_bf16 v[92:95], v[140:143], v[152:155], v[92:95]
    ds_read_b128 v[116:119], v8 offset:19456
    v_mfma_f32_16x16x32_bf16 v[96:99], v[176:179], v[156:159], v[96:99]
    ds_read_b128 v[132:135], v8 offset:20480
    v_mfma_f32_16x16x32_bf16 v[100:103], v[156:159], v[160:163], v[100:103]
    ds_read_b128 v[120:123], v8 offset:21504
    v_mfma_f32_16x16x32_bf16 v[32:35], v[172:175], v[164:167], v[32:35]
    ds_read_b128 v[140:143], v8 offset:22528
    v_mfma_f32_16x16x32_bf16 v[36:39], v[172:175], v[168:171], v[36:39]
    ds_read_b128 v[152:155], v8 offset:23552
    v_mfma_f32_16x16x32_bf16 v[40:43], v[188:191], v[164:167], v[40:43]
    ds_read_b128 v[204:207], v6 offset:9216
    v_mfma_f32_16x16x32_bf16 v[44:47], v[188:191], v[168:171], v[44:47]
    ds_read_b128 v[184:187], v9 offset:24576
    v_mfma_f32_16x16x32_bf16 v[48:51], v[192:195], v[164:167], v[48:51]
    ds_read_b128 v[176:179], v10 offset:24576
    v_mfma_f32_16x16x32_bf16 v[52:55], v[192:195], v[168:171], v[52:55]
    ds_read_b128 v[156:159], v4 offset:9216
    v_mfma_f32_16x16x32_bf16 v[56:59], v[196:199], v[164:167], v[56:59]
    ds_read_b128 v[160:163], v8 offset:24576
    v_mfma_f32_16x16x32_bf16 v[60:63], v[196:199], v[168:171], v[60:63]
    ds_read_b128 v[172:175], v4 offset:10240
    v_mfma_f32_16x16x32_bf16 v[64:67], v[24:27], v[164:167], v[64:67]
    ds_read_b128 v[188:191], v8 offset:25600
    v_mfma_f32_16x16x32_bf16 v[68:71], v[24:27], v[168:171], v[68:71]
    ds_read_b128 v[192:195], v8 offset:26624
    v_mfma_f32_16x16x32_bf16 v[72:75], v[164:167], v[28:31], v[72:75]
    ds_read_b128 v[196:199], v8 offset:27648
    v_mfma_f32_16x16x32_bf16 v[76:79], v[168:171], v[28:31], v[76:79]
    ds_read_b128 v[216:219], v8 offset:28672
    v_mfma_f32_16x16x32_bf16 v[80:83], v[164:167], v[200:203], v[80:83]
    ds_read_b128 v[220:223], v8 offset:29696
    v_mfma_f32_16x16x32_bf16 v[84:87], v[168:171], v[200:203], v[84:87]
    ds_read_b128 v[200:203], v8 offset:30720
    v_mfma_f32_16x16x32_bf16 v[88:91], v[164:167], v[180:183], v[88:91]
    ds_read_b128 v[164:167], v8 offset:31744
    v_mfma_f32_16x16x32_bf16 v[92:95], v[168:171], v[180:183], v[92:95]
    s_waitcnt lgkmcnt(15)
    v_mfma_f32_16x16x32_bf16 v[96:99], v[104:107], v[108:111], v[96:99]
    v_mfma_f32_16x16x32_bf16 v[100:103], v[108:111], v[112:115], v[100:103]
    v_mfma_f32_16x16x32_bf16 v[32:35], v[136:139], v[128:131], v[32:35]
    v_mfma_f32_16x16x32_bf16 v[36:39], v[136:139], v[148:151], v[36:39]
    v_mfma_f32_16x16x32_bf16 v[40:43], v[144:147], v[128:131], v[40:43]
    v_mfma_f32_16x16x32_bf16 v[44:47], v[144:147], v[148:151], v[44:47]
    v_mfma_f32_16x16x32_bf16 v[48:51], v[124:127], v[128:131], v[48:51]
    v_mfma_f32_16x16x32_bf16 v[52:55], v[124:127], v[148:151], v[52:55]
    v_mfma_f32_16x16x32_bf16 v[56:59], v[116:119], v[128:131], v[56:59]
    s_waitcnt lgkmcnt(0)
    s_barrier
    v_mfma_f32_16x16x32_bf16 v[60:63], v[116:119], v[148:151], v[60:63]
    ds_read2st64_b64 v[104:107], v252 offset0:36 offset1:37
    v_mfma_f32_16x16x32_bf16 v[64:67], v[132:135], v[128:131], v[64:67]
    ds_read_b128 v[108:111], v9 offset:32768
    v_mfma_f32_16x16x32_bf16 v[68:71], v[132:135], v[148:151], v[68:71]
    ds_read_b128 v[112:115], v10 offset:32768
    v_mfma_f32_16x16x32_bf16 v[72:75], v[128:131], v[120:123], v[72:75]
    ds_read2st64_b64 v[136:139], v11 offset0:36 offset1:37
    v_mfma_f32_16x16x32_bf16 v[76:79], v[148:151], v[120:123], v[76:79]
    ds_read_b128 v[144:147], v8 offset:32768
    v_mfma_f32_16x16x32_bf16 v[80:83], v[128:131], v[140:143], v[80:83]
    ds_read2st64_b64 v[124:127], v11 offset0:38 offset1:39
    v_mfma_f32_16x16x32_bf16 v[84:87], v[148:151], v[140:143], v[84:87]
    ds_read_b128 v[116:119], v8 offset:33792
    v_mfma_f32_16x16x32_bf16 v[88:91], v[128:131], v[152:155], v[88:91]
    ds_read_b128 v[132:135], v8 offset:34816
    v_mfma_f32_16x16x32_bf16 v[92:95], v[148:151], v[152:155], v[92:95]
    ds_read_b128 v[120:123], v8 offset:35840
    v_mfma_f32_16x16x32_bf16 v[96:99], v[184:187], v[204:207], v[96:99]
    ds_read_b128 v[140:143], v8 offset:36864
    v_mfma_f32_16x16x32_bf16 v[100:103], v[204:207], v[176:179], v[100:103]
    ds_read_b128 v[128:131], v8 offset:37888
    v_mfma_f32_16x16x32_bf16 v[32:35], v[160:163], v[156:159], v[32:35]
    ds_read_b128 v[148:151], v8 offset:38912
    v_mfma_f32_16x16x32_bf16 v[36:39], v[160:163], v[172:175], v[36:39]
    ds_read_b128 v[152:155], v8 offset:39936
    v_mfma_f32_16x16x32_bf16 v[40:43], v[188:191], v[156:159], v[40:43]
    ds_read2st64_b64 v[168:171], v252 offset0:54 offset1:55
    v_mfma_f32_16x16x32_bf16 v[44:47], v[188:191], v[172:175], v[44:47]
    ds_read_b128 v[180:183], v9 offset:40960
    v_mfma_f32_16x16x32_bf16 v[48:51], v[192:195], v[156:159], v[48:51]
    ds_read_b128 v[184:187], v10 offset:40960
    v_mfma_f32_16x16x32_bf16 v[52:55], v[192:195], v[172:175], v[52:55]
    ds_read2st64_b64 v[204:207], v11 offset0:54 offset1:55
    v_mfma_f32_16x16x32_bf16 v[56:59], v[196:199], v[156:159], v[56:59]
    ds_read_b128 v[176:179], v8 offset:40960
    v_mfma_f32_16x16x32_bf16 v[60:63], v[196:199], v[172:175], v[60:63]
    ds_read2st64_b64 v[160:163], v11 offset0:56 offset1:57
    v_mfma_f32_16x16x32_bf16 v[64:67], v[216:219], v[156:159], v[64:67]
    ds_read_b128 v[188:191], v8 offset:41984
    v_mfma_f32_16x16x32_bf16 v[68:71], v[216:219], v[172:175], v[68:71]
    ds_read_b128 v[192:195], v8 offset:43008
    v_mfma_f32_16x16x32_bf16 v[72:75], v[156:159], v[220:223], v[72:75]
    ds_read_b128 v[196:199], v8 offset:44032
    v_mfma_f32_16x16x32_bf16 v[76:79], v[172:175], v[220:223], v[76:79]
    ds_read_b128 v[224:227], v8 offset:45056
    v_mfma_f32_16x16x32_bf16 v[80:83], v[156:159], v[200:203], v[80:83]
    ds_read_b128 v[228:231], v8 offset:46080
    v_mfma_f32_16x16x32_bf16 v[84:87], v[172:175], v[200:203], v[84:87]
    ds_read_b128 v[200:203], v8 offset:47104
    v_mfma_f32_16x16x32_bf16 v[88:91], v[156:159], v[164:167], v[88:91]
    ds_read_b128 v[156:159], v8 offset:48128
    v_mfma_f32_16x16x32_bf16 v[92:95], v[172:175], v[164:167], v[92:95]
    s_waitcnt lgkmcnt(15)
    v_mfma_f32_16x16x32_bf16 v[96:99], v[108:111], v[104:107], v[96:99]
    v_mfma_f32_16x16x32_bf16 v[100:103], v[104:107], v[112:115], v[100:103]
    v_mfma_f32_16x16x32_bf16 v[32:35], v[144:147], v[136:139], v[32:35]
    v_mfma_f32_16x16x32_bf16 v[36:39], v[144:147], v[124:127], v[36:39]
    v_mfma_f32_16x16x32_bf16 v[40:43], v[116:119], v[136:139], v[40:43]
    v_mfma_f32_16x16x32_bf16 v[44:47], v[116:119], v[124:127], v[44:47]
    v_mfma_f32_16x16x32_bf16 v[48:51], v[132:135], v[136:139], v[48:51]
    v_mfma_f32_16x16x32_bf16 v[52:55], v[132:135], v[124:127], v[52:55]
    v_mfma_f32_16x16x32_bf16 v[56:59], v[120:123], v[136:139], v[56:59]
    s_waitcnt lgkmcnt(0)
    s_barrier
    v_mfma_f32_16x16x32_bf16 v[60:63], v[120:123], v[124:127], v[60:63]
    ds_read2st64_b64 v[108:111], v252 offset0:72 offset1:73
    v_mfma_f32_16x16x32_bf16 v[64:67], v[140:143], v[136:139], v[64:67]
    ds_read_b128 v[104:107], v9 offset:49152
    v_mfma_f32_16x16x32_bf16 v[68:71], v[140:143], v[124:127], v[68:71]
    ds_read_b128 v[112:115], v10 offset:49152
    v_mfma_f32_16x16x32_bf16 v[72:75], v[136:139], v[128:131], v[72:75]
    ds_read2st64_b64 v[144:147], v11 offset0:72 offset1:73
    v_mfma_f32_16x16x32_bf16 v[76:79], v[124:127], v[128:131], v[76:79]
    ds_read_b128 v[116:119], v8 offset:49152
    v_mfma_f32_16x16x32_bf16 v[80:83], v[136:139], v[148:151], v[80:83]
    ds_read2st64_b64 v[132:135], v11 offset0:74 offset1:75
    v_mfma_f32_16x16x32_bf16 v[84:87], v[124:127], v[148:151], v[84:87]
    ds_read_b128 v[120:123], v8 offset:50176
    v_mfma_f32_16x16x32_bf16 v[88:91], v[136:139], v[152:155], v[88:91]
    ds_read_b128 v[140:143], v8 offset:51200
    v_mfma_f32_16x16x32_bf16 v[92:95], v[124:127], v[152:155], v[92:95]
    ds_read_b128 v[128:131], v8 offset:52224
    v_mfma_f32_16x16x32_bf16 v[96:99], v[180:183], v[168:171], v[96:99]
    ds_read_b128 v[148:151], v8 offset:53248
    v_mfma_f32_16x16x32_bf16 v[100:103], v[168:171], v[184:187], v[100:103]
    ds_read_b128 v[136:139], v8 offset:54272
    v_mfma_f32_16x16x32_bf16 v[32:35], v[176:179], v[204:207], v[32:35]
    ds_read_b128 v[124:127], v8 offset:55296
    v_mfma_f32_16x16x32_bf16 v[36:39], v[176:179], v[160:163], v[36:39]
    ds_read_b128 v[152:155], v8 offset:56320
    v_mfma_f32_16x16x32_bf16 v[40:43], v[188:191], v[204:207], v[40:43]
    ds_read2st64_b64 v[172:175], v252 offset0:90 offset1:91
    v_mfma_f32_16x16x32_bf16 v[44:47], v[188:191], v[160:163], v[44:47]
    ds_read_b128 v[164:167], v9 offset:57344
    v_mfma_f32_16x16x32_bf16 v[48:51], v[192:195], v[204:207], v[48:51]
    ds_read_b128 v[180:183], v10 offset:57344
    v_mfma_f32_16x16x32_bf16 v[52:55], v[192:195], v[160:163], v[52:55]
    ds_read2st64_b64 v[168:171], v11 offset0:92 offset1:93
    v_mfma_f32_16x16x32_bf16 v[56:59], v[196:199], v[204:207], v[56:59]
    ds_read_b128 v[184:187], v8 offset:57344
    v_mfma_f32_16x16x32_bf16 v[60:63], v[196:199], v[160:163], v[60:63]
    ds_read_b128 v[176:179], v8 offset:58368
    v_mfma_f32_16x16x32_bf16 v[64:67], v[224:227], v[204:207], v[64:67]
    ds_read_b128 v[188:191], v8 offset:59392
    v_mfma_f32_16x16x32_bf16 v[68:71], v[224:227], v[160:163], v[68:71]
    ds_read_b128 v[192:195], v8 offset:60416
    v_mfma_f32_16x16x32_bf16 v[72:75], v[204:207], v[228:231], v[72:75]
    ds_read_b128 v[196:199], v8 offset:61440
    v_mfma_f32_16x16x32_bf16 v[76:79], v[160:163], v[228:231], v[76:79]
    ds_read_b128 v[24:27], v8 offset:62464
    v_mfma_f32_16x16x32_bf16 v[80:83], v[204:207], v[200:203], v[80:83]
    ds_read_b128 v[28:31], v8 offset:63488
    v_mfma_f32_16x16x32_bf16 v[84:87], v[160:163], v[200:203], v[84:87]
    ds_read_b128 v[200:203], v8 offset:64512
    v_mfma_f32_16x16x32_bf16 v[88:91], v[204:207], v[156:159], v[88:91]
    ds_read2st64_b64 v[204:207], v11 offset0:90 offset1:91
    v_mfma_f32_16x16x32_bf16 v[92:95], v[160:163], v[156:159], v[92:95]
    ds_read_b128 v[208:211], v15 offset:1536
    s_waitcnt lgkmcnt(15)
    v_mfma_f32_16x16x32_bf16 v[96:99], v[104:107], v[108:111], v[96:99]
    ds_read_b32 v215, v12 offset:1536
    v_mfma_f32_16x16x32_bf16 v[100:103], v[108:111], v[112:115], v[100:103]
    ds_read2_b32 v[108:109], v18 offset0:0 offset1:192
    v_mfma_f32_16x16x32_bf16 v[32:35], v[116:119], v[144:147], v[32:35]
    ds_read2_b32 v[106:107], v13 offset0:32 offset1:224
    v_mfma_f32_16x16x32_bf16 v[36:39], v[116:119], v[132:135], v[36:39]
    ds_read_b128 v[116:119], v14 offset:128
    v_mfma_f32_16x16x32_bf16 v[40:43], v[120:123], v[144:147], v[40:43]
    ds_read_b32 v212, v18 offset:1856
    v_mfma_f32_16x16x32_bf16 v[44:47], v[120:123], v[132:135], v[44:47]
    ds_read_b128 v[120:123], v23 offset:0
    v_mfma_f32_16x16x32_bf16 v[48:51], v[140:143], v[144:147], v[48:51]
    ds_read_b32 v213, v18 offset:1920
    v_mfma_f32_16x16x32_bf16 v[52:55], v[140:143], v[132:135], v[52:55]
    ds_read_b128 v[140:143], v23 offset:1600
    v_mfma_f32_16x16x32_bf16 v[56:59], v[128:131], v[144:147], v[56:59]
    ds_read_b32 v214, v18 offset:1984
    v_mfma_f32_16x16x32_bf16 v[60:63], v[128:131], v[132:135], v[60:63]
    ds_read_b128 v[128:131], v14 offset:896
    v_mfma_f32_16x16x32_bf16 v[64:67], v[148:151], v[144:147], v[64:67]
    ds_read2_b32 v[104:105], v13 offset0:16 offset1:208
    v_mfma_f32_16x16x32_bf16 v[68:71], v[148:151], v[132:135], v[68:71]
    ds_read_b128 v[148:151], v23 offset:1728
    v_mfma_f32_16x16x32_bf16 v[72:75], v[144:147], v[136:139], v[72:75]
    ds_read_b128 v[112:115], v14 offset:64
    v_mfma_f32_16x16x32_bf16 v[76:79], v[132:135], v[136:139], v[76:79]
    ds_read_b128 v[136:139], v23 offset:1536
    v_mfma_f32_16x16x32_bf16 v[80:83], v[144:147], v[124:127], v[80:83]
    v_mfma_f32_16x16x32_bf16 v[84:87], v[132:135], v[124:127], v[84:87]
    ds_read_b128 v[124:127], v14 offset:832
    s_waitcnt lgkmcnt(15)
    v_mfma_f32_16x16x32_bf16 v[88:91], v[144:147], v[152:155], v[88:91]
    ds_read_b128 v[144:147], v23 offset:1664
    v_mfma_f32_16x16x32_bf16 v[92:95], v[132:135], v[152:155], v[92:95]
    ds_read_b128 v[132:135], v23 offset:768
    ds_read_b128 v[152:155], v23 offset:1792
    v_mfma_f32_16x16x32_bf16 v[96:99], v[164:167], v[172:175], v[96:99]
    v_mfma_f32_16x16x32_bf16 v[100:103], v[172:175], v[180:183], v[100:103]
    v_mfma_f32_16x16x32_bf16 v[36:39], v[184:187], v[168:171], v[36:39]
    v_mfma_f32_16x16x32_bf16 v[44:47], v[176:179], v[168:171], v[44:47]
    v_mfma_f32_16x16x32_bf16 v[52:55], v[188:191], v[168:171], v[52:55]
    v_mfma_f32_16x16x32_bf16 v[60:63], v[192:195], v[168:171], v[60:63]
    v_mfma_f32_16x16x32_bf16 v[68:71], v[196:199], v[168:171], v[68:71]
    v_mfma_f32_16x16x32_bf16 v[76:79], v[168:171], v[24:27], v[76:79]
    v_mfma_f32_16x16x32_bf16 v[84:87], v[168:171], v[28:31], v[84:87]
    v_mfma_f32_16x16x32_bf16 v[92:95], v[168:171], v[200:203], v[92:95]
    v_mfma_f32_16x16x32_bf16 v[32:35], v[184:187], v[204:207], v[32:35]
    v_mfma_f32_16x16x32_bf16 v[40:43], v[176:179], v[204:207], v[40:43]
    v_mfma_f32_16x16x32_bf16 v[48:51], v[188:191], v[204:207], v[48:51]
    v_mfma_f32_16x16x32_bf16 v[56:59], v[192:195], v[204:207], v[56:59]
    v_mfma_f32_16x16x32_bf16 v[64:67], v[196:199], v[204:207], v[64:67]
    v_mfma_f32_16x16x32_bf16 v[72:75], v[204:207], v[24:27], v[72:75]
    v_mfma_f32_16x16x32_bf16 v[80:83], v[204:207], v[28:31], v[80:83]
    v_mfma_f32_16x16x32_bf16 v[88:91], v[204:207], v[200:203], v[88:91]
    s_barrier
    s_waitcnt lgkmcnt(0)
    v_pk_mul_f32 v[196:197], v[208:209], v[108:109] op_sel:[0,1] op_sel_hi:[1,1]
    v_pk_mul_f32 v[198:199], v[210:211], v[108:109] op_sel:[0,1] op_sel_hi:[1,1]
    v_pk_fma_f32 v[96:97], v[96:97], v[108:109], v[196:197] op_sel:[0,0,0] op_sel_hi:[1,0,1]
    v_pk_fma_f32 v[98:99], v[98:99], v[108:109], v[198:199] op_sel:[0,0,0] op_sel_hi:[1,0,1]
    v_pk_mul_f32 v[24:25], v[132:133], v[214:215] op_sel:[0,1] op_sel_hi:[1,1]
    v_pk_mul_f32 v[26:27], v[134:135], v[214:215] op_sel:[0,1] op_sel_hi:[1,1]
    v_pk_fma_f32 v[100:101], v[100:101], v[120:121], v[24:25]
    v_pk_fma_f32 v[102:103], v[102:103], v[122:123], v[26:27]
    v_cvt_pk_bf16_f32 v200, v96, v97
    v_cvt_pk_bf16_f32 v201, v98, v99
    v_cvt_pk_bf16_f32 v202, v100, v101
    v_cvt_pk_bf16_f32 v203, v102, v103
    ds_write_b64 v20, v[200:201] offset:4096
    ds_write_b64 v20, v[202:203] offset:5632
    v_pk_mul_f32 v[196:197], v[140:141], v[106:107] op_sel:[0,1] op_sel_hi:[1,1]
    v_pk_mul_f32 v[198:199], v[142:143], v[106:107] op_sel:[0,1] op_sel_hi:[1,1]
    v_pk_fma_f32 v[44:45], v[44:45], v[106:107], v[196:197] op_sel:[0,0,0] op_sel_hi:[1,0,1]
    v_pk_fma_f32 v[46:47], v[46:47], v[106:107], v[198:199] op_sel:[0,0,0] op_sel_hi:[1,0,1]
    v_pk_mul_f32 v[24:25], v[148:149], v[106:107] op_sel:[0,1] op_sel_hi:[1,1]
    v_pk_mul_f32 v[26:27], v[150:151], v[106:107] op_sel:[0,1] op_sel_hi:[1,1]
    v_pk_fma_f32 v[60:61], v[60:61], v[106:107], v[24:25] op_sel:[0,0,0] op_sel_hi:[1,0,1]
    v_pk_fma_f32 v[62:63], v[62:63], v[106:107], v[26:27] op_sel:[0,0,0] op_sel_hi:[1,0,1]
    v_pk_mul_f32 v[196:197], v[152:153], v[106:107] op_sel:[0,1] op_sel_hi:[1,1]
    v_pk_mul_f32 v[198:199], v[154:155], v[106:107] op_sel:[0,1] op_sel_hi:[1,1]
    v_pk_fma_f32 v[68:69], v[68:69], v[106:107], v[196:197] op_sel:[0,0,0] op_sel_hi:[1,0,1]
    v_pk_fma_f32 v[70:71], v[70:71], v[106:107], v[198:199] op_sel:[0,0,0] op_sel_hi:[1,0,1]
    v_pk_mul_f32 v[24:25], v[128:129], v[212:213] op_sel:[0,0] op_sel_hi:[1,0]
    v_pk_mul_f32 v[26:27], v[130:131], v[212:213] op_sel:[0,0] op_sel_hi:[1,0]
    v_pk_fma_f32 v[76:77], v[76:77], v[116:117], v[24:25]
    v_pk_fma_f32 v[78:79], v[78:79], v[118:119], v[26:27]
    v_pk_mul_f32 v[196:197], v[128:129], v[212:213] op_sel:[0,1] op_sel_hi:[1,1]
    v_pk_mul_f32 v[198:199], v[130:131], v[212:213] op_sel:[0,1] op_sel_hi:[1,1]
    v_pk_fma_f32 v[84:85], v[84:85], v[116:117], v[196:197]
    v_pk_fma_f32 v[86:87], v[86:87], v[118:119], v[198:199]
    v_pk_mul_f32 v[24:25], v[128:129], v[214:215] op_sel:[0,0] op_sel_hi:[1,0]
    v_pk_mul_f32 v[26:27], v[130:131], v[214:215] op_sel:[0,0] op_sel_hi:[1,0]
    v_pk_fma_f32 v[92:93], v[92:93], v[116:117], v[24:25]
    v_pk_fma_f32 v[94:95], v[94:95], v[118:119], v[26:27]
    v_cvt_pk_bf16_f32 v180, v44, v45
    v_cvt_pk_bf16_f32 v181, v46, v47
    v_cvt_pk_bf16_f32 v184, v60, v61
    v_cvt_pk_bf16_f32 v185, v62, v63
    v_cvt_pk_bf16_f32 v206, v68, v69
    v_cvt_pk_bf16_f32 v207, v70, v71
    v_cvt_pk_bf16_f32 v220, v76, v77
    v_cvt_pk_bf16_f32 v221, v78, v79
    v_cvt_pk_bf16_f32 v226, v84, v85
    v_cvt_pk_bf16_f32 v227, v86, v87
    v_cvt_pk_bf16_f32 v232, v92, v93
    v_cvt_pk_bf16_f32 v233, v94, v95
    ds_write_b64 v21, v[180:181] offset:7168
    ds_write_b64 v21, v[184:185] offset:7680
    ds_write_b64 v21, v[206:207] offset:8192
    ds_write_b64 v21, v[220:221] offset:8704
    ds_write_b64 v21, v[226:227] offset:9216
    ds_write_b64 v21, v[232:233] offset:9728
    v_pk_mul_f32 v[196:197], v[140:141], v[104:105] op_sel:[0,1] op_sel_hi:[1,1]
    v_pk_mul_f32 v[198:199], v[142:143], v[104:105] op_sel:[0,1] op_sel_hi:[1,1]
    v_pk_fma_f32 v[40:41], v[40:41], v[104:105], v[196:197] op_sel:[0,0,0] op_sel_hi:[1,0,1]
    v_pk_fma_f32 v[42:43], v[42:43], v[104:105], v[198:199] op_sel:[0,0,0] op_sel_hi:[1,0,1]
    v_pk_mul_f32 v[24:25], v[148:149], v[104:105] op_sel:[0,1] op_sel_hi:[1,1]
    v_pk_mul_f32 v[26:27], v[150:151], v[104:105] op_sel:[0,1] op_sel_hi:[1,1]
    v_pk_fma_f32 v[56:57], v[56:57], v[104:105], v[24:25] op_sel:[0,0,0] op_sel_hi:[1,0,1]
    v_pk_fma_f32 v[58:59], v[58:59], v[104:105], v[26:27] op_sel:[0,0,0] op_sel_hi:[1,0,1]
    v_pk_mul_f32 v[196:197], v[152:153], v[104:105] op_sel:[0,1] op_sel_hi:[1,1]
    v_pk_mul_f32 v[198:199], v[154:155], v[104:105] op_sel:[0,1] op_sel_hi:[1,1]
    v_pk_fma_f32 v[64:65], v[64:65], v[104:105], v[196:197] op_sel:[0,0,0] op_sel_hi:[1,0,1]
    v_pk_fma_f32 v[66:67], v[66:67], v[104:105], v[198:199] op_sel:[0,0,0] op_sel_hi:[1,0,1]
    v_pk_mul_f32 v[24:25], v[124:125], v[212:213] op_sel:[0,0] op_sel_hi:[1,0]
    v_pk_mul_f32 v[26:27], v[126:127], v[212:213] op_sel:[0,0] op_sel_hi:[1,0]
    v_pk_fma_f32 v[72:73], v[72:73], v[112:113], v[24:25]
    v_pk_fma_f32 v[74:75], v[74:75], v[114:115], v[26:27]
    v_pk_mul_f32 v[196:197], v[124:125], v[212:213] op_sel:[0,1] op_sel_hi:[1,1]
    v_pk_mul_f32 v[198:199], v[126:127], v[212:213] op_sel:[0,1] op_sel_hi:[1,1]
    v_pk_fma_f32 v[80:81], v[80:81], v[112:113], v[196:197]
    v_pk_fma_f32 v[82:83], v[82:83], v[114:115], v[198:199]
    v_pk_mul_f32 v[24:25], v[124:125], v[214:215] op_sel:[0,0] op_sel_hi:[1,0]
    v_pk_mul_f32 v[26:27], v[126:127], v[214:215] op_sel:[0,0] op_sel_hi:[1,0]
    v_pk_fma_f32 v[88:89], v[88:89], v[112:113], v[24:25]
    v_pk_fma_f32 v[90:91], v[90:91], v[114:115], v[26:27]
    v_cvt_pk_bf16_f32 v172, v40, v41
    v_cvt_pk_bf16_f32 v173, v42, v43
    v_cvt_pk_bf16_f32 v176, v56, v57
    v_cvt_pk_bf16_f32 v177, v58, v59
    v_cvt_pk_bf16_f32 v204, v64, v65
    v_cvt_pk_bf16_f32 v205, v66, v67
    v_cvt_pk_bf16_f32 v218, v72, v73
    v_cvt_pk_bf16_f32 v219, v74, v75
    v_cvt_pk_bf16_f32 v224, v80, v81
    v_cvt_pk_bf16_f32 v225, v82, v83
    v_cvt_pk_bf16_f32 v230, v88, v89
    v_cvt_pk_bf16_f32 v231, v90, v91
    s_waitcnt lgkmcnt(0)
    s_barrier
    ds_read_b64 v[188:189], v21 offset:4096
    ds_read_b64 v[192:193], v21 offset:4608
    ds_read_b64 v[190:191], v22 offset:5120
    ds_read_b64 v[194:195], v22 offset:5120
    ds_read_b64 v[216:217], v21 offset:5632
    ds_read_b64 v[222:223], v21 offset:6144
    ds_read_b64 v[228:229], v21 offset:6656
    v_pk_mul_f32 v[196:197], v[136:137], v[106:107] op_sel:[0,1] op_sel_hi:[1,1]
    v_pk_mul_f32 v[198:199], v[138:139], v[106:107] op_sel:[0,1] op_sel_hi:[1,1]
    v_pk_fma_f32 v[36:37], v[36:37], v[106:107], v[196:197] op_sel:[0,0,0] op_sel_hi:[1,0,1]
    v_pk_fma_f32 v[38:39], v[38:39], v[106:107], v[198:199] op_sel:[0,0,0] op_sel_hi:[1,0,1]
    v_pk_mul_f32 v[24:25], v[144:145], v[106:107] op_sel:[0,1] op_sel_hi:[1,1]
    v_pk_mul_f32 v[26:27], v[146:147], v[106:107] op_sel:[0,1] op_sel_hi:[1,1]
    v_pk_fma_f32 v[52:53], v[52:53], v[106:107], v[24:25] op_sel:[0,0,0] op_sel_hi:[1,0,1]
    v_pk_fma_f32 v[54:55], v[54:55], v[106:107], v[26:27] op_sel:[0,0,0] op_sel_hi:[1,0,1]
    v_mov_b32 v182, v206
    v_mov_b32 v186, v206
    v_mov_b32 v183, v207
    v_mov_b32 v187, v207
    v_cvt_pk_bf16_f32 v164, v36, v37
    v_cvt_pk_bf16_f32 v165, v38, v39
    v_cvt_pk_bf16_f32 v168, v52, v53
    v_cvt_pk_bf16_f32 v169, v54, v55
    v_permlane32_swap_b32 v182, v186
    v_permlane32_swap_b32 v183, v187
    v_cndmask_b32 v166, 0, v206, s[40:41]
    v_cndmask_b32 v170, 0, v206, s[42:43]
    v_cndmask_b32 v167, 0, v207, s[40:41]
    v_cndmask_b32 v171, 0, v207, s[42:43]
    v_mov_b32 v182, v186
    v_mov_b32 v183, v187
    v_pk_mul_f32 v[196:197], v[136:137], v[104:105] op_sel:[0,1] op_sel_hi:[1,1]
    v_pk_mul_f32 v[198:199], v[138:139], v[104:105] op_sel:[0,1] op_sel_hi:[1,1]
    v_pk_fma_f32 v[32:33], v[32:33], v[104:105], v[196:197] op_sel:[0,0,0] op_sel_hi:[1,0,1]
    v_pk_fma_f32 v[34:35], v[34:35], v[104:105], v[198:199] op_sel:[0,0,0] op_sel_hi:[1,0,1]
    v_pk_mul_f32 v[24:25], v[144:145], v[104:105] op_sel:[0,1] op_sel_hi:[1,1]
    v_pk_mul_f32 v[26:27], v[146:147], v[104:105] op_sel:[0,1] op_sel_hi:[1,1]
    v_pk_fma_f32 v[48:49], v[48:49], v[104:105], v[24:25] op_sel:[0,0,0] op_sel_hi:[1,0,1]
    v_pk_fma_f32 v[50:51], v[50:51], v[104:105], v[26:27] op_sel:[0,0,0] op_sel_hi:[1,0,1]
    v_mov_b32 v174, v204
    v_mov_b32 v178, v204
    v_mov_b32 v175, v205
    v_mov_b32 v179, v205
    v_cvt_pk_bf16_f32 v156, v32, v33
    v_cvt_pk_bf16_f32 v157, v34, v35
    v_cvt_pk_bf16_f32 v160, v48, v49
    v_cvt_pk_bf16_f32 v161, v50, v51
    v_permlane32_swap_b32 v174, v178
    v_permlane32_swap_b32 v175, v179
    v_cndmask_b32 v158, 0, v204, s[40:41]
    v_cndmask_b32 v162, 0, v204, s[42:43]
    v_cndmask_b32 v159, 0, v205, s[40:41]
    v_cndmask_b32 v163, 0, v205, s[42:43]
    v_mov_b32 v174, v178
    v_mov_b32 v175, v179
    s_waitcnt lgkmcnt(0)
    s_nop 0
    v_mfma_f32_16x16x32_bf16 v[32:35], v[172:175], v[164:167], 0
    v_mfma_f32_16x16x32_bf16 v[36:39], v[180:183], v[164:167], 0
    v_mfma_f32_16x16x32_bf16 v[40:43], v[176:179], v[168:171], 0
    v_mfma_f32_16x16x32_bf16 v[44:47], v[184:187], v[168:171], 0
    v_mfma_f32_16x16x32_bf16 v[68:71], v[188:191], v[156:159], 0
    v_mfma_f32_16x16x32_bf16 v[72:75], v[172:175], v[156:159], 0
    v_mfma_f32_16x16x32_bf16 v[76:79], v[192:195], v[160:163], 0
    v_mfma_f32_16x16x32_bf16 v[80:83], v[176:179], v[160:163], 0
    s_nop 0
    v_pk_fma_f32 v[32:33], v[32:33], s[44:45], v[234:235]
    v_pk_fma_f32 v[34:35], v[34:35], s[44:45], v[236:237]
    v_pk_fma_f32 v[36:37], v[36:37], s[44:45], v[238:239]
    v_pk_fma_f32 v[38:39], v[38:39], s[44:45], v[240:241]
    v_max3_f32 v48, v32, v33, v34
    v_max3_f32 v49, v35, v36, v37
    v_max3_f32 v48, v48, v38, v39
    v_max_f32 v48, v48, v49
    v_pk_fma_f32 v[40:41], v[40:41], s[44:45], v[234:235]
    v_pk_fma_f32 v[42:43], v[42:43], s[44:45], v[236:237]
    v_pk_fma_f32 v[44:45], v[44:45], s[44:45], v[238:239]
    v_pk_fma_f32 v[46:47], v[46:47], s[44:45], v[240:241]
    v_max3_f32 v50, v40, v41, v42
    v_max3_f32 v51, v43, v44, v45
    v_max3_f32 v50, v50, v46, v47
    v_max_f32 v50, v50, v51
    v_pk_fma_f32 v[68:69], v[68:69], s[44:45], v[242:243]
    v_pk_fma_f32 v[70:71], v[70:71], s[44:45], v[244:245]
    v_pk_fma_f32 v[72:73], v[72:73], s[44:45], v[238:239]
    v_pk_fma_f32 v[74:75], v[74:75], s[44:45], v[240:241]
    v_max3_f32 v84, v68, v69, v70
    v_max3_f32 v85, v71, v72, v73
    v_max3_f32 v84, v84, v74, v75
    v_max_f32 v84, v84, v85
    v_pk_fma_f32 v[76:77], v[76:77], s[44:45], v[242:243]
    v_pk_fma_f32 v[78:79], v[78:79], s[44:45], v[244:245]
    v_pk_fma_f32 v[80:81], v[80:81], s[44:45], v[238:239]
    v_pk_fma_f32 v[82:83], v[82:83], s[44:45], v[240:241]
    v_max3_f32 v86, v76, v77, v78
    v_max3_f32 v87, v79, v80, v81
    v_max3_f32 v86, v86, v82, v83
    v_max_f32 v86, v86, v87
    v_mov_b32 v49, v48
    v_mov_b32 v51, v50
    v_mov_b32 v85, v84
    v_mov_b32 v87, v86
    v_permlane32_swap_b32 v49, v48
    v_permlane32_swap_b32 v51, v50
    v_permlane32_swap_b32 v85, v84
    v_permlane32_swap_b32 v87, v86
    v_max_f32 v48, v48, v49
    v_max_f32 v50, v50, v51
    v_max_f32 v84, v84, v85
    v_max_f32 v86, v86, v87
    v_mov_b32 v49, v48
    v_mov_b32 v51, v50
    v_mov_b32 v85, v84
    v_mov_b32 v87, v86
    v_permlane16_swap_b32 v49, v48
    v_permlane16_swap_b32 v51, v50
    v_permlane16_swap_b32 v85, v84
    v_permlane16_swap_b32 v87, v86
    v_max_f32 v48, v48, v49
    v_max_f32 v50, v50, v51
    v_max_f32 v84, v84, v85
    v_max_f32 v86, v86, v87
    v_pk_add_f32 v[32:33], v[32:33], v[48:49] op_sel:[0,0] op_sel_hi:[1,0] neg_lo:[0,1] neg_hi:[0,1]
    v_pk_add_f32 v[34:35], v[34:35], v[48:49] op_sel:[0,0] op_sel_hi:[1,0] neg_lo:[0,1] neg_hi:[0,1]
    v_pk_add_f32 v[36:37], v[36:37], v[48:49] op_sel:[0,0] op_sel_hi:[1,0] neg_lo:[0,1] neg_hi:[0,1]
    v_pk_add_f32 v[38:39], v[38:39], v[48:49] op_sel:[0,0] op_sel_hi:[1,0] neg_lo:[0,1] neg_hi:[0,1]
    v_exp_f32 v32, v32
    v_exp_f32 v33, v33
    v_exp_f32 v34, v34
    v_exp_f32 v35, v35
    v_exp_f32 v36, v36
    v_exp_f32 v37, v37
    v_exp_f32 v38, v38
    v_exp_f32 v39, v39
    v_pk_add_f32 v[40:41], v[40:41], v[50:51] op_sel:[0,0] op_sel_hi:[1,0] neg_lo:[0,1] neg_hi:[0,1]
    v_pk_add_f32 v[42:43], v[42:43], v[50:51] op_sel:[0,0] op_sel_hi:[1,0] neg_lo:[0,1] neg_hi:[0,1]
    v_pk_add_f32 v[44:45], v[44:45], v[50:51] op_sel:[0,0] op_sel_hi:[1,0] neg_lo:[0,1] neg_hi:[0,1]
    v_pk_add_f32 v[46:47], v[46:47], v[50:51] op_sel:[0,0] op_sel_hi:[1,0] neg_lo:[0,1] neg_hi:[0,1]
    v_exp_f32 v40, v40
    v_exp_f32 v41, v41
    v_exp_f32 v42, v42
    v_exp_f32 v43, v43
    v_exp_f32 v44, v44
    v_exp_f32 v45, v45
    v_exp_f32 v46, v46
    v_exp_f32 v47, v47
    v_cvt_pk_bf16_f32 v52, v32, v33
    v_cvt_pk_bf16_f32 v53, v34, v35
    v_cvt_pk_bf16_f32 v54, v36, v37
    v_cvt_pk_bf16_f32 v55, v38, v39
    v_cvt_pk_bf16_f32 v56, v40, v41
    v_cvt_pk_bf16_f32 v57, v42, v43
    v_cvt_pk_bf16_f32 v58, v44, v45
    v_cvt_pk_bf16_f32 v59, v46, v47
    v_mfma_f32_16x16x32_bf16 v[60:63], v[246:249], v[52:55], 0
    s_nop 0
    v_mfma_f32_16x16x32_bf16 v[64:67], v[246:249], v[56:59], 0
    v_mfma_f32_16x16x32_bf16 v[32:35], v[218:221], v[52:55], 0
    v_mfma_f32_16x16x32_bf16 v[36:39], v[224:227], v[52:55], 0
    v_mfma_f32_16x16x32_bf16 v[40:43], v[224:227], v[56:59], 0
    v_mfma_f32_16x16x32_bf16 v[44:47], v[230:233], v[56:59], 0
    v_pk_add_f32 v[68:69], v[68:69], v[84:85] op_sel:[0,0] op_sel_hi:[1,0] neg_lo:[0,1] neg_hi:[0,1]
    v_pk_add_f32 v[70:71], v[70:71], v[84:85] op_sel:[0,0] op_sel_hi:[1,0] neg_lo:[0,1] neg_hi:[0,1]
    v_pk_add_f32 v[72:73], v[72:73], v[84:85] op_sel:[0,0] op_sel_hi:[1,0] neg_lo:[0,1] neg_hi:[0,1]
    v_pk_add_f32 v[74:75], v[74:75], v[84:85] op_sel:[0,0] op_sel_hi:[1,0] neg_lo:[0,1] neg_hi:[0,1]
    v_exp_f32 v68, v68
    v_exp_f32 v69, v69
    v_exp_f32 v70, v70
    v_exp_f32 v71, v71
    v_exp_f32 v72, v72
    v_exp_f32 v73, v73
    v_exp_f32 v74, v74
    v_exp_f32 v75, v75
    v_pk_add_f32 v[76:77], v[76:77], v[86:87] op_sel:[0,0] op_sel_hi:[1,0] neg_lo:[0,1] neg_hi:[0,1]
    v_pk_add_f32 v[78:79], v[78:79], v[86:87] op_sel:[0,0] op_sel_hi:[1,0] neg_lo:[0,1] neg_hi:[0,1]
    v_pk_add_f32 v[80:81], v[80:81], v[86:87] op_sel:[0,0] op_sel_hi:[1,0] neg_lo:[0,1] neg_hi:[0,1]
    v_pk_add_f32 v[82:83], v[82:83], v[86:87] op_sel:[0,0] op_sel_hi:[1,0] neg_lo:[0,1] neg_hi:[0,1]
    v_exp_f32 v76, v76
    v_exp_f32 v77, v77
    v_exp_f32 v78, v78
    v_exp_f32 v79, v79
    v_exp_f32 v80, v80
    v_exp_f32 v81, v81
    v_exp_f32 v82, v82
    v_exp_f32 v83, v83
    v_cvt_pk_bf16_f32 v88, v68, v69
    v_cvt_pk_bf16_f32 v89, v70, v71
    v_cvt_pk_bf16_f32 v90, v72, v73
    v_cvt_pk_bf16_f32 v91, v74, v75
    v_cvt_pk_bf16_f32 v92, v76, v77
    v_cvt_pk_bf16_f32 v93, v78, v79
    v_cvt_pk_bf16_f32 v94, v80, v81
    v_cvt_pk_bf16_f32 v95, v82, v83
    v_mfma_f32_16x16x32_bf16 v[96:99], v[246:249], v[88:91], 0
    s_nop 0
    v_mfma_f32_16x16x32_bf16 v[100:103], v[246:249], v[92:95], 0
    v_mfma_f32_16x16x32_bf16 v[68:71], v[216:219], v[88:91], 0
    v_mfma_f32_16x16x32_bf16 v[72:75], v[222:225], v[88:91], 0
    v_mfma_f32_16x16x32_bf16 v[76:79], v[222:225], v[92:95], 0
    v_mfma_f32_16x16x32_bf16 v[80:83], v[228:231], v[92:95], 0
    v_rcp_f32 v60, v60
    v_rcp_f32 v64, v64
    v_cndmask_b32 v36, v40, v36, s[40:41]
    v_cndmask_b32 v37, v41, v37, s[40:41]
    v_cndmask_b32 v38, v42, v38, s[40:41]
    v_cndmask_b32 v39, v43, v39, s[40:41]
    v_cndmask_b32 v61, v64, v60, s[40:41]
    v_pk_mul_f32 v[32:33], v[32:33], v[60:61] op_sel:[0,0] op_sel_hi:[1,0]
    v_pk_mul_f32 v[34:35], v[34:35], v[60:61] op_sel:[0,0] op_sel_hi:[1,0]
    v_pk_mul_f32 v[36:37], v[36:37], v[60:61] op_sel:[0,1] op_sel_hi:[1,1]
    v_pk_mul_f32 v[38:39], v[38:39], v[60:61] op_sel:[0,1] op_sel_hi:[1,1]
    v_pk_mul_f32 v[44:45], v[44:45], v[64:65] op_sel:[0,0] op_sel_hi:[1,0]
    v_pk_mul_f32 v[46:47], v[46:47], v[64:65] op_sel:[0,0] op_sel_hi:[1,0]
    v_cvt_pk_bf16_f32 v52, v32, v33
    v_cvt_pk_bf16_f32 v53, v34, v35
    v_cvt_pk_bf16_f32 v54, v36, v37
    v_cvt_pk_bf16_f32 v55, v38, v39
    v_cvt_pk_bf16_f32 v56, v44, v45
    v_cvt_pk_bf16_f32 v57, v46, v47
    buffer_store_dwordx4 v[52:55], v3, s[4:7], s46 offen offset:1024 sc1
    s_mov_b64 exec, 0xffffffff
    buffer_store_dwordx2 v[56:57], v19, s[4:7], s47 offen offset:1024 sc1
    s_mov_b64 exec, -1
    v_rcp_f32 v96, v96
    v_rcp_f32 v100, v100
    v_cndmask_b32 v72, v76, v72, s[40:41]
    v_cndmask_b32 v73, v77, v73, s[40:41]
    v_cndmask_b32 v74, v78, v74, s[40:41]
    v_cndmask_b32 v75, v79, v75, s[40:41]
    v_cndmask_b32 v97, v100, v96, s[40:41]
    v_pk_mul_f32 v[68:69], v[68:69], v[96:97] op_sel:[0,0] op_sel_hi:[1,0]
    v_pk_mul_f32 v[70:71], v[70:71], v[96:97] op_sel:[0,0] op_sel_hi:[1,0]
    v_pk_mul_f32 v[72:73], v[72:73], v[96:97] op_sel:[0,1] op_sel_hi:[1,1]
    v_pk_mul_f32 v[74:75], v[74:75], v[96:97] op_sel:[0,1] op_sel_hi:[1,1]
    v_pk_mul_f32 v[80:81], v[80:81], v[100:101] op_sel:[0,0] op_sel_hi:[1,0]
    v_pk_mul_f32 v[82:83], v[82:83], v[100:101] op_sel:[0,0] op_sel_hi:[1,0]
    v_cvt_pk_bf16_f32 v88, v68, v69
    v_cvt_pk_bf16_f32 v89, v70, v71
    v_cvt_pk_bf16_f32 v90, v72, v73
    v_cvt_pk_bf16_f32 v91, v74, v75
    v_cvt_pk_bf16_f32 v92, v80, v81
    v_cvt_pk_bf16_f32 v93, v82, v83
    buffer_store_dwordx4 v[88:91], v3, s[4:7], s46 offen offset:0 sc1
    s_mov_b64 exec, 0xffffffff
    buffer_store_dwordx2 v[92:93], v19, s[4:7], s47 offen offset:0 sc1
    s_mov_b64 exec, -1
    v_lshlrev_b32 v8, 3, v0
    s_lshl_b32 s33, s50, 2
    s_add_u32 s33, s33, s13
    s_lshl_b32 s34, s33, 10
    s_lshl_b32 s31, s51, 18
    s_add_u32 s31, s31, s34
    s_lshr_b32 s32, s51, 1
    s_add_u32 s32, s32, 16
    s_lshl_b32 s32, s32, 17
    s_add_u32 s32, s32, s34
    s_and_b32 s35, s51, 1
    s_lshl_b32 s35, s35, 9
    s_add_u32 s32, s32, s35
    s_add_u32 s35, s12, 0
    s_add_u32 s36, s35, s31
    s_add_u32 s37, s36, 131072
    s_add_u32 s35, s35, s32
    buffer_load_dwordx4 v[160:163], v3, s[4:7], s36 offen sc1
    buffer_load_dwordx4 v[164:167], v3, s[4:7], s37 offen sc1
    buffer_load_dwordx2 v[168:169], v8, s[4:7], s35 offen sc1
    s_lshl_b32 s30, s13, 10
    v_add_u32 v13, s30, v3
    v_add_u32 v4, 20480, v13
    v_add_u32 v6, 81920, v3
    v_add_u32 v7, 147456, v3
    s_add_u32 s30, s30, 20480
    v_add_u32 v5, s30, v8
    s_add_u32 s35, s12, 5373952
    s_add_u32 s36, s35, s31
    s_add_u32 s37, s36, 131072
    s_add_u32 s35, s35, s32
    s_lshl_b32 s39, s51, 14
    s_lshl_b32 s40, s33, 7
    s_add_u32 s39, s39, s40
    s_add_u32 s39, s39, s12
    s_add_u32 s39, s39, 7995392
    v_mov_b32 v172, 0
    v_mov_b32 v173, 0
    v_mov_b32 v174, 0x3f803f80
    v_lshlrev_b32 v177, 3, v2
    s_waitcnt vmcnt(3)
    s_barrier
    v_mov_b32 v178, 0
    v_mov_b32 v179, 0
    s_mov_b32 s38, 0xffff0000
    s_waitcnt vmcnt(0)
    v_lshlrev_b32 v32, 16, v160
    v_and_b32 v33, s38, v160
    v_lshlrev_b32 v34, 16, v161
    v_and_b32 v35, s38, v161
    v_lshlrev_b32 v36, 16, v162
    v_and_b32 v37, s38, v162
    v_lshlrev_b32 v38, 16, v163
    v_and_b32 v39, s38, v163
    v_lshlrev_b32 v40, 16, v164
    v_and_b32 v41, s38, v164
    v_lshlrev_b32 v42, 16, v165
    v_and_b32 v43, s38, v165
    v_lshlrev_b32 v44, 16, v166
    v_and_b32 v45, s38, v166
    v_lshlrev_b32 v46, 16, v167
    v_and_b32 v47, s38, v167
    v_lshlrev_b32 v48, 16, v168
    v_and_b32 v49, s38, v168
    v_lshlrev_b32 v50, 16, v169
    v_and_b32 v51, s38, v169
    s_cmp_lg_u32 s13, 3
    s_cbranch_scc1 CPL2_ok
    s_lshl_b32 s73, s14, 15
    s_add_u32 s73, s73, 6881280
    s_lshr_b32 s72, s50, 1
    s_lshl_b32 s72, s72, 7
    s_add_u32 s72, s72, s73
    s_mov_b64 exec, 1
    s_mov_b32 s73, 0
    buffer_load_dword v253, off, s[4:7], s72 sc1
    s_sleep 2
    buffer_load_dword v254, off, s[4:7], s72 sc1
    s_sleep 2
CPL2:
    buffer_load_dword v255, off, s[4:7], s72 sc1
    s_waitcnt vmcnt(2)
    v_cmp_ne_u32 vcc, 16, v253
    s_nop 1
    s_cmp_eq_u64 vcc, 0
    s_cbranch_scc1 CPL2_x
    s_sleep 1
    buffer_load_dword v253, off, s[4:7], s72 sc1
    s_waitcnt vmcnt(2)
    v_cmp_ne_u32 vcc, 16, v254
    s_nop 1
    s_cmp_eq_u64 vcc, 0
    s_cbranch_scc1 CPL2_x
    s_sleep 1
    buffer_load_dword v254, off, s[4:7], s72 sc1
    s_waitcnt vmcnt(2)
    v_cmp_ne_u32 vcc, 16, v255
    s_nop 1
    s_cmp_eq_u64 vcc, 0
    s_cbranch_scc1 CPL2_x
    s_sleep 1
    s_add_u32 s73, s73, 1
    s_cmp_lt_u32 s73, 0x20000
    s_cbranch_scc1 CPL2
CPL2_x:
    s_mov_b64 exec, -1
CPL2_ok:
    s_barrier
    s_barrier
    ds_read_b128 v[64:67], v4 offset:0
    ds_read_b128 v[68:71], v6 offset:0
    ds_read_b128 v[72:75], v6 offset:1024
    ds_read_b128 v[76:79], v6 offset:2048
    ds_read_b128 v[80:83], v6 offset:3072
    ds_read_b128 v[84:87], v6 offset:4096
    ds_read_b128 v[88:91], v4 offset:4096
    ds_read_b128 v[92:95], v6 offset:5120
    ds_read_b128 v[96:99], v6 offset:6144
    ds_read_b128 v[100:103], v6 offset:7168
    ds_read_b128 v[104:107], v6 offset:8192
    ds_read_b128 v[108:111], v6 offset:9216
    s_barrier
    s_waitcnt lgkmcnt(10)
    v_mfma_f32_16x16x32_bf16 v[32:35], v[68:71], v[64:67], v[32:35]
    ds_read_b128 v[112:115], v4 offset:8192
    s_waitcnt lgkmcnt(10)
    v_mfma_f32_16x16x32_bf16 v[36:39], v[72:75], v[64:67], v[36:39]
    ds_read_b128 v[116:119], v6 offset:10240
    s_waitcnt lgkmcnt(10)
    v_mfma_f32_16x16x32_bf16 v[40:43], v[76:79], v[64:67], v[40:43]
    ds_read_b128 v[120:123], v6 offset:11264
    s_waitcnt lgkmcnt(10)
    v_mfma_f32_16x16x32_bf16 v[44:47], v[80:83], v[64:67], v[44:47]
    ds_read_b128 v[124:127], v6 offset:12288
    ds_read_b128 v[128:131], v6 offset:13312
    s_waitcnt lgkmcnt(11)
    v_mfma_f32_16x16x32_bf16 v[48:51], v[84:87], v[64:67], v[48:51]
    ds_read_b128 v[132:135], v6 offset:14336
    s_waitcnt lgkmcnt(10)
    v_mfma_f32_16x16x32_bf16 v[32:35], v[92:95], v[88:91], v[32:35]
    ds_read_b128 v[136:139], v4 offset:12288
    s_waitcnt lgkmcnt(10)
    v_mfma_f32_16x16x32_bf16 v[36:39], v[96:99], v[88:91], v[36:39]
    ds_read_b128 v[140:143], v6 offset:15360
    s_waitcnt lgkmcnt(10)
    v_mfma_f32_16x16x32_bf16 v[40:43], v[100:103], v[88:91], v[40:43]
    ds_read_b128 v[144:147], v6 offset:16384
    ds_read_b128 v[148:151], v6 offset:17408
    s_waitcnt lgkmcnt(11)
    v_mfma_f32_16x16x32_bf16 v[44:47], v[104:107], v[88:91], v[44:47]
    ds_read_b128 v[152:155], v6 offset:18432
    s_waitcnt lgkmcnt(11)
    v_mfma_f32_16x16x32_bf16 v[48:51], v[108:111], v[88:91], v[48:51]
    ds_read_b128 v[156:159], v6 offset:19456
    s_barrier
    s_waitcnt lgkmcnt(10)
    v_mfma_f32_16x16x32_bf16 v[32:35], v[116:119], v[112:115], v[32:35]
    ds_read_b128 v[64:67], v4 offset:16384
    s_waitcnt lgkmcnt(10)
    v_mfma_f32_16x16x32_bf16 v[36:39], v[120:123], v[112:115], v[36:39]
    ds_read_b128 v[68:71], v6 offset:20480
    s_waitcnt lgkmcnt(10)
    v_mfma_f32_16x16x32_bf16 v[40:43], v[124:127], v[112:115], v[40:43]
    ds_read_b128 v[72:75], v6 offset:21504
    s_waitcnt lgkmcnt(10)
    v_mfma_f32_16x16x32_bf16 v[44:47], v[128:131], v[112:115], v[44:47]
    ds_read_b128 v[76:79], v6 offset:22528
    ds_read_b128 v[80:83], v6 offset:23552
    s_waitcnt lgkmcnt(11)
    v_mfma_f32_16x16x32_bf16 v[48:51], v[132:135], v[112:115], v[48:51]
    ds_read_b128 v[84:87], v6 offset:24576
    s_waitcnt lgkmcnt(10)
    v_mfma_f32_16x16x32_bf16 v[32:35], v[140:143], v[136:139], v[32:35]
    ds_read_b128 v[88:91], v4 offset:20480
    s_waitcnt lgkmcnt(10)
    v_mfma_f32_16x16x32_bf16 v[36:39], v[144:147], v[136:139], v[36:39]
    ds_read_b128 v[92:95], v6 offset:25600
    s_waitcnt lgkmcnt(10)
    v_mfma_f32_16x16x32_bf16 v[40:43], v[148:151], v[136:139], v[40:43]
    ds_read_b128 v[96:99], v6 offset:26624
    ds_read_b128 v[100:103], v6 offset:27648
    s_waitcnt lgkmcnt(11)
    v_mfma_f32_16x16x32_bf16 v[44:47], v[152:155], v[136:139], v[44:47]
    ds_read_b128 v[104:107], v6 offset:28672
    s_waitcnt lgkmcnt(11)
    v_mfma_f32_16x16x32_bf16 v[48:51], v[156:159], v[136:139], v[48:51]
    ds_read_b128 v[108:111], v6 offset:29696
    s_barrier
    s_waitcnt lgkmcnt(10)
    v_mfma_f32_16x16x32_bf16 v[32:35], v[68:71], v[64:67], v[32:35]
    ds_read_b128 v[112:115], v4 offset:24576
    s_waitcnt lgkmcnt(10)
    v_mfma_f32_16x16x32_bf16 v[36:39], v[72:75], v[64:67], v[36:39]
    ds_read_b128 v[116:119], v6 offset:30720
    s_waitcnt lgkmcnt(10)
    v_mfma_f32_16x16x32_bf16 v[40:43], v[76:79], v[64:67], v[40:43]
    ds_read_b128 v[120:123], v6 offset:31744
    s_waitcnt lgkmcnt(10)
    v_mfma_f32_16x16x32_bf16 v[44:47], v[80:83], v[64:67], v[44:47]
    ds_read_b128 v[124:127], v6 offset:32768
    ds_read_b128 v[128:131], v6 offset:33792
    s_waitcnt lgkmcnt(11)
    v_mfma_f32_16x16x32_bf16 v[48:51], v[84:87], v[64:67], v[48:51]
    ds_read_b128 v[132:135], v6 offset:34816
    s_waitcnt lgkmcnt(10)
    v_mfma_f32_16x16x32_bf16 v[32:35], v[92:95], v[88:91], v[32:35]
    ds_read_b128 v[136:139], v4 offset:28672
    s_waitcnt lgkmcnt(10)
    v_mfma_f32_16x16x32_bf16 v[36:39], v[96:99], v[88:91], v[36:39]
    ds_read_b128 v[140:143], v6 offset:35840
    s_waitcnt lgkmcnt(10)
    v_mfma_f32_16x16x32_bf16 v[40:43], v[100:103], v[88:91], v[40:43]
    ds_read_b128 v[144:147], v6 offset:36864
    ds_read_b128 v[148:151], v6 offset:37888
    s_waitcnt lgkmcnt(11)
    v_mfma_f32_16x16x32_bf16 v[44:47], v[104:107], v[88:91], v[44:47]
    ds_read_b128 v[152:155], v6 offset:38912
    s_waitcnt lgkmcnt(11)
    v_mfma_f32_16x16x32_bf16 v[48:51], v[108:111], v[88:91], v[48:51]
    ds_read_b128 v[156:159], v6 offset:39936
    s_barrier
    s_waitcnt lgkmcnt(10)
    v_mfma_f32_16x16x32_bf16 v[32:35], v[116:119], v[112:115], v[32:35]
    ds_read_b128 v[64:67], v4 offset:32768
    s_waitcnt lgkmcnt(10)
    v_mfma_f32_16x16x32_bf16 v[36:39], v[120:123], v[112:115], v[36:39]
    ds_read_b128 v[68:71], v6 offset:40960
    s_waitcnt lgkmcnt(10)
    v_mfma_f32_16x16x32_bf16 v[40:43], v[124:127], v[112:115], v[40:43]
    ds_read_b128 v[72:75], v6 offset:41984
    s_waitcnt lgkmcnt(10)
    v_mfma_f32_16x16x32_bf16 v[44:47], v[128:131], v[112:115], v[44:47]
    ds_read_b128 v[76:79], v6 offset:43008
    ds_read_b128 v[80:83], v6 offset:44032
    s_waitcnt lgkmcnt(11)
    v_mfma_f32_16x16x32_bf16 v[48:51], v[132:135], v[112:115], v[48:51]
    ds_read_b128 v[84:87], v6 offset:45056
    s_waitcnt lgkmcnt(10)
    v_mfma_f32_16x16x32_bf16 v[32:35], v[140:143], v[136:139], v[32:35]
    ds_read_b128 v[88:91], v4 offset:36864
    s_waitcnt lgkmcnt(10)
    v_mfma_f32_16x16x32_bf16 v[36:39], v[144:147], v[136:139], v[36:39]
    ds_read_b128 v[92:95], v6 offset:46080
    s_waitcnt lgkmcnt(10)
    v_mfma_f32_16x16x32_bf16 v[40:43], v[148:151], v[136:139], v[40:43]
    ds_read_b128 v[96:99], v6 offset:47104
    ds_read_b128 v[100:103], v6 offset:48128
    s_waitcnt lgkmcnt(11)
    v_mfma_f32_16x16x32_bf16 v[44:47], v[152:155], v[136:139], v[44:47]
    ds_read_b128 v[104:107], v6 offset:49152
    s_waitcnt lgkmcnt(11)
    v_mfma_f32_16x16x32_bf16 v[48:51], v[156:159], v[136:139], v[48:51]
    ds_read_b128 v[108:111], v6 offset:50176
    s_barrier
    s_waitcnt lgkmcnt(10)
    v_mfma_f32_16x16x32_bf16 v[32:35], v[68:71], v[64:67], v[32:35]
    ds_read_b128 v[112:115], v4 offset:40960
    s_waitcnt lgkmcnt(10)
    v_mfma_f32_16x16x32_bf16 v[36:39], v[72:75], v[64:67], v[36:39]
    ds_read_b128 v[116:119], v6 offset:51200
    s_waitcnt lgkmcnt(10)
    v_mfma_f32_16x16x32_bf16 v[40:43], v[76:79], v[64:67], v[40:43]
    ds_read_b128 v[120:123], v6 offset:52224
    s_waitcnt lgkmcnt(10)
    v_mfma_f32_16x16x32_bf16 v[44:47], v[80:83], v[64:67], v[44:47]
    ds_read_b128 v[124:127], v6 offset:53248
    ds_read_b128 v[128:131], v6 offset:54272
    s_waitcnt lgkmcnt(11)
    v_mfma_f32_16x16x32_bf16 v[48:51], v[84:87], v[64:67], v[48:51]
    ds_read_b128 v[132:135], v6 offset:55296
    s_waitcnt lgkmcnt(10)
    v_mfma_f32_16x16x32_bf16 v[32:35], v[92:95], v[88:91], v[32:35]
    ds_read_b128 v[136:139], v4 offset:45056
    s_waitcnt lgkmcnt(10)
    v_mfma_f32_16x16x32_bf16 v[36:39], v[96:99], v[88:91], v[36:39]
    ds_read_b128 v[140:143], v6 offset:56320
    s_waitcnt lgkmcnt(10)
    v_mfma_f32_16x16x32_bf16 v[40:43], v[100:103], v[88:91], v[40:43]
    ds_read_b128 v[144:147], v6 offset:57344
    ds_read_b128 v[148:151], v6 offset:58368
    s_waitcnt lgkmcnt(11)
    v_mfma_f32_16x16x32_bf16 v[44:47], v[104:107], v[88:91], v[44:47]
    ds_read_b128 v[152:155], v6 offset:59392
    s_waitcnt lgkmcnt(11)
    v_mfma_f32_16x16x32_bf16 v[48:51], v[108:111], v[88:91], v[48:51]
    ds_read_b128 v[156:159], v6 offset:60416
    s_barrier
    s_waitcnt lgkmcnt(10)
    v_mfma_f32_16x16x32_bf16 v[32:35], v[116:119], v[112:115], v[32:35]
    ds_read_b128 v[64:67], v4 offset:49152
    s_waitcnt lgkmcnt(10)
    v_mfma_f32_16x16x32_bf16 v[36:39], v[120:123], v[112:115], v[36:39]
    ds_read_b128 v[68:71], v6 offset:61440
    s_waitcnt lgkmcnt(10)
    v_mfma_f32_16x16x32_bf16 v[40:43], v[124:127], v[112:115], v[40:43]
    ds_read_b128 v[72:75], v6 offset:62464
    s_waitcnt lgkmcnt(10)
    v_mfma_f32_16x16x32_bf16 v[44:47], v[128:131], v[112:115], v[44:47]
    ds_read_b128 v[76:79], v6 offset:63488
    ds_read_b128 v[80:83], v6 offset:64512
    s_waitcnt lgkmcnt(11)
    v_mfma_f32_16x16x32_bf16 v[48:51], v[132:135], v[112:115], v[48:51]
    ds_read_b128 v[84:87], v7 offset:0
    s_waitcnt lgkmcnt(10)
    v_mfma_f32_16x16x32_bf16 v[32:35], v[140:143], v[136:139], v[32:35]
    ds_read_b128 v[88:91], v4 offset:53248
    s_waitcnt lgkmcnt(10)
    v_mfma_f32_16x16x32_bf16 v[36:39], v[144:147], v[136:139], v[36:39]
    ds_read_b128 v[92:95], v7 offset:1024
    s_waitcnt lgkmcnt(10)
    v_mfma_f32_16x16x32_bf16 v[40:43], v[148:151], v[136:139], v[40:43]
    ds_read_b128 v[96:99], v7 offset:2048
    ds_read_b128 v[100:103], v7 offset:3072
    s_waitcnt lgkmcnt(11)
    v_mfma_f32_16x16x32_bf16 v[44:47], v[152:155], v[136:139], v[44:47]
    ds_read_b128 v[104:107], v7 offset:4096
    s_waitcnt lgkmcnt(11)
    v_mfma_f32_16x16x32_bf16 v[48:51], v[156:159], v[136:139], v[48:51]
    ds_read_b128 v[108:111], v7 offset:5120
    s_barrier
    s_waitcnt lgkmcnt(10)
    v_mfma_f32_16x16x32_bf16 v[32:35], v[68:71], v[64:67], v[32:35]
    ds_read_b128 v[112:115], v4 offset:0
    s_waitcnt lgkmcnt(10)
    v_mfma_f32_16x16x32_bf16 v[36:39], v[72:75], v[64:67], v[36:39]
    ds_read_b128 v[116:119], v7 offset:6144
    s_waitcnt lgkmcnt(10)
    v_mfma_f32_16x16x32_bf16 v[40:43], v[76:79], v[64:67], v[40:43]
    ds_read_b128 v[120:123], v7 offset:7168
    s_waitcnt lgkmcnt(10)
    v_mfma_f32_16x16x32_bf16 v[44:47], v[80:83], v[64:67], v[44:47]
    ds_read_b128 v[124:127], v7 offset:8192
    ds_read_b128 v[128:131], v7 offset:9216
    s_waitcnt lgkmcnt(11)
    v_mfma_f32_16x16x32_bf16 v[48:51], v[84:87], v[64:67], v[48:51]
    ds_read_b128 v[132:135], v7 offset:10240
    s_waitcnt lgkmcnt(10)
    v_mfma_f32_16x16x32_bf16 v[32:35], v[92:95], v[88:91], v[32:35]
    ds_read_b128 v[136:139], v4 offset:4096
    s_waitcnt lgkmcnt(10)
    v_mfma_f32_16x16x32_bf16 v[36:39], v[96:99], v[88:91], v[36:39]
    ds_read_b128 v[140:143], v7 offset:11264
    s_waitcnt lgkmcnt(10)
    v_mfma_f32_16x16x32_bf16 v[40:43], v[100:103], v[88:91], v[40:43]
    ds_read_b128 v[144:147], v7 offset:12288
    ds_read_b128 v[148:151], v7 offset:13312
    s_waitcnt lgkmcnt(11)
    v_mfma_f32_16x16x32_bf16 v[44:47], v[104:107], v[88:91], v[44:47]
    ds_read_b128 v[152:155], v7 offset:14336
    s_waitcnt lgkmcnt(11)
    v_mfma_f32_16x16x32_bf16 v[48:51], v[108:111], v[88:91], v[48:51]
    ds_read_b128 v[156:159], v7 offset:15360
    s_barrier
    s_waitcnt lgkmcnt(10)
    v_mfma_f32_16x16x32_bf16 v[32:35], v[116:119], v[112:115], v[32:35]
    ds_read2st64_b64 v[64:67], v5 offset0:16 offset1:17
    s_waitcnt lgkmcnt(10)
    v_mfma_f32_16x16x32_bf16 v[36:39], v[120:123], v[112:115], v[36:39]
    ds_read_b128 v[68:71], v6 offset:0
    s_waitcnt lgkmcnt(10)
    v_mfma_f32_16x16x32_bf16 v[40:43], v[124:127], v[112:115], v[40:43]
    ds_read_b128 v[72:75], v6 offset:1024
    s_waitcnt lgkmcnt(10)
    v_mfma_f32_16x16x32_bf16 v[44:47], v[128:131], v[112:115], v[44:47]
    ds_read_b128 v[76:79], v6 offset:2048
    ds_read_b128 v[80:83], v6 offset:3072
    s_waitcnt lgkmcnt(11)
    v_mfma_f32_16x16x32_bf16 v[48:51], v[132:135], v[112:115], v[48:51]
    ds_read_b128 v[84:87], v6 offset:4096
    s_waitcnt lgkmcnt(10)
    v_mfma_f32_16x16x32_bf16 v[32:35], v[140:143], v[136:139], v[32:35]
    ds_read2st64_b64 v[88:91], v5 offset0:24 offset1:25
    s_waitcnt lgkmcnt(10)
    v_mfma_f32_16x16x32_bf16 v[36:39], v[144:147], v[136:139], v[36:39]
    ds_read_b128 v[92:95], v6 offset:5120
    s_waitcnt lgkmcnt(10)
    v_mfma_f32_16x16x32_bf16 v[40:43], v[148:151], v[136:139], v[40:43]
    ds_read_b128 v[96:99], v6 offset:6144
    ds_read_b128 v[100:103], v6 offset:7168
    s_waitcnt lgkmcnt(11)
    v_mfma_f32_16x16x32_bf16 v[44:47], v[152:155], v[136:139], v[44:47]
    ds_read_b128 v[104:107], v6 offset:8192
    s_waitcnt lgkmcnt(11)
    v_mfma_f32_16x16x32_bf16 v[48:51], v[156:159], v[136:139], v[48:51]
    ds_read_b128 v[108:111], v6 offset:9216
    s_barrier
    s_waitcnt lgkmcnt(10)
    v_mfma_f32_16x16x32_bf16 v[32:35], v[68:71], v[64:67], v[32:35]
    ds_read2st64_b64 v[112:115], v5 offset0:32 offset1:33
    s_waitcnt lgkmcnt(10)
    v_mfma_f32_16x16x32_bf16 v[36:39], v[72:75], v[64:67], v[36:39]
    ds_read_b128 v[116:119], v6 offset:10240
    s_waitcnt lgkmcnt(10)
    v_mfma_f32_16x16x32_bf16 v[40:43], v[76:79], v[64:67], v[40:43]
    ds_read_b128 v[120:123], v6 offset:11264
    s_waitcnt lgkmcnt(10)
    v_mfma_f32_16x16x32_bf16 v[44:47], v[80:83], v[64:67], v[44:47]
    ds_read_b128 v[124:127], v6 offset:12288
    ds_read_b128 v[128:131], v6 offset:13312
    s_waitcnt lgkmcnt(11)
    v_mfma_f32_16x16x32_bf16 v[48:51], v[84:87], v[64:67], v[48:51]
    ds_read_b128 v[132:135], v6 offset:14336
    s_waitcnt lgkmcnt(10)
    v_mfma_f32_16x16x32_bf16 v[32:35], v[92:95], v[88:91], v[32:35]
    ds_read2st64_b64 v[136:139], v5 offset0:40 offset1:41
    s_waitcnt lgkmcnt(10)
    v_mfma_f32_16x16x32_bf16 v[36:39], v[96:99], v[88:91], v[36:39]
    ds_read_b128 v[140:143], v6 offset:15360
    s_waitcnt lgkmcnt(10)
    v_mfma_f32_16x16x32_bf16 v[40:43], v[100:103], v[88:91], v[40:43]
    ds_read_b128 v[144:147], v6 offset:16384
    ds_read_b128 v[148:151], v6 offset:17408
    s_waitcnt lgkmcnt(11)
    v_mfma_f32_16x16x32_bf16 v[44:47], v[104:107], v[88:91], v[44:47]
    ds_read_b128 v[152:155], v6 offset:18432
    s_waitcnt lgkmcnt(11)
    v_mfma_f32_16x16x32_bf16 v[48:51], v[108:111], v[88:91], v[48:51]
    ds_read_b128 v[156:159], v6 offset:19456
    s_waitcnt lgkmcnt(10)
    v_mfma_f32_16x16x32_bf16 v[32:35], v[116:119], v[112:115], v[32:35]
    s_waitcnt lgkmcnt(9)
    v_mfma_f32_16x16x32_bf16 v[36:39], v[120:123], v[112:115], v[36:39]
    s_waitcnt lgkmcnt(8)
    v_mfma_f32_16x16x32_bf16 v[40:43], v[124:127], v[112:115], v[40:43]
    s_waitcnt lgkmcnt(7)
    v_mfma_f32_16x16x32_bf16 v[44:47], v[128:131], v[112:115], v[44:47]
    s_waitcnt lgkmcnt(6)
    v_mfma_f32_16x16x32_bf16 v[48:51], v[132:135], v[112:115], v[48:51]
    s_waitcnt lgkmcnt(4)
    v_mfma_f32_16x16x32_bf16 v[32:35], v[140:143], v[136:139], v[32:35]
    s_waitcnt lgkmcnt(3)
    v_mfma_f32_16x16x32_bf16 v[36:39], v[144:147], v[136:139], v[36:39]
    s_waitcnt lgkmcnt(2)
    v_mfma_f32_16x16x32_bf16 v[40:43], v[148:151], v[136:139], v[40:43]
    s_waitcnt lgkmcnt(1)
    v_mfma_f32_16x16x32_bf16 v[44:47], v[152:155], v[136:139], v[44:47]
    s_waitcnt lgkmcnt(0)
    v_mfma_f32_16x16x32_bf16 v[48:51], v[156:159], v[136:139], v[48:51]
    s_barrier
    v_cvt_pk_bf16_f32 v160, v32, v33
    v_cvt_pk_bf16_f32 v161, v34, v35
    v_cvt_pk_bf16_f32 v162, v36, v37
    v_cvt_pk_bf16_f32 v163, v38, v39
    v_cvt_pk_bf16_f32 v164, v40, v41
    v_cvt_pk_bf16_f32 v165, v42, v43
    v_cvt_pk_bf16_f32 v166, v44, v45
    v_cvt_pk_bf16_f32 v167, v46, v47
    v_cvt_pk_bf16_f32 v168, v48, v49
    v_cvt_pk_bf16_f32 v169, v50, v51
    buffer_store_dwordx4 v[160:163], v3, s[4:7], s36 offen sc1
    buffer_store_dwordx4 v[164:167], v3, s[4:7], s37 offen sc1
    buffer_store_dwordx2 v[168:169], v8, s[4:7], s35 offen sc1
    v_dot2_f32_bf16 v172, v160, v174, v172
    v_dot2_f32_bf16 v173, v160, v160, v173
    v_dot2_f32_bf16 v178, v161, v174, v178
    v_dot2_f32_bf16 v179, v161, v161, v179
    v_dot2_f32_bf16 v172, v162, v174, v172
    v_dot2_f32_bf16 v173, v162, v162, v173
    v_dot2_f32_bf16 v178, v163, v174, v178
    v_dot2_f32_bf16 v179, v163, v163, v179
    v_dot2_f32_bf16 v172, v164, v174, v172
    v_dot2_f32_bf16 v173, v164, v164, v173
    v_dot2_f32_bf16 v178, v165, v174, v178
    v_dot2_f32_bf16 v179, v165, v165, v179
    v_dot2_f32_bf16 v172, v166, v174, v172
    v_dot2_f32_bf16 v173, v166, v166, v173
    v_dot2_f32_bf16 v178, v167, v174, v178
    v_dot2_f32_bf16 v179, v167, v167, v179
    v_dot2_f32_bf16 v172, v168, v174, v172
    v_dot2_f32_bf16 v173, v168, v168, v173
    v_dot2_f32_bf16 v178, v169, v174, v178
    v_dot2_f32_bf16 v179, v169, v169, v179
    s_nop 2
    v_pk_add_f32 v[172:173], v[172:173], v[178:179]
    v_mov_b32 v178, v172
    v_mov_b32 v179, v173
    s_nop 0
    v_permlane32_swap_b32 v178, v172
    v_permlane32_swap_b32 v179, v173
    v_pk_add_f32 v[172:173], v[172:173], v[178:179]
    v_mov_b32 v178, v172
    v_mov_b32 v179, v173
    s_nop 0
    v_permlane16_swap_b32 v178, v172
    v_permlane16_swap_b32 v179, v173
    v_pk_add_f32 v[172:173], v[172:173], v[178:179]
    s_mov_b64 exec, 0xffff
    buffer_store_dwordx2 v[172:173], v177, s[4:7], s39 offen sc1
    s_mov_b64 exec, -1
    s_lshl_b32 s34, s51, 9
    s_add_u32 s34, s34, 6864896
    s_add_u32 s35, s34, 8192
    v_lshlrev_b32 v22, 3, v0
    s_and_b32 s38, s51, 3
    s_cmp_eq_u32 s38, 3
    s_cselect_b32 s38, 47, 55
    s_lshl_b32 s38, s38, 3
    v_min_u32 v7, s38, v22
    buffer_load_dwordx2 v[192:193], v7, s[4:7], s34 offen
    buffer_load_dwordx2 v[194:195], v7, s[4:7], s35 offen
    s_add_u32 s34, s34, 4096
    s_add_u32 s35, s35, 4096
    buffer_load_dwordx2 v[196:197], v7, s[4:7], s34 offen
    buffer_load_dwordx2 v[198:199], v7, s[4:7], s35 offen
    s_and_b32 s31, s13, 1
    s_lshr_b32 s32, s13, 1
    v_add_u32 v16, 20480, v3
    v_add_u32 v17, 86016, v3
    s_lshl_b32 s34, s31, 11
    s_add_u32 s34, s34, 106496
    v_add_u32 v18, s34, v3
    v_lshlrev_b32 v19, 4, v1
    v_and_b32 v20, 1, v2
    v_lshlrev_b32 v20, 6, v20
    v_lshl_add_u32 v20, v1, 4, v20
    s_lshl_b32 s34, s31, 9
    v_add_u32 v21, s34, v22
    s_lshl_b32 s33, s50, 1
    s_add_u32 s33, s33, s31
    v_lshlrev_b32 v24, 1, v2
    s_lshl_b32 s34, s33, 6
    s_add_u32 s34, s34, 6946816
    buffer_load_ushort v25, v24, s[4:7], s34 offen offset:32
    buffer_load_ushort v24, v24, s[4:7], s34 offen
    s_lshl_b32 s46, s33, 11
    s_add_u32 s46, s46, s12
    s_add_u32 s46, s46, 16007168
    s_mul_i32 s47, s51, 3
    s_lshl_b32 s34, s32, 1
    s_waitcnt vmcnt(6)
    s_barrier
    s_add_u32 s47, s47, s34
    s_lshl_b32 s47, s47, 17
    s_add_u32 s47, s47, s46
    s_lshr_b32 s34, s51, 2
    s_sub_u32 s34, s51, s34
    s_lshr_b32 s56, s34, 1
    s_add_u32 s56, s56, 24
    s_lshl_b32 s56, s56, 17
    s_add_u32 s46, s46, s56
    s_and_b32 s34, s34, 1
    s_lshl_b32 s34, s34, 9
    s_add_u32 s46, s46, s34
    s_add_u32 s56, s47, 131072
    s_mov_b32 s57, 0xffff0000
    s_mov_b32 s58, 0x3c800000
    s_mov_b32 s59, 0x3c800000
    s_lshl_b32 s30, s31, 11
    v_add_u32 v13, s30, v3
    v_add_u32 v4, 20480, v13
    v_add_u32 v5, 86016, v13
    s_add_u32 s30, s30, 20480
    v_add_u32 v252, s30, v22
    s_lshl_b32 s30, s32, 12
    v_add_u32 v13, s30, v3
    v_add_u32 v6, 106496, v13
    v_mov_b32 v32, 0
    v_mov_b32 v33, 0
    v_mov_b32 v34, 0
    v_mov_b32 v35, 0
    v_mov_b32 v36, 0
    v_mov_b32 v37, 0
    v_mov_b32 v38, 0
    v_mov_b32 v39, 0
    v_mov_b32 v40, 0
    v_mov_b32 v41, 0
    v_mov_b32 v42, 0
    v_mov_b32 v43, 0
    v_mov_b32 v44, 0
    v_mov_b32 v45, 0
    v_mov_b32 v46, 0
    v_mov_b32 v47, 0
    s_mov_b32 s44, 0xbdd2d3e8
    s_mov_b32 s45, 0xbdd2d3e8
    v_mov_b32 v14, 0xc0135761
    v_mov_b32 v15, 0xc0135761
    s_lshl_b32 s34, s32, 8
    s_lshl_b32 s35, s31, 7
    v_lshlrev_b32 v10, 2, v2
    v_add_u32 v8, s34, v10
    v_add_u32 v10, s35, v10
    v_lshlrev_b32 v12, 4, v1
    v_add_u32 v9, s35, v12
    v_add_u32 v12, s34, v12
    s_and_b32 s38, s51, 3
    s_cmp_eq_u32 s38, 3
    s_cselect_b32 s38, 2, 3
    s_cmp_eq_u32 s32, 0
    s_cselect_b32 s38, 4, s38
    s_lshl_b32 s36, s33, 8
    s_mul_i32 s39, s33, 57344
    s_mul_i32 s34, s51, 7168
    s_add_u32 s39, s39, s34
    s_lshl_b32 s34, s32, 12
    s_add_u32 s39, s39, s34
    s_add_u32 s39, s39, s12
    s_add_u32 s39, s39, 12320768
    s_add_u32 s36, s36, s12
    s_add_u32 s36, s36, 15990784
    s_mov_b32 s40, 0xaaaaaaaa
    s_mov_b32 s41, 0xaaaaaaaa
    s_mov_b32 s42, 0xcccccccc
    s_mov_b32 s43, 0xcccccccc
    v_and_b32 v11, 3, v2
    v_lshl_add_u32 v11, v1, 2, v11
    v_bfe_u32 v13, v2, 2, 1
    v_lshl_add_u32 v11, v13, 4, v11
    v_lshlrev_b32 v11, 3, v11
    v_lshrrev_b32 v13, 3, v2
    v_lshl_add_u32 v11, v13, 2, v11
    s_waitcnt vmcnt(0)
    v_pk_add_f32 v[192:193], v[192:193], v[194:195]
    v_pk_add_f32 v[196:197], v[196:197], v[198:199]
    ds_write_b64 v22, v[192:193] offset:1536
    ds_write_b64 v22, v[196:197] offset:2048
    v_lshlrev_b32 v24, 16, v24
    v_lshlrev_b32 v25, 16, v25
    s_waitcnt lgkmcnt(0)
    s_cmp_lg_u32 s13, 3
    s_cbranch_scc1 CPL3a_ok
    s_lshl_b32 s73, s14, 15
    s_add_u32 s73, s73, 6883328
    s_lshl_b32 s72, s50, 7
    s_add_u32 s72, s72, s73
    s_mov_b64 exec, 1
    s_mov_b32 s73, 0
    buffer_load_dword v253, off, s[4:7], s72 sc1
    s_sleep 2
    buffer_load_dword v254, off, s[4:7], s72 sc1
    s_sleep 2
CPL3a:
    buffer_load_dword v255, off, s[4:7], s72 sc1
    s_waitcnt vmcnt(2)
    v_cmp_ne_u32 vcc, 8, v253
    s_nop 1
    s_cmp_eq_u64 vcc, 0
    s_cbranch_scc1 CPL3a_x
    s_sleep 1
    buffer_load_dword v253, off, s[4:7], s72 sc1
    s_waitcnt vmcnt(2)
    v_cmp_ne_u32 vcc, 8, v254
    s_nop 1
    s_cmp_eq_u64 vcc, 0
    s_cbranch_scc1 CPL3a_x
    s_sleep 1
    buffer_load_dword v254, off, s[4:7], s72 sc1
    s_waitcnt vmcnt(2)
    v_cmp_ne_u32 vcc, 8, v255
    s_nop 1
    s_cmp_eq_u64 vcc, 0
    s_cbranch_scc1 CPL3a_x
    s_sleep 1
    s_add_u32 s73, s73, 1
    s_cmp_lt_u32 s73, 0x20000
    s_cbranch_scc1 CPL3a
CPL3a_x:
    s_mov_b64 exec, -1
CPL3a_ok:
    s_barrier
    s_barrier
    ds_read_b128 v[96:99], v4 offset:0
    ds_read_b128 v[104:107], v6 offset:0
    ds_read_b128 v[100:103], v4 offset:1024
    ds_read_b128 v[108:111], v6 offset:1024
    ds_read_b128 v[112:115], v6 offset:2048
    ds_read_b128 v[116:119], v6 offset:3072
    ds_read_b128 v[120:123], v4 offset:4096
    ds_read_b128 v[128:131], v6 offset:7168
    ds_read_b128 v[124:127], v4 offset:5120
    ds_read_b128 v[132:135], v6 offset:8192
    ds_read_b128 v[136:139], v6 offset:9216
    ds_read_b128 v[140:143], v6 offset:10240
    s_waitcnt lgkmcnt(0)
    s_barrier
    v_mfma_f32_16x16x32_bf16 v[64:67], v[96:99], v[104:107], 0
    ds_read_b128 v[144:147], v4 offset:8192
    v_mfma_f32_16x16x32_bf16 v[68:71], v[100:103], v[104:107], 0
    ds_read_b128 v[152:155], v6 offset:14336
    v_mfma_f32_16x16x32_bf16 v[72:75], v[96:99], v[108:111], 0
    ds_read_b128 v[148:151], v4 offset:9216
    v_mfma_f32_16x16x32_bf16 v[76:79], v[100:103], v[108:111], 0
    ds_read_b128 v[156:159], v6 offset:15360
    v_mfma_f32_16x16x32_bf16 v[80:83], v[96:99], v[112:115], 0
    ds_read_b128 v[160:163], v6 offset:16384
    v_mfma_f32_16x16x32_bf16 v[84:87], v[100:103], v[112:115], 0
    ds_read_b128 v[164:167], v6 offset:17408
    v_mfma_f32_16x16x32_bf16 v[88:91], v[96:99], v[116:119], 0
    ds_read_b128 v[168:171], v4 offset:12288
    v_mfma_f32_16x16x32_bf16 v[92:95], v[100:103], v[116:119], 0
    ds_read_b128 v[176:179], v6 offset:21504
    v_mfma_f32_16x16x32_bf16 v[64:67], v[120:123], v[128:131], v[64:67]
    ds_read_b128 v[172:175], v4 offset:13312
    v_mfma_f32_16x16x32_bf16 v[68:71], v[124:127], v[128:131], v[68:71]
    ds_read_b128 v[180:183], v6 offset:22528
    v_mfma_f32_16x16x32_bf16 v[72:75], v[120:123], v[132:135], v[72:75]
    ds_read_b128 v[184:187], v6 offset:23552
    v_mfma_f32_16x16x32_bf16 v[76:79], v[124:127], v[132:135], v[76:79]
    ds_read_b128 v[188:191], v6 offset:24576
    v_mfma_f32_16x16x32_bf16 v[80:83], v[120:123], v[136:139], v[80:83]
    v_mfma_f32_16x16x32_bf16 v[84:87], v[124:127], v[136:139], v[84:87]
    v_mfma_f32_16x16x32_bf16 v[88:91], v[120:123], v[140:143], v[88:91]
    v_mfma_f32_16x16x32_bf16 v[92:95], v[124:127], v[140:143], v[92:95]
    s_waitcnt lgkmcnt(0)
    s_barrier
    v_mfma_f32_16x16x32_bf16 v[64:67], v[144:147], v[152:155], v[64:67]
    ds_read_b128 v[96:99], v4 offset:16384
    v_mfma_f32_16x16x32_bf16 v[68:71], v[148:151], v[152:155], v[68:71]
    ds_read_b128 v[104:107], v6 offset:28672
    v_mfma_f32_16x16x32_bf16 v[72:75], v[144:147], v[156:159], v[72:75]
    ds_read_b128 v[100:103], v4 offset:17408
    v_mfma_f32_16x16x32_bf16 v[76:79], v[148:151], v[156:159], v[76:79]
    ds_read_b128 v[108:111], v6 offset:29696
    v_mfma_f32_16x16x32_bf16 v[80:83], v[144:147], v[160:163], v[80:83]
    ds_read_b128 v[112:115], v6 offset:30720
    v_mfma_f32_16x16x32_bf16 v[84:87], v[148:151], v[160:163], v[84:87]
    ds_read_b128 v[116:119], v6 offset:31744
    v_mfma_f32_16x16x32_bf16 v[88:91], v[144:147], v[164:167], v[88:91]
    ds_read_b128 v[120:123], v4 offset:20480
    v_mfma_f32_16x16x32_bf16 v[92:95], v[148:151], v[164:167], v[92:95]
    ds_read_b128 v[128:131], v6 offset:35840
    v_mfma_f32_16x16x32_bf16 v[64:67], v[168:171], v[176:179], v[64:67]
    ds_read_b128 v[124:127], v4 offset:21504
    v_mfma_f32_16x16x32_bf16 v[68:71], v[172:175], v[176:179], v[68:71]
    ds_read_b128 v[132:135], v6 offset:36864
    v_mfma_f32_16x16x32_bf16 v[72:75], v[168:171], v[180:183], v[72:75]
    ds_read_b128 v[136:139], v6 offset:37888
    v_mfma_f32_16x16x32_bf16 v[76:79], v[172:175], v[180:183], v[76:79]
    ds_read_b128 v[140:143], v6 offset:38912
    v_mfma_f32_16x16x32_bf16 v[80:83], v[168:171], v[184:187], v[80:83]
    v_mfma_f32_16x16x32_bf16 v[84:87], v[172:175], v[184:187], v[84:87]
    v_mfma_f32_16x16x32_bf16 v[88:91], v[168:171], v[188:191], v[88:91]
    v_mfma_f32_16x16x32_bf16 v[92:95], v[172:175], v[188:191], v[92:95]
    s_waitcnt lgkmcnt(0)
    s_barrier
    v_mfma_f32_16x16x32_bf16 v[64:67], v[96:99], v[104:107], v[64:67]
    ds_read_b128 v[144:147], v4 offset:24576
    v_mfma_f32_16x16x32_bf16 v[68:71], v[100:103], v[104:107], v[68:71]
    ds_read_b128 v[152:155], v6 offset:43008
    v_mfma_f32_16x16x32_bf16 v[72:75], v[96:99], v[108:111], v[72:75]
    ds_read_b128 v[148:151], v4 offset:25600
    v_mfma_f32_16x16x32_bf16 v[76:79], v[100:103], v[108:111], v[76:79]
    ds_read_b128 v[156:159], v6 offset:44032
    v_mfma_f32_16x16x32_bf16 v[80:83], v[96:99], v[112:115], v[80:83]
    ds_read_b128 v[160:163], v6 offset:45056
    v_mfma_f32_16x16x32_bf16 v[84:87], v[100:103], v[112:115], v[84:87]
    ds_read_b128 v[164:167], v6 offset:46080
    v_mfma_f32_16x16x32_bf16 v[88:91], v[96:99], v[116:119], v[88:91]
    ds_read_b128 v[168:171], v4 offset:28672
    v_mfma_f32_16x16x32_bf16 v[92:95], v[100:103], v[116:119], v[92:95]
    ds_read_b128 v[176:179], v6 offset:50176
    v_mfma_f32_16x16x32_bf16 v[64:67], v[120:123], v[128:131], v[64:67]
    ds_read_b128 v[172:175], v4 offset:29696
    v_mfma_f32_16x16x32_bf16 v[68:71], v[124:127], v[128:131], v[68:71]
    ds_read_b128 v[180:183], v6 offset:51200
    v_mfma_f32_16x16x32_bf16 v[72:75], v[120:123], v[132:135], v[72:75]
    ds_read_b128 v[184:187], v6 offset:52224
    v_mfma_f32_16x16x32_bf16 v[76:79], v[124:127], v[132:135], v[76:79]
    ds_read_b128 v[188:191], v6 offset:53248
    v_mfma_f32_16x16x32_bf16 v[80:83], v[120:123], v[136:139], v[80:83]
    v_mfma_f32_16x16x32_bf16 v[84:87], v[124:127], v[136:139], v[84:87]
    v_mfma_f32_16x16x32_bf16 v[88:91], v[120:123], v[140:143], v[88:91]
    v_mfma_f32_16x16x32_bf16 v[92:95], v[124:127], v[140:143], v[92:95]
    s_waitcnt lgkmcnt(0)
    s_barrier
    v_mfma_f32_16x16x32_bf16 v[64:67], v[144:147], v[152:155], v[64:67]
    ds_read_b128 v[96:99], v4 offset:32768
    v_mfma_f32_16x16x32_bf16 v[68:71], v[148:151], v[152:155], v[68:71]
    ds_read_b128 v[104:107], v6 offset:0
    v_mfma_f32_16x16x32_bf16 v[72:75], v[144:147], v[156:159], v[72:75]
    ds_read_b128 v[100:103], v4 offset:33792
    v_mfma_f32_16x16x32_bf16 v[76:79], v[148:151], v[156:159], v[76:79]
    ds_read_b128 v[108:111], v6 offset:1024
    v_mfma_f32_16x16x32_bf16 v[80:83], v[144:147], v[160:163], v[80:83]
    ds_read_b128 v[112:115], v6 offset:2048
    v_mfma_f32_16x16x32_bf16 v[84:87], v[148:151], v[160:163], v[84:87]
    ds_read_b128 v[116:119], v6 offset:3072
    v_mfma_f32_16x16x32_bf16 v[88:91], v[144:147], v[164:167], v[88:91]
    ds_read_b128 v[120:123], v4 offset:36864
    v_mfma_f32_16x16x32_bf16 v[92:95], v[148:151], v[164:167], v[92:95]
    ds_read_b128 v[128:131], v6 offset:7168
    v_mfma_f32_16x16x32_bf16 v[64:67], v[168:171], v[176:179], v[64:67]
    ds_read_b128 v[124:127], v4 offset:37888
    v_mfma_f32_16x16x32_bf16 v[68:71], v[172:175], v[176:179], v[68:71]
    ds_read_b128 v[132:135], v6 offset:8192
    v_mfma_f32_16x16x32_bf16 v[72:75], v[168:171], v[180:183], v[72:75]
    ds_read_b128 v[136:139], v6 offset:9216
    v_mfma_f32_16x16x32_bf16 v[76:79], v[172:175], v[180:183], v[76:79]
    ds_read_b128 v[140:143], v6 offset:10240
    v_mfma_f32_16x16x32_bf16 v[80:83], v[168:171], v[184:187], v[80:83]
    v_mfma_f32_16x16x32_bf16 v[84:87], v[172:175], v[184:187], v[84:87]
    v_mfma_f32_16x16x32_bf16 v[88:91], v[168:171], v[188:191], v[88:91]
    v_mfma_f32_16x16x32_bf16 v[92:95], v[172:175], v[188:191], v[92:95]
    s_waitcnt lgkmcnt(0)
    s_barrier
    v_mfma_f32_16x16x32_bf16 v[64:67], v[96:99], v[104:107], v[64:67]
    ds_read_b128 v[144:147], v4 offset:40960
    v_mfma_f32_16x16x32_bf16 v[68:71], v[100:103], v[104:107], v[68:71]
    ds_read_b128 v[152:155], v6 offset:14336
    v_mfma_f32_16x16x32_bf16 v[72:75], v[96:99], v[108:111], v[72:75]
    ds_read_b128 v[148:151], v4 offset:41984
    v_mfma_f32_16x16x32_bf16 v[76:79], v[100:103], v[108:111], v[76:79]
    ds_read_b128 v[156:159], v6 offset:15360
    v_mfma_f32_16x16x32_bf16 v[80:83], v[96:99], v[112:115], v[80:83]
    ds_read_b128 v[160:163], v6 offset:16384
    v_mfma_f32_16x16x32_bf16 v[84:87], v[100:103], v[112:115], v[84:87]
    ds_read_b128 v[164:167], v6 offset:17408
    v_mfma_f32_16x16x32_bf16 v[88:91], v[96:99], v[116:119], v[88:91]
    ds_read_b128 v[168:171], v4 offset:45056
    v_mfma_f32_16x16x32_bf16 v[92:95], v[100:103], v[116:119], v[92:95]
    ds_read_b128 v[176:179], v6 offset:21504
    v_mfma_f32_16x16x32_bf16 v[64:67], v[120:123], v[128:131], v[64:67]
    ds_read_b128 v[172:175], v4 offset:46080
    v_mfma_f32_16x16x32_bf16 v[68:71], v[124:127], v[128:131], v[68:71]
    ds_read_b128 v[180:183], v6 offset:22528
    v_mfma_f32_16x16x32_bf16 v[72:75], v[120:123], v[132:135], v[72:75]
    ds_read_b128 v[184:187], v6 offset:23552
    v_mfma_f32_16x16x32_bf16 v[76:79], v[124:127], v[132:135], v[76:79]
    ds_read_b128 v[188:191], v6 offset:24576
    v_mfma_f32_16x16x32_bf16 v[80:83], v[120:123], v[136:139], v[80:83]
    v_mfma_f32_16x16x32_bf16 v[84:87], v[124:127], v[136:139], v[84:87]
    v_mfma_f32_16x16x32_bf16 v[88:91], v[120:123], v[140:143], v[88:91]
    v_mfma_f32_16x16x32_bf16 v[92:95], v[124:127], v[140:143], v[92:95]
    s_waitcnt lgkmcnt(0)
    s_barrier
    v_mfma_f32_16x16x32_bf16 v[64:67], v[144:147], v[152:155], v[64:67]
    ds_read_b128 v[96:99], v4 offset:49152
    v_mfma_f32_16x16x32_bf16 v[68:71], v[148:151], v[152:155], v[68:71]
    ds_read_b128 v[104:107], v6 offset:28672
    v_mfma_f32_16x16x32_bf16 v[72:75], v[144:147], v[156:159], v[72:75]
    ds_read_b128 v[100:103], v4 offset:50176
    v_mfma_f32_16x16x32_bf16 v[76:79], v[148:151], v[156:159], v[76:79]
    ds_read_b128 v[108:111], v6 offset:29696
    v_mfma_f32_16x16x32_bf16 v[80:83], v[144:147], v[160:163], v[80:83]
    ds_read_b128 v[112:115], v6 offset:30720
    v_mfma_f32_16x16x32_bf16 v[84:87], v[148:151], v[160:163], v[84:87]
    ds_read_b128 v[116:119], v6 offset:31744
    v_mfma_f32_16x16x32_bf16 v[88:91], v[144:147], v[164:167], v[88:91]
    ds_read_b128 v[120:123], v4 offset:53248
    v_mfma_f32_16x16x32_bf16 v[92:95], v[148:151], v[164:167], v[92:95]
    ds_read_b128 v[128:131], v6 offset:35840
    v_mfma_f32_16x16x32_bf16 v[64:67], v[168:171], v[176:179], v[64:67]
    ds_read_b128 v[124:127], v4 offset:54272
    v_mfma_f32_16x16x32_bf16 v[68:71], v[172:175], v[176:179], v[68:71]
    ds_read_b128 v[132:135], v6 offset:36864
    v_mfma_f32_16x16x32_bf16 v[72:75], v[168:171], v[180:183], v[72:75]
    ds_read_b128 v[136:139], v6 offset:37888
    v_mfma_f32_16x16x32_bf16 v[76:79], v[172:175], v[180:183], v[76:79]
    ds_read_b128 v[140:143], v6 offset:38912
    v_mfma_f32_16x16x32_bf16 v[80:83], v[168:171], v[184:187], v[80:83]
    v_mfma_f32_16x16x32_bf16 v[84:87], v[172:175], v[184:187], v[84:87]
    v_mfma_f32_16x16x32_bf16 v[88:91], v[168:171], v[188:191], v[88:91]
    v_mfma_f32_16x16x32_bf16 v[92:95], v[172:175], v[188:191], v[92:95]
    s_waitcnt lgkmcnt(0)
    s_barrier
    v_mfma_f32_16x16x32_bf16 v[64:67], v[96:99], v[104:107], v[64:67]
    ds_read_b128 v[144:147], v4 offset:57344
    v_mfma_f32_16x16x32_bf16 v[68:71], v[100:103], v[104:107], v[68:71]
    ds_read_b128 v[152:155], v6 offset:43008
    v_mfma_f32_16x16x32_bf16 v[72:75], v[96:99], v[108:111], v[72:75]
    ds_read_b128 v[148:151], v4 offset:58368
    v_mfma_f32_16x16x32_bf16 v[76:79], v[100:103], v[108:111], v[76:79]
    ds_read_b128 v[156:159], v6 offset:44032
    v_mfma_f32_16x16x32_bf16 v[80:83], v[96:99], v[112:115], v[80:83]
    ds_read_b128 v[160:163], v6 offset:45056
    v_mfma_f32_16x16x32_bf16 v[84:87], v[100:103], v[112:115], v[84:87]
    ds_read_b128 v[164:167], v6 offset:46080
    v_mfma_f32_16x16x32_bf16 v[88:91], v[96:99], v[116:119], v[88:91]
    ds_read_b128 v[168:171], v4 offset:61440
    v_mfma_f32_16x16x32_bf16 v[92:95], v[100:103], v[116:119], v[92:95]
    ds_read_b128 v[176:179], v6 offset:50176
    v_mfma_f32_16x16x32_bf16 v[64:67], v[120:123], v[128:131], v[64:67]
    ds_read_b128 v[172:175], v4 offset:62464
    v_mfma_f32_16x16x32_bf16 v[68:71], v[124:127], v[128:131], v[68:71]
    ds_read_b128 v[180:183], v6 offset:51200
    v_mfma_f32_16x16x32_bf16 v[72:75], v[120:123], v[132:135], v[72:75]
    ds_read_b128 v[184:187], v6 offset:52224
    v_mfma_f32_16x16x32_bf16 v[76:79], v[124:127], v[132:135], v[76:79]
    ds_read_b128 v[188:191], v6 offset:53248
    v_mfma_f32_16x16x32_bf16 v[80:83], v[120:123], v[136:139], v[80:83]
    v_mfma_f32_16x16x32_bf16 v[84:87], v[124:127], v[136:139], v[84:87]
    v_mfma_f32_16x16x32_bf16 v[88:91], v[120:123], v[140:143], v[88:91]
    v_mfma_f32_16x16x32_bf16 v[92:95], v[124:127], v[140:143], v[92:95]
    s_waitcnt lgkmcnt(0)
    s_barrier
    v_mfma_f32_16x16x32_bf16 v[64:67], v[144:147], v[152:155], v[64:67]
    ds_read2st64_b64 v[96:99], v252 offset0:128 offset1:129
    v_mfma_f32_16x16x32_bf16 v[68:71], v[148:151], v[152:155], v[68:71]
    ds_read_b128 v[104:107], v6 offset:0
    v_mfma_f32_16x16x32_bf16 v[72:75], v[144:147], v[156:159], v[72:75]
    ds_read2st64_b64 v[100:103], v252 offset0:130 offset1:131
    v_mfma_f32_16x16x32_bf16 v[76:79], v[148:151], v[156:159], v[76:79]
    ds_read_b128 v[108:111], v6 offset:1024
    v_mfma_f32_16x16x32_bf16 v[80:83], v[144:147], v[160:163], v[80:83]
    ds_read_b128 v[112:115], v6 offset:2048
    v_mfma_f32_16x16x32_bf16 v[84:87], v[148:151], v[160:163], v[84:87]
    ds_read_b128 v[116:119], v6 offset:3072
    v_mfma_f32_16x16x32_bf16 v[88:91], v[144:147], v[164:167], v[88:91]
    ds_read2st64_b64 v[120:123], v252 offset0:136 offset1:137
    v_mfma_f32_16x16x32_bf16 v[92:95], v[148:151], v[164:167], v[92:95]
    ds_read_b128 v[128:131], v6 offset:7168
    v_mfma_f32_16x16x32_bf16 v[64:67], v[168:171], v[176:179], v[64:67]
    ds_read2st64_b64 v[124:127], v252 offset0:138 offset1:139
    v_mfma_f32_16x16x32_bf16 v[68:71], v[172:175], v[176:179], v[68:71]
    ds_read_b128 v[132:135], v6 offset:8192
    v_mfma_f32_16x16x32_bf16 v[72:75], v[168:171], v[180:183], v[72:75]
    ds_read_b128 v[136:139], v6 offset:9216
    v_mfma_f32_16x16x32_bf16 v[76:79], v[172:175], v[180:183], v[76:79]
    ds_read_b128 v[140:143], v6 offset:10240
    v_mfma_f32_16x16x32_bf16 v[80:83], v[168:171], v[184:187], v[80:83]
    v_mfma_f32_16x16x32_bf16 v[84:87], v[172:175], v[184:187], v[84:87]
    v_mfma_f32_16x16x32_bf16 v[88:91], v[168:171], v[188:191], v[88:91]
    v_mfma_f32_16x16x32_bf16 v[92:95], v[172:175], v[188:191], v[92:95]
    s_waitcnt lgkmcnt(0)
    s_barrier
    v_mfma_f32_16x16x32_bf16 v[64:67], v[96:99], v[104:107], v[64:67]
    ds_read2st64_b64 v[144:147], v252 offset0:144 offset1:145
    v_mfma_f32_16x16x32_bf16 v[68:71], v[100:103], v[104:107], v[68:71]
    ds_read_b128 v[152:155], v6 offset:14336
    v_mfma_f32_16x16x32_bf16 v[72:75], v[96:99], v[108:111], v[72:75]
    ds_read2st64_b64 v[148:151], v252 offset0:146 offset1:147
    v_mfma_f32_16x16x32_bf16 v[76:79], v[100:103], v[108:111], v[76:79]
    ds_read_b128 v[156:159], v6 offset:15360
    v_mfma_f32_16x16x32_bf16 v[80:83], v[96:99], v[112:115], v[80:83]
    ds_read_b128 v[160:163], v6 offset:16384
    v_mfma_f32_16x16x32_bf16 v[84:87], v[100:103], v[112:115], v[84:87]
    ds_read_b128 v[164:167], v6 offset:17408
    v_mfma_f32_16x16x32_bf16 v[88:91], v[96:99], v[116:119], v[88:91]
    ds_read2st64_b64 v[168:171], v252 offset0:152 offset1:153
    v_mfma_f32_16x16x32_bf16 v[92:95], v[100:103], v[116:119], v[92:95]
    ds_read_b128 v[176:179], v6 offset:21504
    v_mfma_f32_16x16x32_bf16 v[64:67], v[120:123], v[128:131], v[64:67]
    ds_read2st64_b64 v[172:175], v252 offset0:154 offset1:155
    v_mfma_f32_16x16x32_bf16 v[68:71], v[124:127], v[128:131], v[68:71]
    ds_read_b128 v[180:183], v6 offset:22528
    v_mfma_f32_16x16x32_bf16 v[72:75], v[120:123], v[132:135], v[72:75]
    ds_read_b128 v[184:187], v6 offset:23552
    v_mfma_f32_16x16x32_bf16 v[76:79], v[124:127], v[132:135], v[76:79]
    ds_read_b128 v[188:191], v6 offset:24576
    v_mfma_f32_16x16x32_bf16 v[80:83], v[120:123], v[136:139], v[80:83]
    v_mfma_f32_16x16x32_bf16 v[84:87], v[124:127], v[136:139], v[84:87]
    v_mfma_f32_16x16x32_bf16 v[88:91], v[120:123], v[140:143], v[88:91]
    v_mfma_f32_16x16x32_bf16 v[92:95], v[124:127], v[140:143], v[92:95]
    s_waitcnt lgkmcnt(10)
    v_mfma_f32_16x16x32_bf16 v[64:67], v[144:147], v[152:155], v[64:67]
    ds_read_b128 v[192:195], v9 offset:0
    s_waitcnt lgkmcnt(10)
    v_mfma_f32_16x16x32_bf16 v[68:71], v[148:151], v[152:155], v[68:71]
    ds_read_b128 v[200:203], v9 offset:768
    s_waitcnt lgkmcnt(10)
    v_mfma_f32_16x16x32_bf16 v[72:75], v[144:147], v[156:159], v[72:75]
    ds_read_b128 v[196:199], v9 offset:64
    v_mfma_f32_16x16x32_bf16 v[76:79], v[148:151], v[156:159], v[76:79]
    ds_read_b128 v[204:207], v9 offset:832
    s_waitcnt lgkmcnt(11)
    v_mfma_f32_16x16x32_bf16 v[80:83], v[144:147], v[160:163], v[80:83]
    ds_read_b32 v208, v8 offset:2048
    v_mfma_f32_16x16x32_bf16 v[84:87], v[148:151], v[160:163], v[84:87]
    ds_read_b32 v209, v8 offset:2112
    s_waitcnt lgkmcnt(12)
    v_mfma_f32_16x16x32_bf16 v[88:91], v[144:147], v[164:167], v[88:91]
    ds_read_b32 v210, v8 offset:2176
    v_mfma_f32_16x16x32_bf16 v[92:95], v[148:151], v[164:167], v[92:95]
    ds_read_b32 v211, v8 offset:2240
    s_waitcnt lgkmcnt(12)
    v_mfma_f32_16x16x32_bf16 v[64:67], v[168:171], v[176:179], v[64:67]
    s_waitcnt lgkmcnt(11)
    v_mfma_f32_16x16x32_bf16 v[68:71], v[172:175], v[176:179], v[68:71]
    s_waitcnt lgkmcnt(10)
    v_mfma_f32_16x16x32_bf16 v[72:75], v[168:171], v[180:183], v[72:75]
    v_mfma_f32_16x16x32_bf16 v[76:79], v[172:175], v[180:183], v[76:79]
    s_waitcnt lgkmcnt(9)
    v_mfma_f32_16x16x32_bf16 v[80:83], v[168:171], v[184:187], v[80:83]
    v_mfma_f32_16x16x32_bf16 v[84:87], v[172:175], v[184:187], v[84:87]
    s_waitcnt lgkmcnt(8)
    v_mfma_f32_16x16x32_bf16 v[88:91], v[168:171], v[188:191], v[88:91]
    v_mfma_f32_16x16x32_bf16 v[92:95], v[172:175], v[188:191], v[92:95]
    s_barrier
    s_waitcnt lgkmcnt(0)
    v_pk_mul_f32 v[232:233], v[200:201], v[208:209] op_sel:[0,0] op_sel_hi:[1,0]
    v_pk_mul_f32 v[234:235], v[202:203], v[208:209] op_sel:[0,0] op_sel_hi:[1,0]
    v_pk_fma_f32 v[64:65], v[64:65], v[192:193], v[232:233]
    v_pk_fma_f32 v[66:67], v[66:67], v[194:195], v[234:235]
    v_pk_mul_f32 v[236:237], v[204:205], v[208:209] op_sel:[0,0] op_sel_hi:[1,0]
    v_pk_mul_f32 v[238:239], v[206:207], v[208:209] op_sel:[0,0] op_sel_hi:[1,0]
    v_pk_fma_f32 v[68:69], v[68:69], v[196:197], v[236:237]
    v_pk_fma_f32 v[70:71], v[70:71], v[198:199], v[238:239]
    v_pk_mul_f32 v[232:233], v[64:65], v[64:65]
    v_pk_mul_f32 v[234:235], v[66:67], v[66:67]
    v_pk_mul_f32 v[236:237], v[68:69], v[68:69]
    v_pk_mul_f32 v[238:239], v[70:71], v[70:71]
    v_pk_fma_f32 v[232:233], v[232:233], s[44:45], v[14:15]
    v_pk_fma_f32 v[234:235], v[234:235], s[44:45], v[14:15]
    v_pk_fma_f32 v[236:237], v[236:237], s[44:45], v[14:15]
    v_pk_fma_f32 v[238:239], v[238:239], s[44:45], v[14:15]
    v_pk_mul_f32 v[232:233], v[232:233], v[64:65]
    v_pk_mul_f32 v[234:235], v[234:235], v[66:67]
    v_pk_mul_f32 v[236:237], v[236:237], v[68:69]
    v_pk_mul_f32 v[238:239], v[238:239], v[70:71]
    v_exp_f32 v232, v232
    v_exp_f32 v233, v233
    v_exp_f32 v234, v234
    v_exp_f32 v235, v235
    v_exp_f32 v236, v236
    v_exp_f32 v237, v237
    v_exp_f32 v238, v238
    v_exp_f32 v239, v239
    v_pk_add_f32 v[232:233], v[232:233], 1.0 op_sel_hi:[1,0]
    v_pk_add_f32 v[234:235], v[234:235], 1.0 op_sel_hi:[1,0]
    v_pk_add_f32 v[236:237], v[236:237], 1.0 op_sel_hi:[1,0]
    v_pk_add_f32 v[238:239], v[238:239], 1.0 op_sel_hi:[1,0]
    v_rcp_f32 v232, v232
    v_rcp_f32 v233, v233
    v_rcp_f32 v234, v234
    v_rcp_f32 v235, v235
    v_rcp_f32 v236, v236
    v_rcp_f32 v237, v237
    v_rcp_f32 v238, v238
    v_rcp_f32 v239, v239
    v_pk_mul_f32 v[64:65], v[64:65], v[232:233]
    v_pk_mul_f32 v[66:67], v[66:67], v[234:235]
    v_pk_mul_f32 v[68:69], v[68:69], v[236:237]
    v_pk_mul_f32 v[70:71], v[70:71], v[238:239]
    v_cvt_pk_f16_f32 v216, v64, v65
    v_cvt_pk_f16_f32 v217, v66, v67
    v_cvt_pk_f16_f32 v218, v68, v69
    v_cvt_pk_f16_f32 v219, v70, v71
    buffer_store_dwordx4 v[216:219], v3, s[4:7], s39 offen offset:0 sc1
    v_pk_add_f32 v[32:33], v[32:33], v[64:65]
    v_pk_fma_f32 v[40:41], v[64:65], v[64:65], v[40:41]
    v_pk_add_f32 v[34:35], v[34:35], v[66:67]
    v_pk_fma_f32 v[42:43], v[66:67], v[66:67], v[42:43]
    v_pk_add_f32 v[36:37], v[36:37], v[68:69]
    v_pk_fma_f32 v[44:45], v[68:69], v[68:69], v[44:45]
    v_pk_add_f32 v[38:39], v[38:39], v[70:71]
    v_pk_fma_f32 v[46:47], v[70:71], v[70:71], v[46:47]
    v_pk_mul_f32 v[232:233], v[200:201], v[208:209] op_sel:[0,1] op_sel_hi:[1,1]
    v_pk_mul_f32 v[234:235], v[202:203], v[208:209] op_sel:[0,1] op_sel_hi:[1,1]
    v_pk_fma_f32 v[72:73], v[72:73], v[192:193], v[232:233]
    v_pk_fma_f32 v[74:75], v[74:75], v[194:195], v[234:235]
    v_pk_mul_f32 v[236:237], v[204:205], v[208:209] op_sel:[0,1] op_sel_hi:[1,1]
    v_pk_mul_f32 v[238:239], v[206:207], v[208:209] op_sel:[0,1] op_sel_hi:[1,1]
    v_pk_fma_f32 v[76:77], v[76:77], v[196:197], v[236:237]
    v_pk_fma_f32 v[78:79], v[78:79], v[198:199], v[238:239]
    v_pk_mul_f32 v[232:233], v[72:73], v[72:73]
    v_pk_mul_f32 v[234:235], v[74:75], v[74:75]
    v_pk_mul_f32 v[236:237], v[76:77], v[76:77]
    v_pk_mul_f32 v[238:239], v[78:79], v[78:79]
    v_pk_fma_f32 v[232:233], v[232:233], s[44:45], v[14:15]
    v_pk_fma_f32 v[234:235], v[234:235], s[44:45], v[14:15]
    v_pk_fma_f32 v[236:237], v[236:237], s[44:45], v[14:15]
    v_pk_fma_f32 v[238:239], v[238:239], s[44:45], v[14:15]
    v_pk_mul_f32 v[232:233], v[232:233], v[72:73]
    v_pk_mul_f32 v[234:235], v[234:235], v[74:75]
    v_pk_mul_f32 v[236:237], v[236:237], v[76:77]
    v_pk_mul_f32 v[238:239], v[238:239], v[78:79]
    v_exp_f32 v232, v232
    v_exp_f32 v233, v233
    v_exp_f32 v234, v234
    v_exp_f32 v235, v235
    v_exp_f32 v236, v236
    v_exp_f32 v237, v237
    v_exp_f32 v238, v238
    v_exp_f32 v239, v239
    v_pk_add_f32 v[232:233], v[232:233], 1.0 op_sel_hi:[1,0]
    v_pk_add_f32 v[234:235], v[234:235], 1.0 op_sel_hi:[1,0]
    v_pk_add_f32 v[236:237], v[236:237], 1.0 op_sel_hi:[1,0]
    v_pk_add_f32 v[238:239], v[238:239], 1.0 op_sel_hi:[1,0]
    v_rcp_f32 v232, v232
    v_rcp_f32 v233, v233
    v_rcp_f32 v234, v234
    v_rcp_f32 v235, v235
    v_rcp_f32 v236, v236
    v_rcp_f32 v237, v237
    v_rcp_f32 v238, v238
    v_rcp_f32 v239, v239
    v_pk_mul_f32 v[72:73], v[72:73], v[232:233]
    v_pk_mul_f32 v[74:75], v[74:75], v[234:235]
    v_pk_mul_f32 v[76:77], v[76:77], v[236:237]
    v_pk_mul_f32 v[78:79], v[78:79], v[238:239]
    v_cvt_pk_f16_f32 v220, v72, v73
    v_cvt_pk_f16_f32 v221, v74, v75
    v_cvt_pk_f16_f32 v222, v76, v77
    v_cvt_pk_f16_f32 v223, v78, v79
    buffer_store_dwordx4 v[220:223], v3, s[4:7], s39 offen offset:1024 sc1
    v_pk_add_f32 v[32:33], v[32:33], v[72:73]
    v_pk_fma_f32 v[40:41], v[72:73], v[72:73], v[40:41]
    v_pk_add_f32 v[34:35], v[34:35], v[74:75]
    v_pk_fma_f32 v[42:43], v[74:75], v[74:75], v[42:43]
    v_pk_add_f32 v[36:37], v[36:37], v[76:77]
    v_pk_fma_f32 v[44:45], v[76:77], v[76:77], v[44:45]
    v_pk_add_f32 v[38:39], v[38:39], v[78:79]
    v_pk_fma_f32 v[46:47], v[78:79], v[78:79], v[46:47]
    s_cmp_eq_u32 s38, 2
    s_cbranch_scc1 P3_red
    v_pk_mul_f32 v[232:233], v[200:201], v[210:211] op_sel:[0,0] op_sel_hi:[1,0]
    v_pk_mul_f32 v[234:235], v[202:203], v[210:211] op_sel:[0,0] op_sel_hi:[1,0]
    v_pk_fma_f32 v[80:81], v[80:81], v[192:193], v[232:233]
    v_pk_fma_f32 v[82:83], v[82:83], v[194:195], v[234:235]
    v_pk_mul_f32 v[236:237], v[204:205], v[210:211] op_sel:[0,0] op_sel_hi:[1,0]
    v_pk_mul_f32 v[238:239], v[206:207], v[210:211] op_sel:[0,0] op_sel_hi:[1,0]
    v_pk_fma_f32 v[84:85], v[84:85], v[196:197], v[236:237]
    v_pk_fma_f32 v[86:87], v[86:87], v[198:199], v[238:239]
    v_pk_mul_f32 v[232:233], v[80:81], v[80:81]
    v_pk_mul_f32 v[234:235], v[82:83], v[82:83]
    v_pk_mul_f32 v[236:237], v[84:85], v[84:85]
    v_pk_mul_f32 v[238:239], v[86:87], v[86:87]
    v_pk_fma_f32 v[232:233], v[232:233], s[44:45], v[14:15]
    v_pk_fma_f32 v[234:235], v[234:235], s[44:45], v[14:15]
    v_pk_fma_f32 v[236:237], v[236:237], s[44:45], v[14:15]
    v_pk_fma_f32 v[238:239], v[238:239], s[44:45], v[14:15]
    v_pk_mul_f32 v[232:233], v[232:233], v[80:81]
    v_pk_mul_f32 v[234:235], v[234:235], v[82:83]
    v_pk_mul_f32 v[236:237], v[236:237], v[84:85]
    v_pk_mul_f32 v[238:239], v[238:239], v[86:87]
    v_exp_f32 v232, v232
    v_exp_f32 v233, v233
    v_exp_f32 v234, v234
    v_exp_f32 v235, v235
    v_exp_f32 v236, v236
    v_exp_f32 v237, v237
    v_exp_f32 v238, v238
    v_exp_f32 v239, v239
    v_pk_add_f32 v[232:233], v[232:233], 1.0 op_sel_hi:[1,0]
    v_pk_add_f32 v[234:235], v[234:235], 1.0 op_sel_hi:[1,0]
    v_pk_add_f32 v[236:237], v[236:237], 1.0 op_sel_hi:[1,0]
    v_pk_add_f32 v[238:239], v[238:239], 1.0 op_sel_hi:[1,0]
    v_rcp_f32 v232, v232
    v_rcp_f32 v233, v233
    v_rcp_f32 v234, v234
    v_rcp_f32 v235, v235
    v_rcp_f32 v236, v236
    v_rcp_f32 v237, v237
    v_rcp_f32 v238, v238
    v_rcp_f32 v239, v239
    v_pk_mul_f32 v[80:81], v[80:81], v[232:233]
    v_pk_mul_f32 v[82:83], v[82:83], v[234:235]
    v_pk_mul_f32 v[84:85], v[84:85], v[236:237]
    v_pk_mul_f32 v[86:87], v[86:87], v[238:239]
    v_cvt_pk_f16_f32 v224, v80, v81
    v_cvt_pk_f16_f32 v225, v82, v83
    v_cvt_pk_f16_f32 v226, v84, v85
    v_cvt_pk_f16_f32 v227, v86, v87
    buffer_store_dwordx4 v[224:227], v3, s[4:7], s39 offen offset:2048 sc1
    v_pk_add_f32 v[32:33], v[32:33], v[80:81]
    v_pk_fma_f32 v[40:41], v[80:81], v[80:81], v[40:41]
    v_pk_add_f32 v[34:35], v[34:35], v[82:83]
    v_pk_fma_f32 v[42:43], v[82:83], v[82:83], v[42:43]
    v_pk_add_f32 v[36:37], v[36:37], v[84:85]
    v_pk_fma_f32 v[44:45], v[84:85], v[84:85], v[44:45]
    v_pk_add_f32 v[38:39], v[38:39], v[86:87]
    v_pk_fma_f32 v[46:47], v[86:87], v[86:87], v[46:47]
    s_cmp_eq_u32 s38, 3
    s_cbranch_scc1 P3_red
    v_pk_mul_f32 v[232:233], v[200:201], v[210:211] op_sel:[0,1] op_sel_hi:[1,1]
    v_pk_mul_f32 v[234:235], v[202:203], v[210:211] op_sel:[0,1] op_sel_hi:[1,1]
    v_pk_fma_f32 v[88:89], v[88:89], v[192:193], v[232:233]
    v_pk_fma_f32 v[90:91], v[90:91], v[194:195], v[234:235]
    v_pk_mul_f32 v[236:237], v[204:205], v[210:211] op_sel:[0,1] op_sel_hi:[1,1]
    v_pk_mul_f32 v[238:239], v[206:207], v[210:211] op_sel:[0,1] op_sel_hi:[1,1]
    v_pk_fma_f32 v[92:93], v[92:93], v[196:197], v[236:237]
    v_pk_fma_f32 v[94:95], v[94:95], v[198:199], v[238:239]
    v_pk_mul_f32 v[232:233], v[88:89], v[88:89]
    v_pk_mul_f32 v[234:235], v[90:91], v[90:91]
    v_pk_mul_f32 v[236:237], v[92:93], v[92:93]
    v_pk_mul_f32 v[238:239], v[94:95], v[94:95]
    v_pk_fma_f32 v[232:233], v[232:233], s[44:45], v[14:15]
    v_pk_fma_f32 v[234:235], v[234:235], s[44:45], v[14:15]
    v_pk_fma_f32 v[236:237], v[236:237], s[44:45], v[14:15]
    v_pk_fma_f32 v[238:239], v[238:239], s[44:45], v[14:15]
    v_pk_mul_f32 v[232:233], v[232:233], v[88:89]
    v_pk_mul_f32 v[234:235], v[234:235], v[90:91]
    v_pk_mul_f32 v[236:237], v[236:237], v[92:93]
    v_pk_mul_f32 v[238:239], v[238:239], v[94:95]
    v_exp_f32 v232, v232
    v_exp_f32 v233, v233
    v_exp_f32 v234, v234
    v_exp_f32 v235, v235
    v_exp_f32 v236, v236
    v_exp_f32 v237, v237
    v_exp_f32 v238, v238
    v_exp_f32 v239, v239
    v_pk_add_f32 v[232:233], v[232:233], 1.0 op_sel_hi:[1,0]
    v_pk_add_f32 v[234:235], v[234:235], 1.0 op_sel_hi:[1,0]
    v_pk_add_f32 v[236:237], v[236:237], 1.0 op_sel_hi:[1,0]
    v_pk_add_f32 v[238:239], v[238:239], 1.0 op_sel_hi:[1,0]
    v_rcp_f32 v232, v232
    v_rcp_f32 v233, v233
    v_rcp_f32 v234, v234
    v_rcp_f32 v235, v235
    v_rcp_f32 v236, v236
    v_rcp_f32 v237, v237
    v_rcp_f32 v238, v238
    v_rcp_f32 v239, v239
    v_pk_mul_f32 v[88:89], v[88:89], v[232:233]
    v_pk_mul_f32 v[90:91], v[90:91], v[234:235]
    v_pk_mul_f32 v[92:93], v[92:93], v[236:237]
    v_pk_mul_f32 v[94:95], v[94:95], v[238:239]
    v_cvt_pk_f16_f32 v228, v88, v89
    v_cvt_pk_f16_f32 v229, v90, v91
    v_cvt_pk_f16_f32 v230, v92, v93
    v_cvt_pk_f16_f32 v231, v94, v95
    buffer_store_dwordx4 v[228:231], v3, s[4:7], s39 offen offset:3072 sc1
    v_pk_add_f32 v[32:33], v[32:33], v[88:89]
    v_pk_fma_f32 v[40:41], v[88:89], v[88:89], v[40:41]
    v_pk_add_f32 v[34:35], v[34:35], v[90:91]
    v_pk_fma_f32 v[42:43], v[90:91], v[90:91], v[42:43]
    v_pk_add_f32 v[36:37], v[36:37], v[92:93]
    v_pk_fma_f32 v[44:45], v[92:93], v[92:93], v[44:45]
    v_pk_add_f32 v[38:39], v[38:39], v[94:95]
    v_pk_fma_f32 v[46:47], v[94:95], v[94:95], v[46:47]
P3_red:
    s_nop 1
    v_add_f32_dpp v64, v32, v32 row_ror:8 row_mask:0xf bank_mask:0x3
    v_add_f32_dpp v65, v33, v33 row_ror:8 row_mask:0xf bank_mask:0x3
    v_add_f32_dpp v66, v34, v34 row_ror:8 row_mask:0xf bank_mask:0x3
    v_add_f32_dpp v67, v35, v35 row_ror:8 row_mask:0xf bank_mask:0x3
    v_add_f32_dpp v68, v36, v36 row_ror:8 row_mask:0xf bank_mask:0x3
    v_add_f32_dpp v69, v37, v37 row_ror:8 row_mask:0xf bank_mask:0x3
    v_add_f32_dpp v70, v38, v38 row_ror:8 row_mask:0xf bank_mask:0x3
    v_add_f32_dpp v71, v39, v39 row_ror:8 row_mask:0xf bank_mask:0x3
    v_add_f32_dpp v64, v40, v40 row_ror:8 row_mask:0xf bank_mask:0xc
    v_add_f32_dpp v65, v41, v41 row_ror:8 row_mask:0xf bank_mask:0xc
    v_add_f32_dpp v66, v42, v42 row_ror:8 row_mask:0xf bank_mask:0xc
    v_add_f32_dpp v67, v43, v43 row_ror:8 row_mask:0xf bank_mask:0xc
    v_add_f32_dpp v68, v44, v44 row_ror:8 row_mask:0xf bank_mask:0xc
    v_add_f32_dpp v69, v45, v45 row_ror:8 row_mask:0xf bank_mask:0xc
    v_add_f32_dpp v70, v46, v46 row_ror:8 row_mask:0xf bank_mask:0xc
    v_add_f32_dpp v71, v47, v47 row_ror:8 row_mask:0xf bank_mask:0xc
    v_add_f32_dpp v72, v64, v64 row_half_mirror row_mask:0xf bank_mask:0x5
    v_add_f32_dpp v73, v65, v65 row_half_mirror row_mask:0xf bank_mask:0x5
    v_add_f32_dpp v74, v66, v66 row_half_mirror row_mask:0xf bank_mask:0x5
    v_add_f32_dpp v75, v67, v67 row_half_mirror row_mask:0xf bank_mask:0x5
    v_add_f32_dpp v72, v68, v68 row_half_mirror row_mask:0xf bank_mask:0xa
    v_add_f32_dpp v73, v69, v69 row_half_mirror row_mask:0xf bank_mask:0xa
    v_add_f32_dpp v74, v70, v70 row_half_mirror row_mask:0xf bank_mask:0xa
    v_add_f32_dpp v75, v71, v71 row_half_mirror row_mask:0xf bank_mask:0xa
    v_add_f32_dpp v72, v72, v72 quad_perm:[1,0,3,2] row_mask:0xf bank_mask:0xf
    v_add_f32_dpp v73, v73, v73 quad_perm:[1,0,3,2] row_mask:0xf bank_mask:0xf
    v_add_f32_dpp v74, v74, v74 quad_perm:[1,0,3,2] row_mask:0xf bank_mask:0xf
    v_add_f32_dpp v75, v75, v75 quad_perm:[1,0,3,2] row_mask:0xf bank_mask:0xf
    v_add_f32_dpp v72, v72, v72 quad_perm:[2,3,0,1] row_mask:0xf bank_mask:0xf
    v_add_f32_dpp v73, v73, v73 quad_perm:[2,3,0,1] row_mask:0xf bank_mask:0xf
    v_add_f32_dpp v74, v74, v74 quad_perm:[2,3,0,1] row_mask:0xf bank_mask:0xf
    v_add_f32_dpp v75, v75, v75 quad_perm:[2,3,0,1] row_mask:0xf bank_mask:0xf
    v_cndmask_b32 v64, v72, v73, s[40:41]
    v_cndmask_b32 v65, v74, v75, s[40:41]
    v_cndmask_b32 v64, v64, v65, s[42:43]
    buffer_atomic_add_f32 v64, v11, s[4:7], s36 offen
    s_barrier
    ds_read_b128 v[96:99], v4 offset:0
    ds_read_b128 v[104:107], v6 offset:28672
    ds_read_b128 v[100:103], v4 offset:1024
    ds_read_b128 v[108:111], v6 offset:29696
    ds_read_b128 v[112:115], v6 offset:30720
    ds_read_b128 v[116:119], v6 offset:31744
    ds_read_b128 v[120:123], v4 offset:4096
    ds_read_b128 v[128:131], v6 offset:35840
    ds_read_b128 v[124:127], v4 offset:5120
    ds_read_b128 v[132:135], v6 offset:36864
    ds_read_b128 v[136:139], v6 offset:37888
    ds_read_b128 v[140:143], v6 offset:38912
    s_waitcnt lgkmcnt(0)
    s_barrier
    v_mfma_f32_16x16x32_bf16 v[64:67], v[104:107], v[96:99], 0
    ds_read_b128 v[144:147], v4 offset:8192
    v_mfma_f32_16x16x32_bf16 v[68:71], v[104:107], v[100:103], 0
    ds_read_b128 v[152:155], v6 offset:43008
    v_mfma_f32_16x16x32_bf16 v[72:75], v[108:111], v[96:99], 0
    ds_read_b128 v[148:151], v4 offset:9216
    v_mfma_f32_16x16x32_bf16 v[76:79], v[108:111], v[100:103], 0
    ds_read_b128 v[156:159], v6 offset:44032
    v_mfma_f32_16x16x32_bf16 v[80:83], v[112:115], v[96:99], 0
    ds_read_b128 v[160:163], v6 offset:45056
    v_mfma_f32_16x16x32_bf16 v[84:87], v[112:115], v[100:103], 0
    ds_read_b128 v[164:167], v6 offset:46080
    v_mfma_f32_16x16x32_bf16 v[88:91], v[116:119], v[96:99], 0
    ds_read_b128 v[168:171], v4 offset:12288
    v_mfma_f32_16x16x32_bf16 v[92:95], v[116:119], v[100:103], 0
    ds_read_b128 v[176:179], v6 offset:50176
    v_mfma_f32_16x16x32_bf16 v[64:67], v[128:131], v[120:123], v[64:67]
    ds_read_b128 v[172:175], v4 offset:13312
    v_mfma_f32_16x16x32_bf16 v[68:71], v[128:131], v[124:127], v[68:71]
    ds_read_b128 v[180:183], v6 offset:51200
    v_mfma_f32_16x16x32_bf16 v[72:75], v[132:135], v[120:123], v[72:75]
    ds_read_b128 v[184:187], v6 offset:52224
    v_mfma_f32_16x16x32_bf16 v[76:79], v[132:135], v[124:127], v[76:79]
    ds_read_b128 v[188:191], v6 offset:53248
    v_mfma_f32_16x16x32_bf16 v[80:83], v[136:139], v[120:123], v[80:83]
    v_mfma_f32_16x16x32_bf16 v[84:87], v[136:139], v[124:127], v[84:87]
    v_mfma_f32_16x16x32_bf16 v[88:91], v[140:143], v[120:123], v[88:91]
    v_mfma_f32_16x16x32_bf16 v[92:95], v[140:143], v[124:127], v[92:95]
    s_waitcnt lgkmcnt(0)
    s_waitcnt vmcnt(0)
    s_barrier
    v_mfma_f32_16x16x32_bf16 v[64:67], v[152:155], v[144:147], v[64:67]
    ds_read_b128 v[96:99], v4 offset:16384
    v_mfma_f32_16x16x32_bf16 v[68:71], v[152:155], v[148:151], v[68:71]
    ds_read_b128 v[104:107], v6 offset:0
    v_mfma_f32_16x16x32_bf16 v[72:75], v[156:159], v[144:147], v[72:75]
    ds_read_b128 v[100:103], v4 offset:17408
    v_mfma_f32_16x16x32_bf16 v[76:79], v[156:159], v[148:151], v[76:79]
    ds_read_b128 v[108:111], v6 offset:1024
    v_mfma_f32_16x16x32_bf16 v[80:83], v[160:163], v[144:147], v[80:83]
    ds_read_b128 v[112:115], v6 offset:2048
    v_mfma_f32_16x16x32_bf16 v[84:87], v[160:163], v[148:151], v[84:87]
    ds_read_b128 v[116:119], v6 offset:3072
    v_mfma_f32_16x16x32_bf16 v[88:91], v[164:167], v[144:147], v[88:91]
    ds_read_b128 v[120:123], v4 offset:20480
    v_mfma_f32_16x16x32_bf16 v[92:95], v[164:167], v[148:151], v[92:95]
    ds_read_b128 v[128:131], v6 offset:7168
    v_mfma_f32_16x16x32_bf16 v[64:67], v[176:179], v[168:171], v[64:67]
    ds_read_b128 v[124:127], v4 offset:21504
    v_mfma_f32_16x16x32_bf16 v[68:71], v[176:179], v[172:175], v[68:71]
    ds_read_b128 v[132:135], v6 offset:8192
    v_mfma_f32_16x16x32_bf16 v[72:75], v[180:183], v[168:171], v[72:75]
    ds_read_b128 v[136:139], v6 offset:9216
    v_mfma_f32_16x16x32_bf16 v[76:79], v[180:183], v[172:175], v[76:79]
    ds_read_b128 v[140:143], v6 offset:10240
    v_mfma_f32_16x16x32_bf16 v[80:83], v[184:187], v[168:171], v[80:83]
    v_mfma_f32_16x16x32_bf16 v[84:87], v[184:187], v[172:175], v[84:87]
    v_mfma_f32_16x16x32_bf16 v[88:91], v[188:191], v[168:171], v[88:91]
    v_mfma_f32_16x16x32_bf16 v[92:95], v[188:191], v[172:175], v[92:95]
    s_waitcnt lgkmcnt(0)
    s_barrier
    v_mfma_f32_16x16x32_bf16 v[64:67], v[104:107], v[96:99], v[64:67]
    ds_read_b128 v[144:147], v4 offset:24576
    v_mfma_f32_16x16x32_bf16 v[68:71], v[104:107], v[100:103], v[68:71]
    ds_read_b128 v[152:155], v6 offset:14336
    v_mfma_f32_16x16x32_bf16 v[72:75], v[108:111], v[96:99], v[72:75]
    ds_read_b128 v[148:151], v4 offset:25600
    v_mfma_f32_16x16x32_bf16 v[76:79], v[108:111], v[100:103], v[76:79]
    ds_read_b128 v[156:159], v6 offset:15360
    v_mfma_f32_16x16x32_bf16 v[80:83], v[112:115], v[96:99], v[80:83]
    ds_read_b128 v[160:163], v6 offset:16384
    v_mfma_f32_16x16x32_bf16 v[84:87], v[112:115], v[100:103], v[84:87]
    ds_read_b128 v[164:167], v6 offset:17408
    v_mfma_f32_16x16x32_bf16 v[88:91], v[116:119], v[96:99], v[88:91]
    ds_read_b128 v[168:171], v4 offset:28672
    v_mfma_f32_16x16x32_bf16 v[92:95], v[116:119], v[100:103], v[92:95]
    ds_read_b128 v[176:179], v6 offset:21504
    v_mfma_f32_16x16x32_bf16 v[64:67], v[128:131], v[120:123], v[64:67]
    ds_read_b128 v[172:175], v4 offset:29696
    v_mfma_f32_16x16x32_bf16 v[68:71], v[128:131], v[124:127], v[68:71]
    ds_read_b128 v[180:183], v6 offset:22528
    v_mfma_f32_16x16x32_bf16 v[72:75], v[132:135], v[120:123], v[72:75]
    ds_read_b128 v[184:187], v6 offset:23552
    v_mfma_f32_16x16x32_bf16 v[76:79], v[132:135], v[124:127], v[76:79]
    ds_read_b128 v[188:191], v6 offset:24576
    v_mfma_f32_16x16x32_bf16 v[80:83], v[136:139], v[120:123], v[80:83]
    v_mfma_f32_16x16x32_bf16 v[84:87], v[136:139], v[124:127], v[84:87]
    v_mfma_f32_16x16x32_bf16 v[88:91], v[140:143], v[120:123], v[88:91]
    v_mfma_f32_16x16x32_bf16 v[92:95], v[140:143], v[124:127], v[92:95]
    s_waitcnt lgkmcnt(0)
    s_barrier
    v_mfma_f32_16x16x32_bf16 v[64:67], v[152:155], v[144:147], v[64:67]
    ds_read_b128 v[96:99], v4 offset:32768
    v_mfma_f32_16x16x32_bf16 v[68:71], v[152:155], v[148:151], v[68:71]
    ds_read_b128 v[104:107], v6 offset:28672
    v_mfma_f32_16x16x32_bf16 v[72:75], v[156:159], v[144:147], v[72:75]
    ds_read_b128 v[100:103], v4 offset:33792
    v_mfma_f32_16x16x32_bf16 v[76:79], v[156:159], v[148:151], v[76:79]
    ds_read_b128 v[108:111], v6 offset:29696
    v_mfma_f32_16x16x32_bf16 v[80:83], v[160:163], v[144:147], v[80:83]
    ds_read_b128 v[112:115], v6 offset:30720
    v_mfma_f32_16x16x32_bf16 v[84:87], v[160:163], v[148:151], v[84:87]
    ds_read_b128 v[116:119], v6 offset:31744
    v_mfma_f32_16x16x32_bf16 v[88:91], v[164:167], v[144:147], v[88:91]
    ds_read_b128 v[120:123], v4 offset:36864
    v_mfma_f32_16x16x32_bf16 v[92:95], v[164:167], v[148:151], v[92:95]
    ds_read_b128 v[128:131], v6 offset:35840
    v_mfma_f32_16x16x32_bf16 v[64:67], v[176:179], v[168:171], v[64:67]
    ds_read_b128 v[124:127], v4 offset:37888
    v_mfma_f32_16x16x32_bf16 v[68:71], v[176:179], v[172:175], v[68:71]
    ds_read_b128 v[132:135], v6 offset:36864
    v_mfma_f32_16x16x32_bf16 v[72:75], v[180:183], v[168:171], v[72:75]
    ds_read_b128 v[136:139], v6 offset:37888
    v_mfma_f32_16x16x32_bf16 v[76:79], v[180:183], v[172:175], v[76:79]
    ds_read_b128 v[140:143], v6 offset:38912
    v_mfma_f32_16x16x32_bf16 v[80:83], v[184:187], v[168:171], v[80:83]
    v_mfma_f32_16x16x32_bf16 v[84:87], v[184:187], v[172:175], v[84:87]
    v_mfma_f32_16x16x32_bf16 v[88:91], v[188:191], v[168:171], v[88:91]
    v_mfma_f32_16x16x32_bf16 v[92:95], v[188:191], v[172:175], v[92:95]
    s_waitcnt lgkmcnt(0)
    s_barrier
    v_mfma_f32_16x16x32_bf16 v[64:67], v[104:107], v[96:99], v[64:67]
    ds_read_b128 v[144:147], v4 offset:40960
    v_mfma_f32_16x16x32_bf16 v[68:71], v[104:107], v[100:103], v[68:71]
    ds_read_b128 v[152:155], v6 offset:43008
    v_mfma_f32_16x16x32_bf16 v[72:75], v[108:111], v[96:99], v[72:75]
    ds_read_b128 v[148:151], v4 offset:41984
    v_mfma_f32_16x16x32_bf16 v[76:79], v[108:111], v[100:103], v[76:79]
    ds_read_b128 v[156:159], v6 offset:44032
    v_mfma_f32_16x16x32_bf16 v[80:83], v[112:115], v[96:99], v[80:83]
    ds_read_b128 v[160:163], v6 offset:45056
    v_mfma_f32_16x16x32_bf16 v[84:87], v[112:115], v[100:103], v[84:87]
    ds_read_b128 v[164:167], v6 offset:46080
    v_mfma_f32_16x16x32_bf16 v[88:91], v[116:119], v[96:99], v[88:91]
    ds_read_b128 v[168:171], v4 offset:45056
    v_mfma_f32_16x16x32_bf16 v[92:95], v[116:119], v[100:103], v[92:95]
    ds_read_b128 v[176:179], v6 offset:50176
    v_mfma_f32_16x16x32_bf16 v[64:67], v[128:131], v[120:123], v[64:67]
    ds_read_b128 v[172:175], v4 offset:46080
    v_mfma_f32_16x16x32_bf16 v[68:71], v[128:131], v[124:127], v[68:71]
    ds_read_b128 v[180:183], v6 offset:51200
    v_mfma_f32_16x16x32_bf16 v[72:75], v[132:135], v[120:123], v[72:75]
    ds_read_b128 v[184:187], v6 offset:52224
    v_mfma_f32_16x16x32_bf16 v[76:79], v[132:135], v[124:127], v[76:79]
    ds_read_b128 v[188:191], v6 offset:53248
    v_mfma_f32_16x16x32_bf16 v[80:83], v[136:139], v[120:123], v[80:83]
    v_mfma_f32_16x16x32_bf16 v[84:87], v[136:139], v[124:127], v[84:87]
    v_mfma_f32_16x16x32_bf16 v[88:91], v[140:143], v[120:123], v[88:91]
    v_mfma_f32_16x16x32_bf16 v[92:95], v[140:143], v[124:127], v[92:95]
    s_waitcnt lgkmcnt(0)
    s_barrier
    v_mfma_f32_16x16x32_bf16 v[64:67], v[152:155], v[144:147], v[64:67]
    ds_read_b128 v[96:99], v4 offset:49152
    v_mfma_f32_16x16x32_bf16 v[68:71], v[152:155], v[148:151], v[68:71]
    ds_read_b128 v[104:107], v6 offset:0
    v_mfma_f32_16x16x32_bf16 v[72:75], v[156:159], v[144:147], v[72:75]
    ds_read_b128 v[100:103], v4 offset:50176
    v_mfma_f32_16x16x32_bf16 v[76:79], v[156:159], v[148:151], v[76:79]
    ds_read_b128 v[108:111], v6 offset:1024
    v_mfma_f32_16x16x32_bf16 v[80:83], v[160:163], v[144:147], v[80:83]
    ds_read_b128 v[112:115], v6 offset:2048
    v_mfma_f32_16x16x32_bf16 v[84:87], v[160:163], v[148:151], v[84:87]
    ds_read_b128 v[116:119], v6 offset:3072
    v_mfma_f32_16x16x32_bf16 v[88:91], v[164:167], v[144:147], v[88:91]
    ds_read_b128 v[120:123], v4 offset:53248
    v_mfma_f32_16x16x32_bf16 v[92:95], v[164:167], v[148:151], v[92:95]
    ds_read_b128 v[128:131], v6 offset:7168
    v_mfma_f32_16x16x32_bf16 v[64:67], v[176:179], v[168:171], v[64:67]
    ds_read_b128 v[124:127], v4 offset:54272
    v_mfma_f32_16x16x32_bf16 v[68:71], v[176:179], v[172:175], v[68:71]
    ds_read_b128 v[132:135], v6 offset:8192
    v_mfma_f32_16x16x32_bf16 v[72:75], v[180:183], v[168:171], v[72:75]
    ds_read_b128 v[136:139], v6 offset:9216
    v_mfma_f32_16x16x32_bf16 v[76:79], v[180:183], v[172:175], v[76:79]
    ds_read_b128 v[140:143], v6 offset:10240
    v_mfma_f32_16x16x32_bf16 v[80:83], v[184:187], v[168:171], v[80:83]
    v_mfma_f32_16x16x32_bf16 v[84:87], v[184:187], v[172:175], v[84:87]
    v_mfma_f32_16x16x32_bf16 v[88:91], v[188:191], v[168:171], v[88:91]
    v_mfma_f32_16x16x32_bf16 v[92:95], v[188:191], v[172:175], v[92:95]
    s_waitcnt lgkmcnt(0)
    s_barrier
    v_mfma_f32_16x16x32_bf16 v[64:67], v[104:107], v[96:99], v[64:67]
    ds_read_b128 v[144:147], v4 offset:57344
    v_mfma_f32_16x16x32_bf16 v[68:71], v[104:107], v[100:103], v[68:71]
    ds_read_b128 v[152:155], v6 offset:14336
    v_mfma_f32_16x16x32_bf16 v[72:75], v[108:111], v[96:99], v[72:75]
    ds_read_b128 v[148:151], v4 offset:58368
    v_mfma_f32_16x16x32_bf16 v[76:79], v[108:111], v[100:103], v[76:79]
    ds_read_b128 v[156:159], v6 offset:15360
    v_mfma_f32_16x16x32_bf16 v[80:83], v[112:115], v[96:99], v[80:83]
    ds_read_b128 v[160:163], v6 offset:16384
    v_mfma_f32_16x16x32_bf16 v[84:87], v[112:115], v[100:103], v[84:87]
    ds_read_b128 v[164:167], v6 offset:17408
    v_mfma_f32_16x16x32_bf16 v[88:91], v[116:119], v[96:99], v[88:91]
    ds_read_b128 v[168:171], v4 offset:61440
    v_mfma_f32_16x16x32_bf16 v[92:95], v[116:119], v[100:103], v[92:95]
    ds_read_b128 v[176:179], v6 offset:21504
    v_mfma_f32_16x16x32_bf16 v[64:67], v[128:131], v[120:123], v[64:67]
    ds_read_b128 v[172:175], v4 offset:62464
    v_mfma_f32_16x16x32_bf16 v[68:71], v[128:131], v[124:127], v[68:71]
    ds_read_b128 v[180:183], v6 offset:22528
    v_mfma_f32_16x16x32_bf16 v[72:75], v[132:135], v[120:123], v[72:75]
    ds_read_b128 v[184:187], v6 offset:23552
    v_mfma_f32_16x16x32_bf16 v[76:79], v[132:135], v[124:127], v[76:79]
    ds_read_b128 v[188:191], v6 offset:24576
    v_mfma_f32_16x16x32_bf16 v[80:83], v[136:139], v[120:123], v[80:83]
    v_mfma_f32_16x16x32_bf16 v[84:87], v[136:139], v[124:127], v[84:87]
    v_mfma_f32_16x16x32_bf16 v[88:91], v[140:143], v[120:123], v[88:91]
    v_mfma_f32_16x16x32_bf16 v[92:95], v[140:143], v[124:127], v[92:95]
    s_waitcnt lgkmcnt(0)
    s_barrier
    v_mfma_f32_16x16x32_bf16 v[64:67], v[152:155], v[144:147], v[64:67]
    ds_read2st64_b64 v[96:99], v252 offset0:128 offset1:129
    v_mfma_f32_16x16x32_bf16 v[68:71], v[152:155], v[148:151], v[68:71]
    ds_read_b128 v[104:107], v6 offset:28672
    v_mfma_f32_16x16x32_bf16 v[72:75], v[156:159], v[144:147], v[72:75]
    ds_read2st64_b64 v[100:103], v252 offset0:130 offset1:131
    v_mfma_f32_16x16x32_bf16 v[76:79], v[156:159], v[148:151], v[76:79]
    ds_read_b128 v[108:111], v6 offset:29696
    v_mfma_f32_16x16x32_bf16 v[80:83], v[160:163], v[144:147], v[80:83]
    ds_read_b128 v[112:115], v6 offset:30720
    v_mfma_f32_16x16x32_bf16 v[84:87], v[160:163], v[148:151], v[84:87]
    ds_read_b128 v[116:119], v6 offset:31744
    v_mfma_f32_16x16x32_bf16 v[88:91], v[164:167], v[144:147], v[88:91]
    ds_read2st64_b64 v[120:123], v252 offset0:136 offset1:137
    v_mfma_f32_16x16x32_bf16 v[92:95], v[164:167], v[148:151], v[92:95]
    ds_read_b128 v[128:131], v6 offset:35840
    v_mfma_f32_16x16x32_bf16 v[64:67], v[176:179], v[168:171], v[64:67]
    ds_read2st64_b64 v[124:127], v252 offset0:138 offset1:139
    v_mfma_f32_16x16x32_bf16 v[68:71], v[176:179], v[172:175], v[68:71]
    ds_read_b128 v[132:135], v6 offset:36864
    v_mfma_f32_16x16x32_bf16 v[72:75], v[180:183], v[168:171], v[72:75]
    ds_read_b128 v[136:139], v6 offset:37888
    v_mfma_f32_16x16x32_bf16 v[76:79], v[180:183], v[172:175], v[76:79]
    ds_read_b128 v[140:143], v6 offset:38912
    v_mfma_f32_16x16x32_bf16 v[80:83], v[184:187], v[168:171], v[80:83]
    v_mfma_f32_16x16x32_bf16 v[84:87], v[184:187], v[172:175], v[84:87]
    v_mfma_f32_16x16x32_bf16 v[88:91], v[188:191], v[168:171], v[88:91]
    v_mfma_f32_16x16x32_bf16 v[92:95], v[188:191], v[172:175], v[92:95]
    s_waitcnt lgkmcnt(0)
    s_barrier
    v_mfma_f32_16x16x32_bf16 v[64:67], v[104:107], v[96:99], v[64:67]
    ds_read2st64_b64 v[144:147], v252 offset0:144 offset1:145
    v_mfma_f32_16x16x32_bf16 v[68:71], v[104:107], v[100:103], v[68:71]
    ds_read_b128 v[152:155], v6 offset:43008
    v_mfma_f32_16x16x32_bf16 v[72:75], v[108:111], v[96:99], v[72:75]
    ds_read2st64_b64 v[148:151], v252 offset0:146 offset1:147
    v_mfma_f32_16x16x32_bf16 v[76:79], v[108:111], v[100:103], v[76:79]
    ds_read_b128 v[156:159], v6 offset:44032
    v_mfma_f32_16x16x32_bf16 v[80:83], v[112:115], v[96:99], v[80:83]
    ds_read_b128 v[160:163], v6 offset:45056
    v_mfma_f32_16x16x32_bf16 v[84:87], v[112:115], v[100:103], v[84:87]
    ds_read_b128 v[164:167], v6 offset:46080
    v_mfma_f32_16x16x32_bf16 v[88:91], v[116:119], v[96:99], v[88:91]
    ds_read2st64_b64 v[168:171], v252 offset0:152 offset1:153
    v_mfma_f32_16x16x32_bf16 v[92:95], v[116:119], v[100:103], v[92:95]
    ds_read_b128 v[176:179], v6 offset:50176
    v_mfma_f32_16x16x32_bf16 v[64:67], v[128:131], v[120:123], v[64:67]
    ds_read2st64_b64 v[172:175], v252 offset0:154 offset1:155
    v_mfma_f32_16x16x32_bf16 v[68:71], v[128:131], v[124:127], v[68:71]
    ds_read_b128 v[180:183], v6 offset:51200
    v_mfma_f32_16x16x32_bf16 v[72:75], v[132:135], v[120:123], v[72:75]
    ds_read_b128 v[184:187], v6 offset:52224
    v_mfma_f32_16x16x32_bf16 v[76:79], v[132:135], v[124:127], v[76:79]
    ds_read_b128 v[188:191], v6 offset:53248
    v_mfma_f32_16x16x32_bf16 v[80:83], v[136:139], v[120:123], v[80:83]
    v_mfma_f32_16x16x32_bf16 v[84:87], v[136:139], v[124:127], v[84:87]
    v_mfma_f32_16x16x32_bf16 v[88:91], v[140:143], v[120:123], v[88:91]
    v_mfma_f32_16x16x32_bf16 v[92:95], v[140:143], v[124:127], v[92:95]
    s_waitcnt lgkmcnt(10)
    v_mfma_f32_16x16x32_bf16 v[64:67], v[152:155], v[144:147], v[64:67]
    ds_read2_b32 v[192:193], v10 offset0:0 offset1:192
    s_waitcnt lgkmcnt(10)
    v_mfma_f32_16x16x32_bf16 v[68:71], v[152:155], v[148:151], v[68:71]
    ds_read2_b32 v[194:195], v10 offset0:16 offset1:208
    s_waitcnt lgkmcnt(10)
    v_mfma_f32_16x16x32_bf16 v[72:75], v[156:159], v[144:147], v[72:75]
    ds_read_b128 v[196:199], v12 offset:1536
    v_mfma_f32_16x16x32_bf16 v[76:79], v[156:159], v[148:151], v[76:79]
    ds_read_b128 v[200:203], v12 offset:1600
    s_waitcnt lgkmcnt(11)
    v_mfma_f32_16x16x32_bf16 v[80:83], v[160:163], v[144:147], v[80:83]
    ds_read_b128 v[204:207], v12 offset:1664
    v_mfma_f32_16x16x32_bf16 v[84:87], v[160:163], v[148:151], v[84:87]
    ds_read_b128 v[208:211], v12 offset:1728
    s_waitcnt lgkmcnt(12)
    v_mfma_f32_16x16x32_bf16 v[88:91], v[164:167], v[144:147], v[88:91]
    v_mfma_f32_16x16x32_bf16 v[92:95], v[164:167], v[148:151], v[92:95]
    s_waitcnt lgkmcnt(10)
    v_mfma_f32_16x16x32_bf16 v[64:67], v[176:179], v[168:171], v[64:67]
    s_waitcnt lgkmcnt(9)
    v_mfma_f32_16x16x32_bf16 v[68:71], v[176:179], v[172:175], v[68:71]
    s_waitcnt lgkmcnt(8)
    v_mfma_f32_16x16x32_bf16 v[72:75], v[180:183], v[168:171], v[72:75]
    v_mfma_f32_16x16x32_bf16 v[76:79], v[180:183], v[172:175], v[76:79]
    s_waitcnt lgkmcnt(7)
    v_mfma_f32_16x16x32_bf16 v[80:83], v[184:187], v[168:171], v[80:83]
    v_mfma_f32_16x16x32_bf16 v[84:87], v[184:187], v[172:175], v[84:87]
    s_waitcnt lgkmcnt(6)
    v_mfma_f32_16x16x32_bf16 v[88:91], v[188:191], v[168:171], v[88:91]
    v_mfma_f32_16x16x32_bf16 v[92:95], v[188:191], v[172:175], v[92:95]
    s_barrier
    s_waitcnt lgkmcnt(0)
    v_pk_mul_f32 v[232:233], v[196:197], v[192:193] op_sel:[0,1] op_sel_hi:[1,1]
    v_pk_mul_f32 v[234:235], v[198:199], v[192:193] op_sel:[0,1] op_sel_hi:[1,1]
    v_pk_fma_f32 v[64:65], v[64:65], v[192:193], v[232:233] op_sel:[0,0,0] op_sel_hi:[1,0,1]
    v_pk_fma_f32 v[66:67], v[66:67], v[192:193], v[234:235] op_sel:[0,0,0] op_sel_hi:[1,0,1]
    v_pk_mul_f32 v[236:237], v[200:201], v[192:193] op_sel:[0,1] op_sel_hi:[1,1]
    v_pk_mul_f32 v[238:239], v[202:203], v[192:193] op_sel:[0,1] op_sel_hi:[1,1]
    v_pk_fma_f32 v[72:73], v[72:73], v[192:193], v[236:237] op_sel:[0,0,0] op_sel_hi:[1,0,1]
    v_pk_fma_f32 v[74:75], v[74:75], v[192:193], v[238:239] op_sel:[0,0,0] op_sel_hi:[1,0,1]
    v_pk_mul_f32 v[240:241], v[196:197], v[194:195] op_sel:[0,1] op_sel_hi:[1,1]
    v_pk_mul_f32 v[242:243], v[198:199], v[194:195] op_sel:[0,1] op_sel_hi:[1,1]
    v_pk_fma_f32 v[68:69], v[68:69], v[194:195], v[240:241] op_sel:[0,0,0] op_sel_hi:[1,0,1]
    v_pk_fma_f32 v[70:71], v[70:71], v[194:195], v[242:243] op_sel:[0,0,0] op_sel_hi:[1,0,1]
    v_pk_mul_f32 v[244:245], v[200:201], v[194:195] op_sel:[0,1] op_sel_hi:[1,1]
    v_pk_mul_f32 v[246:247], v[202:203], v[194:195] op_sel:[0,1] op_sel_hi:[1,1]
    v_pk_fma_f32 v[76:77], v[76:77], v[194:195], v[244:245] op_sel:[0,0,0] op_sel_hi:[1,0,1]
    v_pk_fma_f32 v[78:79], v[78:79], v[194:195], v[246:247] op_sel:[0,0,0] op_sel_hi:[1,0,1]
    v_pk_mul_f32 v[232:233], v[64:65], v[64:65]
    v_pk_mul_f32 v[234:235], v[66:67], v[66:67]
    v_pk_mul_f32 v[236:237], v[72:73], v[72:73]
    v_pk_mul_f32 v[238:239], v[74:75], v[74:75]
    v_pk_mul_f32 v[240:241], v[68:69], v[68:69]
    v_pk_mul_f32 v[242:243], v[70:71], v[70:71]
    v_pk_mul_f32 v[244:245], v[76:77], v[76:77]
    v_pk_mul_f32 v[246:247], v[78:79], v[78:79]
    v_pk_fma_f32 v[232:233], v[232:233], s[44:45], v[14:15]
    v_pk_fma_f32 v[234:235], v[234:235], s[44:45], v[14:15]
    v_pk_fma_f32 v[236:237], v[236:237], s[44:45], v[14:15]
    v_pk_fma_f32 v[238:239], v[238:239], s[44:45], v[14:15]
    v_pk_fma_f32 v[240:241], v[240:241], s[44:45], v[14:15]
    v_pk_fma_f32 v[242:243], v[242:243], s[44:45], v[14:15]
    v_pk_fma_f32 v[244:245], v[244:245], s[44:45], v[14:15]
    v_pk_fma_f32 v[246:247], v[246:247], s[44:45], v[14:15]
    v_pk_mul_f32 v[232:233], v[232:233], v[64:65]
    v_pk_mul_f32 v[234:235], v[234:235], v[66:67]
    v_pk_mul_f32 v[236:237], v[236:237], v[72:73]
    v_pk_mul_f32 v[238:239], v[238:239], v[74:75]
    v_pk_mul_f32 v[240:241], v[240:241], v[68:69]
    v_pk_mul_f32 v[242:243], v[242:243], v[70:71]
    v_pk_mul_f32 v[244:245], v[244:245], v[76:77]
    v_pk_mul_f32 v[246:247], v[246:247], v[78:79]
    v_exp_f32 v232, v232
    v_exp_f32 v233, v233
    v_exp_f32 v234, v234
    v_exp_f32 v235, v235
    v_exp_f32 v236, v236
    v_exp_f32 v237, v237
    v_exp_f32 v238, v238
    v_exp_f32 v239, v239
    v_exp_f32 v240, v240
    v_exp_f32 v241, v241
    v_exp_f32 v242, v242
    v_exp_f32 v243, v243
    v_exp_f32 v244, v244
    v_exp_f32 v245, v245
    v_exp_f32 v246, v246
    v_exp_f32 v247, v247
    v_pk_add_f32 v[232:233], v[232:233], 1.0 op_sel_hi:[1,0]
    v_pk_add_f32 v[234:235], v[234:235], 1.0 op_sel_hi:[1,0]
    v_pk_add_f32 v[236:237], v[236:237], 1.0 op_sel_hi:[1,0]
    v_pk_add_f32 v[238:239], v[238:239], 1.0 op_sel_hi:[1,0]
    v_pk_add_f32 v[240:241], v[240:241], 1.0 op_sel_hi:[1,0]
    v_pk_add_f32 v[242:243], v[242:243], 1.0 op_sel_hi:[1,0]
    v_pk_add_f32 v[244:245], v[244:245], 1.0 op_sel_hi:[1,0]
    v_pk_add_f32 v[246:247], v[246:247], 1.0 op_sel_hi:[1,0]
    v_rcp_f32 v232, v232
    v_rcp_f32 v233, v233
    v_rcp_f32 v234, v234
    v_rcp_f32 v235, v235
    v_rcp_f32 v236, v236
    v_rcp_f32 v237, v237
    v_rcp_f32 v238, v238
    v_rcp_f32 v239, v239
    v_rcp_f32 v240, v240
    v_rcp_f32 v241, v241
    v_rcp_f32 v242, v242
    v_rcp_f32 v243, v243
    v_rcp_f32 v244, v244
    v_rcp_f32 v245, v245
    v_rcp_f32 v246, v246
    v_rcp_f32 v247, v247
    v_pk_mul_f32 v[64:65], v[64:65], v[232:233]
    v_pk_mul_f32 v[66:67], v[66:67], v[234:235]
    v_pk_mul_f32 v[72:73], v[72:73], v[236:237]
    v_pk_mul_f32 v[74:75], v[74:75], v[238:239]
    v_pk_mul_f32 v[68:69], v[68:69], v[240:241]
    v_pk_mul_f32 v[70:71], v[70:71], v[242:243]
    v_pk_mul_f32 v[76:77], v[76:77], v[244:245]
    v_pk_mul_f32 v[78:79], v[78:79], v[246:247]
    v_cvt_pk_bf16_f32 v64, v64, v65
    v_cvt_pk_bf16_f32 v65, v66, v67
    v_cvt_pk_bf16_f32 v68, v68, v69
    v_cvt_pk_bf16_f32 v69, v70, v71
    v_cvt_pk_bf16_f32 v72, v72, v73
    v_cvt_pk_bf16_f32 v73, v74, v75
    v_cvt_pk_bf16_f32 v76, v76, v77
    v_cvt_pk_bf16_f32 v77, v78, v79
    v_lshlrev_b32 v32, 16, v64
    v_and_b32 v33, s57, v64
    v_lshlrev_b32 v34, 16, v65
    v_and_b32 v35, s57, v65
    v_lshlrev_b32 v36, 16, v68
    v_and_b32 v37, s57, v68
    v_lshlrev_b32 v38, 16, v69
    v_and_b32 v39, s57, v69
    v_lshlrev_b32 v40, 16, v72
    v_and_b32 v41, s57, v72
    v_lshlrev_b32 v42, 16, v73
    v_and_b32 v43, s57, v73
    v_lshlrev_b32 v44, 16, v76
    v_and_b32 v45, s57, v76
    v_lshlrev_b32 v46, 16, v77
    v_and_b32 v47, s57, v77
    s_cmp_eq_u32 s38, 2
    s_cbranch_scc1 P3b_done1
    v_pk_mul_f32 v[232:233], v[204:205], v[192:193] op_sel:[0,1] op_sel_hi:[1,1]
    v_pk_mul_f32 v[234:235], v[206:207], v[192:193] op_sel:[0,1] op_sel_hi:[1,1]
    v_pk_fma_f32 v[80:81], v[80:81], v[192:193], v[232:233] op_sel:[0,0,0] op_sel_hi:[1,0,1]
    v_pk_fma_f32 v[82:83], v[82:83], v[192:193], v[234:235] op_sel:[0,0,0] op_sel_hi:[1,0,1]
    v_pk_mul_f32 v[236:237], v[204:205], v[194:195] op_sel:[0,1] op_sel_hi:[1,1]
    v_pk_mul_f32 v[238:239], v[206:207], v[194:195] op_sel:[0,1] op_sel_hi:[1,1]
    v_pk_fma_f32 v[84:85], v[84:85], v[194:195], v[236:237] op_sel:[0,0,0] op_sel_hi:[1,0,1]
    v_pk_fma_f32 v[86:87], v[86:87], v[194:195], v[238:239] op_sel:[0,0,0] op_sel_hi:[1,0,1]
    v_pk_mul_f32 v[232:233], v[80:81], v[80:81]
    v_pk_mul_f32 v[234:235], v[82:83], v[82:83]
    v_pk_mul_f32 v[236:237], v[84:85], v[84:85]
    v_pk_mul_f32 v[238:239], v[86:87], v[86:87]
    v_pk_fma_f32 v[232:233], v[232:233], s[44:45], v[14:15]
    v_pk_fma_f32 v[234:235], v[234:235], s[44:45], v[14:15]
    v_pk_fma_f32 v[236:237], v[236:237], s[44:45], v[14:15]
    v_pk_fma_f32 v[238:239], v[238:239], s[44:45], v[14:15]
    v_pk_mul_f32 v[232:233], v[232:233], v[80:81]
    v_pk_mul_f32 v[234:235], v[234:235], v[82:83]
    v_pk_mul_f32 v[236:237], v[236:237], v[84:85]
    v_pk_mul_f32 v[238:239], v[238:239], v[86:87]
    v_exp_f32 v232, v232
    v_exp_f32 v233, v233
    v_exp_f32 v234, v234
    v_exp_f32 v235, v235
    v_exp_f32 v236, v236
    v_exp_f32 v237, v237
    v_exp_f32 v238, v238
    v_exp_f32 v239, v239
    v_pk_add_f32 v[232:233], v[232:233], 1.0 op_sel_hi:[1,0]
    v_pk_add_f32 v[234:235], v[234:235], 1.0 op_sel_hi:[1,0]
    v_pk_add_f32 v[236:237], v[236:237], 1.0 op_sel_hi:[1,0]
    v_pk_add_f32 v[238:239], v[238:239], 1.0 op_sel_hi:[1,0]
    v_rcp_f32 v232, v232
    v_rcp_f32 v233, v233
    v_rcp_f32 v234, v234
    v_rcp_f32 v235, v235
    v_rcp_f32 v236, v236
    v_rcp_f32 v237, v237
    v_rcp_f32 v238, v238
    v_rcp_f32 v239, v239
    v_pk_mul_f32 v[80:81], v[80:81], v[232:233]
    v_pk_mul_f32 v[82:83], v[82:83], v[234:235]
    v_pk_mul_f32 v[84:85], v[84:85], v[236:237]
    v_pk_mul_f32 v[86:87], v[86:87], v[238:239]
    v_cvt_pk_bf16_f32 v80, v80, v81
    v_cvt_pk_bf16_f32 v81, v82, v83
    v_cvt_pk_bf16_f32 v84, v84, v85
    v_cvt_pk_bf16_f32 v85, v86, v87
    v_lshlrev_b32 v48, 16, v80
    v_and_b32 v49, s57, v80
    v_lshlrev_b32 v50, 16, v81
    v_and_b32 v51, s57, v81
    v_lshlrev_b32 v52, 16, v84
    v_and_b32 v53, s57, v84
    v_lshlrev_b32 v54, 16, v85
    v_and_b32 v55, s57, v85
    s_cmp_eq_u32 s38, 3
    s_cbranch_scc1 P3b_done1
    v_pk_mul_f32 v[232:233], v[208:209], v[192:193] op_sel:[0,1] op_sel_hi:[1,1]
    v_pk_mul_f32 v[234:235], v[210:211], v[192:193] op_sel:[0,1] op_sel_hi:[1,1]
    v_pk_fma_f32 v[88:89], v[88:89], v[192:193], v[232:233] op_sel:[0,0,0] op_sel_hi:[1,0,1]
    v_pk_fma_f32 v[90:91], v[90:91], v[192:193], v[234:235] op_sel:[0,0,0] op_sel_hi:[1,0,1]
    v_pk_mul_f32 v[236:237], v[208:209], v[194:195] op_sel:[0,1] op_sel_hi:[1,1]
    v_pk_mul_f32 v[238:239], v[210:211], v[194:195] op_sel:[0,1] op_sel_hi:[1,1]
    v_pk_fma_f32 v[92:93], v[92:93], v[194:195], v[236:237] op_sel:[0,0,0] op_sel_hi:[1,0,1]
    v_pk_fma_f32 v[94:95], v[94:95], v[194:195], v[238:239] op_sel:[0,0,0] op_sel_hi:[1,0,1]
    v_pk_mul_f32 v[232:233], v[88:89], v[88:89]
    v_pk_mul_f32 v[234:235], v[90:91], v[90:91]
    v_pk_mul_f32 v[236:237], v[92:93], v[92:93]
    v_pk_mul_f32 v[238:239], v[94:95], v[94:95]
    v_pk_fma_f32 v[232:233], v[232:233], s[44:45], v[14:15]
    v_pk_fma_f32 v[234:235], v[234:235], s[44:45], v[14:15]
    v_pk_fma_f32 v[236:237], v[236:237], s[44:45], v[14:15]
    v_pk_fma_f32 v[238:239], v[238:239], s[44:45], v[14:15]
    v_pk_mul_f32 v[232:233], v[232:233], v[88:89]
    v_pk_mul_f32 v[234:235], v[234:235], v[90:91]
    v_pk_mul_f32 v[236:237], v[236:237], v[92:93]
    v_pk_mul_f32 v[238:239], v[238:239], v[94:95]
    v_exp_f32 v232, v232
    v_exp_f32 v233, v233
    v_exp_f32 v234, v234
    v_exp_f32 v235, v235
    v_exp_f32 v236, v236
    v_exp_f32 v237, v237
    v_exp_f32 v238, v238
    v_exp_f32 v239, v239
    v_pk_add_f32 v[232:233], v[232:233], 1.0 op_sel_hi:[1,0]
    v_pk_add_f32 v[234:235], v[234:235], 1.0 op_sel_hi:[1,0]
    v_pk_add_f32 v[236:237], v[236:237], 1.0 op_sel_hi:[1,0]
    v_pk_add_f32 v[238:239], v[238:239], 1.0 op_sel_hi:[1,0]
    v_rcp_f32 v232, v232
    v_rcp_f32 v233, v233
    v_rcp_f32 v234, v234
    v_rcp_f32 v235, v235
    v_rcp_f32 v236, v236
    v_rcp_f32 v237, v237
    v_rcp_f32 v238, v238
    v_rcp_f32 v239, v239
    v_pk_mul_f32 v[88:89], v[88:89], v[232:233]
    v_pk_mul_f32 v[90:91], v[90:91], v[234:235]
    v_pk_mul_f32 v[92:93], v[92:93], v[236:237]
    v_pk_mul_f32 v[94:95], v[94:95], v[238:239]
    v_cvt_pk_bf16_f32 v88, v88, v89
    v_cvt_pk_bf16_f32 v89, v90, v91
    v_cvt_pk_bf16_f32 v92, v92, v93
    v_cvt_pk_bf16_f32 v93, v94, v95
    v_lshlrev_b32 v56, 16, v88
    v_and_b32 v57, s57, v88
    v_lshlrev_b32 v58, 16, v89
    v_and_b32 v59, s57, v89
    v_lshlrev_b32 v60, 16, v92
    v_and_b32 v61, s57, v92
    v_lshlrev_b32 v62, 16, v93
    v_and_b32 v63, s57, v93
    s_barrier
    ds_read_b128 v[120:123], v19 offset:4096
    ds_read_b128 v[96:99], v18 offset:0
    ds_read_b128 v[100:103], v18 offset:1024
    ds_read_b128 v[148:151], v19 offset:4160
    ds_read_b128 v[124:127], v18 offset:4096
    ds_read_b128 v[128:131], v18 offset:5120
    ds_read_b128 v[104:107], v16 offset:28672
    ds_read_b128 v[108:111], v16 offset:29696
    ds_read_b128 v[112:115], v16 offset:30720
    ds_read_b128 v[116:119], v16 offset:31744
    ds_read_b128 v[132:135], v16 offset:35840
    ds_read_b128 v[136:139], v16 offset:36864
    ds_read_b128 v[140:143], v16 offset:37888
    ds_read_b128 v[144:147], v16 offset:38912
    s_waitcnt lgkmcnt(12)
    v_pk_mul_f16 v96, v96, v120
    v_pk_mul_f16 v97, v97, v121
    v_pk_mul_f16 v98, v98, v122
    v_pk_mul_f16 v99, v99, v123
    s_waitcnt lgkmcnt(11)
    v_pk_mul_f16 v100, v100, v120
    v_pk_mul_f16 v101, v101, v121
    v_pk_mul_f16 v102, v102, v122
    v_pk_mul_f16 v103, v103, v123
    s_barrier
    s_waitcnt lgkmcnt(7)
    v_mfma_f32_16x16x32_f16 v[64:67], v[104:107], v[96:99], 0
    ds_read_b128 v[176:179], v19 offset:4224
    v_pk_mul_f16 v124, v124, v148
    s_waitcnt lgkmcnt(7)
    v_mfma_f32_16x16x32_f16 v[72:75], v[108:111], v[96:99], 0
    ds_read_b128 v[152:155], v18 offset:8192
    v_pk_mul_f16 v125, v125, v149
    s_waitcnt lgkmcnt(7)
    v_mfma_f32_16x16x32_f16 v[80:83], v[112:115], v[96:99], 0
    ds_read_b128 v[156:159], v18 offset:9216
    v_pk_mul_f16 v126, v126, v150
    s_waitcnt lgkmcnt(7)
    v_mfma_f32_16x16x32_f16 v[88:91], v[116:119], v[96:99], 0
    ds_read_b128 v[204:207], v19 offset:4288
    v_pk_mul_f16 v127, v127, v151
    v_mfma_f32_16x16x32_f16 v[68:71], v[104:107], v[100:103], 0
    ds_read_b128 v[180:183], v18 offset:12288
    v_pk_mul_f16 v128, v128, v148
    v_mfma_f32_16x16x32_f16 v[76:79], v[108:111], v[100:103], 0
    ds_read_b128 v[184:187], v18 offset:13312
    v_pk_mul_f16 v129, v129, v149
    v_mfma_f32_16x16x32_f16 v[84:87], v[112:115], v[100:103], 0
    ds_read_b128 v[160:163], v16 offset:43008
    v_pk_mul_f16 v130, v130, v150
    v_mfma_f32_16x16x32_f16 v[92:95], v[116:119], v[100:103], 0
    v_pk_mul_f16 v131, v131, v151
    s_waitcnt lgkmcnt(10)
    v_mfma_f32_16x16x32_f16 v[64:67], v[132:135], v[124:127], v[64:67]
    ds_read_b128 v[164:167], v16 offset:44032
    s_waitcnt lgkmcnt(6)
    v_pk_mul_f16 v152, v152, v176
    v_mfma_f32_16x16x32_f16 v[72:75], v[136:139], v[124:127], v[72:75]
    ds_read_b128 v[168:171], v16 offset:45056
    v_pk_mul_f16 v153, v153, v177
    v_mfma_f32_16x16x32_f16 v[80:83], v[140:143], v[124:127], v[80:83]
    ds_read_b128 v[172:175], v16 offset:46080
    v_pk_mul_f16 v154, v154, v178
    v_mfma_f32_16x16x32_f16 v[88:91], v[144:147], v[124:127], v[88:91]
    ds_read_b128 v[188:191], v16 offset:50176
    v_pk_mul_f16 v155, v155, v179
    v_mfma_f32_16x16x32_f16 v[68:71], v[132:135], v[128:131], v[68:71]
    ds_read_b128 v[192:195], v16 offset:51200
    s_waitcnt lgkmcnt(9)
    v_pk_mul_f16 v156, v156, v176
    v_mfma_f32_16x16x32_f16 v[76:79], v[136:139], v[128:131], v[76:79]
    ds_read_b128 v[196:199], v16 offset:52224
    v_pk_mul_f16 v157, v157, v177
    v_mfma_f32_16x16x32_f16 v[84:87], v[140:143], v[128:131], v[84:87]
    ds_read_b128 v[200:203], v16 offset:53248
    v_pk_mul_f16 v158, v158, v178
    v_mfma_f32_16x16x32_f16 v[92:95], v[144:147], v[128:131], v[92:95]
    v_pk_mul_f16 v159, v159, v179
    s_mov_b32 s37, 5
P4_loop0:
    s_barrier
    s_waitcnt lgkmcnt(7)
    v_mfma_f32_16x16x32_f16 v[64:67], v[160:163], v[152:155], v[64:67]
    ds_read_b128 v[120:123], v19 offset:4352
    v_pk_mul_f16 v180, v180, v204
    s_waitcnt lgkmcnt(7)
    v_mfma_f32_16x16x32_f16 v[72:75], v[164:167], v[152:155], v[72:75]
    ds_read_b128 v[96:99], v18 offset:16384
    v_pk_mul_f16 v181, v181, v205
    s_waitcnt lgkmcnt(7)
    v_mfma_f32_16x16x32_f16 v[80:83], v[168:171], v[152:155], v[80:83]
    ds_read_b128 v[100:103], v18 offset:17408
    v_pk_mul_f16 v182, v182, v206
    s_waitcnt lgkmcnt(7)
    v_mfma_f32_16x16x32_f16 v[88:91], v[172:175], v[152:155], v[88:91]
    ds_read_b128 v[148:151], v19 offset:4416
    v_pk_mul_f16 v183, v183, v207
    v_mfma_f32_16x16x32_f16 v[68:71], v[160:163], v[156:159], v[68:71]
    ds_read_b128 v[124:127], v18 offset:20480
    v_pk_mul_f16 v184, v184, v204
    v_mfma_f32_16x16x32_f16 v[76:79], v[164:167], v[156:159], v[76:79]
    ds_read_b128 v[128:131], v18 offset:21504
    v_pk_mul_f16 v185, v185, v205
    v_mfma_f32_16x16x32_f16 v[84:87], v[168:171], v[156:159], v[84:87]
    ds_read_b128 v[104:107], v16 offset:57344
    v_pk_mul_f16 v186, v186, v206
    v_mfma_f32_16x16x32_f16 v[92:95], v[172:175], v[156:159], v[92:95]
    v_pk_mul_f16 v187, v187, v207
    s_waitcnt lgkmcnt(10)
    v_mfma_f32_16x16x32_f16 v[64:67], v[188:191], v[180:183], v[64:67]
    ds_read_b128 v[108:111], v16 offset:58368
    s_waitcnt lgkmcnt(6)
    v_pk_mul_f16 v96, v96, v120
    v_mfma_f32_16x16x32_f16 v[72:75], v[192:195], v[180:183], v[72:75]
    ds_read_b128 v[112:115], v16 offset:59392
    v_pk_mul_f16 v97, v97, v121
    v_mfma_f32_16x16x32_f16 v[80:83], v[196:199], v[180:183], v[80:83]
    ds_read_b128 v[116:119], v16 offset:60416
    v_pk_mul_f16 v98, v98, v122
    v_mfma_f32_16x16x32_f16 v[88:91], v[200:203], v[180:183], v[88:91]
    ds_read_b128 v[132:135], v16 offset:64512
    v_pk_mul_f16 v99, v99, v123
    v_mfma_f32_16x16x32_f16 v[68:71], v[188:191], v[184:187], v[68:71]
    ds_read_b128 v[136:139], v17 offset:0
    s_waitcnt lgkmcnt(9)
    v_pk_mul_f16 v100, v100, v120
    v_mfma_f32_16x16x32_f16 v[76:79], v[192:195], v[184:187], v[76:79]
    ds_read_b128 v[140:143], v17 offset:1024
    v_pk_mul_f16 v101, v101, v121
    v_mfma_f32_16x16x32_f16 v[84:87], v[196:199], v[184:187], v[84:87]
    ds_read_b128 v[144:147], v17 offset:2048
    v_pk_mul_f16 v102, v102, v122
    v_mfma_f32_16x16x32_f16 v[92:95], v[200:203], v[184:187], v[92:95]
    v_pk_mul_f16 v103, v103, v123
    s_barrier
    s_waitcnt lgkmcnt(7)
    v_mfma_f32_16x16x32_f16 v[64:67], v[104:107], v[96:99], v[64:67]
    ds_read_b128 v[176:179], v19 offset:4480
    v_pk_mul_f16 v124, v124, v148
    s_waitcnt lgkmcnt(7)
    v_mfma_f32_16x16x32_f16 v[72:75], v[108:111], v[96:99], v[72:75]
    ds_read_b128 v[152:155], v18 offset:24576
    v_pk_mul_f16 v125, v125, v149
    s_waitcnt lgkmcnt(7)
    v_mfma_f32_16x16x32_f16 v[80:83], v[112:115], v[96:99], v[80:83]
    ds_read_b128 v[156:159], v18 offset:25600
    v_pk_mul_f16 v126, v126, v150
    s_waitcnt lgkmcnt(7)
    v_mfma_f32_16x16x32_f16 v[88:91], v[116:119], v[96:99], v[88:91]
    ds_read_b128 v[204:207], v19 offset:4544
    v_pk_mul_f16 v127, v127, v151
    v_mfma_f32_16x16x32_f16 v[68:71], v[104:107], v[100:103], v[68:71]
    ds_read_b128 v[180:183], v18 offset:28672
    v_pk_mul_f16 v128, v128, v148
    v_mfma_f32_16x16x32_f16 v[76:79], v[108:111], v[100:103], v[76:79]
    ds_read_b128 v[184:187], v18 offset:29696
    v_pk_mul_f16 v129, v129, v149
    v_mfma_f32_16x16x32_f16 v[84:87], v[112:115], v[100:103], v[84:87]
    ds_read_b128 v[160:163], v17 offset:6144
    v_pk_mul_f16 v130, v130, v150
    v_mfma_f32_16x16x32_f16 v[92:95], v[116:119], v[100:103], v[92:95]
    v_pk_mul_f16 v131, v131, v151
    s_waitcnt lgkmcnt(10)
    v_mfma_f32_16x16x32_f16 v[64:67], v[132:135], v[124:127], v[64:67]
    ds_read_b128 v[164:167], v17 offset:7168
    s_waitcnt lgkmcnt(6)
    v_pk_mul_f16 v152, v152, v176
    v_mfma_f32_16x16x32_f16 v[72:75], v[136:139], v[124:127], v[72:75]
    ds_read_b128 v[168:171], v17 offset:8192
    v_pk_mul_f16 v153, v153, v177
    v_mfma_f32_16x16x32_f16 v[80:83], v[140:143], v[124:127], v[80:83]
    ds_read_b128 v[172:175], v17 offset:9216
    v_pk_mul_f16 v154, v154, v178
    v_mfma_f32_16x16x32_f16 v[88:91], v[144:147], v[124:127], v[88:91]
    ds_read_b128 v[188:191], v17 offset:13312
    v_pk_mul_f16 v155, v155, v179
    v_mfma_f32_16x16x32_f16 v[68:71], v[132:135], v[128:131], v[68:71]
    ds_read_b128 v[192:195], v17 offset:14336
    s_waitcnt lgkmcnt(9)
    v_pk_mul_f16 v156, v156, v176
    v_mfma_f32_16x16x32_f16 v[76:79], v[136:139], v[128:131], v[76:79]
    ds_read_b128 v[196:199], v17 offset:15360
    v_pk_mul_f16 v157, v157, v177
    v_mfma_f32_16x16x32_f16 v[84:87], v[140:143], v[128:131], v[84:87]
    ds_read_b128 v[200:203], v17 offset:16384
    v_pk_mul_f16 v158, v158, v178
    v_mfma_f32_16x16x32_f16 v[92:95], v[144:147], v[128:131], v[92:95]
    v_pk_mul_f16 v159, v159, v179
    s_barrier
    s_waitcnt lgkmcnt(7)
    v_mfma_f32_16x16x32_f16 v[64:67], v[160:163], v[152:155], v[64:67]
    ds_read_b128 v[120:123], v19 offset:4608
    v_pk_mul_f16 v180, v180, v204
    s_waitcnt lgkmcnt(7)
    v_mfma_f32_16x16x32_f16 v[72:75], v[164:167], v[152:155], v[72:75]
    ds_read_b128 v[96:99], v18 offset:32768
    v_pk_mul_f16 v181, v181, v205
    s_waitcnt lgkmcnt(7)
    v_mfma_f32_16x16x32_f16 v[80:83], v[168:171], v[152:155], v[80:83]
    ds_read_b128 v[100:103], v18 offset:33792
    v_pk_mul_f16 v182, v182, v206
    s_waitcnt lgkmcnt(7)
    v_mfma_f32_16x16x32_f16 v[88:91], v[172:175], v[152:155], v[88:91]
    ds_read_b128 v[148:151], v19 offset:4672
    v_pk_mul_f16 v183, v183, v207
    v_mfma_f32_16x16x32_f16 v[68:71], v[160:163], v[156:159], v[68:71]
    ds_read_b128 v[124:127], v18 offset:36864
    v_pk_mul_f16 v184, v184, v204
    v_mfma_f32_16x16x32_f16 v[76:79], v[164:167], v[156:159], v[76:79]
    ds_read_b128 v[128:131], v18 offset:37888
    v_pk_mul_f16 v185, v185, v205
    v_mfma_f32_16x16x32_f16 v[84:87], v[168:171], v[156:159], v[84:87]
    ds_read_b128 v[104:107], v16 offset:0
    v_pk_mul_f16 v186, v186, v206
    v_mfma_f32_16x16x32_f16 v[92:95], v[172:175], v[156:159], v[92:95]
    v_pk_mul_f16 v187, v187, v207
    s_waitcnt lgkmcnt(10)
    v_mfma_f32_16x16x32_f16 v[64:67], v[188:191], v[180:183], v[64:67]
    ds_read_b128 v[108:111], v16 offset:1024
    s_waitcnt lgkmcnt(6)
    v_pk_mul_f16 v96, v96, v120
    v_mfma_f32_16x16x32_f16 v[72:75], v[192:195], v[180:183], v[72:75]
    ds_read_b128 v[112:115], v16 offset:2048
    v_pk_mul_f16 v97, v97, v121
    v_mfma_f32_16x16x32_f16 v[80:83], v[196:199], v[180:183], v[80:83]
    ds_read_b128 v[116:119], v16 offset:3072
    v_pk_mul_f16 v98, v98, v122
    v_mfma_f32_16x16x32_f16 v[88:91], v[200:203], v[180:183], v[88:91]
    ds_read_b128 v[132:135], v16 offset:7168
    v_pk_mul_f16 v99, v99, v123
    v_mfma_f32_16x16x32_f16 v[68:71], v[188:191], v[184:187], v[68:71]
    ds_read_b128 v[136:139], v16 offset:8192
    s_waitcnt lgkmcnt(9)
    v_pk_mul_f16 v100, v100, v120
    v_mfma_f32_16x16x32_f16 v[76:79], v[192:195], v[184:187], v[76:79]
    ds_read_b128 v[140:143], v16 offset:9216
    v_pk_mul_f16 v101, v101, v121
    v_mfma_f32_16x16x32_f16 v[84:87], v[196:199], v[184:187], v[84:87]
    ds_read_b128 v[144:147], v16 offset:10240
    v_pk_mul_f16 v102, v102, v122
    v_mfma_f32_16x16x32_f16 v[92:95], v[200:203], v[184:187], v[92:95]
    v_pk_mul_f16 v103, v103, v123
    s_barrier
    s_waitcnt lgkmcnt(7)
    v_mfma_f32_16x16x32_f16 v[64:67], v[104:107], v[96:99], v[64:67]
    ds_read_b128 v[176:179], v19 offset:4736
    v_pk_mul_f16 v124, v124, v148
    s_waitcnt lgkmcnt(7)
    v_mfma_f32_16x16x32_f16 v[72:75], v[108:111], v[96:99], v[72:75]
    ds_read_b128 v[152:155], v18 offset:40960
    v_pk_mul_f16 v125, v125, v149
    s_waitcnt lgkmcnt(7)
    v_mfma_f32_16x16x32_f16 v[80:83], v[112:115], v[96:99], v[80:83]
    ds_read_b128 v[156:159], v18 offset:41984
    v_pk_mul_f16 v126, v126, v150
    s_waitcnt lgkmcnt(7)
    v_mfma_f32_16x16x32_f16 v[88:91], v[116:119], v[96:99], v[88:91]
    ds_read_b128 v[204:207], v19 offset:4800
    v_pk_mul_f16 v127, v127, v151
    v_mfma_f32_16x16x32_f16 v[68:71], v[104:107], v[100:103], v[68:71]
    ds_read_b128 v[180:183], v18 offset:45056
    v_pk_mul_f16 v128, v128, v148
    v_mfma_f32_16x16x32_f16 v[76:79], v[108:111], v[100:103], v[76:79]
    ds_read_b128 v[184:187], v18 offset:46080
    v_pk_mul_f16 v129, v129, v149
    v_mfma_f32_16x16x32_f16 v[84:87], v[112:115], v[100:103], v[84:87]
    ds_read_b128 v[160:163], v16 offset:14336
    v_pk_mul_f16 v130, v130, v150
    v_mfma_f32_16x16x32_f16 v[92:95], v[116:119], v[100:103], v[92:95]
    v_pk_mul_f16 v131, v131, v151
    s_waitcnt lgkmcnt(10)
    v_mfma_f32_16x16x32_f16 v[64:67], v[132:135], v[124:127], v[64:67]
    ds_read_b128 v[164:167], v16 offset:15360
    s_waitcnt lgkmcnt(6)
    v_pk_mul_f16 v152, v152, v176
    v_mfma_f32_16x16x32_f16 v[72:75], v[136:139], v[124:127], v[72:75]
    ds_read_b128 v[168:171], v16 offset:16384
    v_pk_mul_f16 v153, v153, v177
    v_mfma_f32_16x16x32_f16 v[80:83], v[140:143], v[124:127], v[80:83]
    ds_read_b128 v[172:175], v16 offset:17408
    v_pk_mul_f16 v154, v154, v178
    v_mfma_f32_16x16x32_f16 v[88:91], v[144:147], v[124:127], v[88:91]
    ds_read_b128 v[188:191], v16 offset:21504
    v_pk_mul_f16 v155, v155, v179
    v_mfma_f32_16x16x32_f16 v[68:71], v[132:135], v[128:131], v[68:71]
    ds_read_b128 v[192:195], v16 offset:22528
    s_waitcnt lgkmcnt(9)
    v_pk_mul_f16 v156, v156, v176
    v_mfma_f32_16x16x32_f16 v[76:79], v[136:139], v[128:131], v[76:79]
    ds_read_b128 v[196:199], v16 offset:23552
    v_pk_mul_f16 v157, v157, v177
    v_mfma_f32_16x16x32_f16 v[84:87], v[140:143], v[128:131], v[84:87]
    ds_read_b128 v[200:203], v16 offset:24576
    v_pk_mul_f16 v158, v158, v178
    v_mfma_f32_16x16x32_f16 v[92:95], v[144:147], v[128:131], v[92:95]
    v_pk_mul_f16 v159, v159, v179
    s_barrier
    s_waitcnt lgkmcnt(7)
    v_mfma_f32_16x16x32_f16 v[64:67], v[160:163], v[152:155], v[64:67]
    ds_read_b128 v[120:123], v19 offset:4864
    v_pk_mul_f16 v180, v180, v204
    s_waitcnt lgkmcnt(7)
    v_mfma_f32_16x16x32_f16 v[72:75], v[164:167], v[152:155], v[72:75]
    ds_read_b128 v[96:99], v18 offset:49152
    v_pk_mul_f16 v181, v181, v205
    s_waitcnt lgkmcnt(7)
    v_mfma_f32_16x16x32_f16 v[80:83], v[168:171], v[152:155], v[80:83]
    ds_read_b128 v[100:103], v18 offset:50176
    v_pk_mul_f16 v182, v182, v206
    s_waitcnt lgkmcnt(7)
    v_mfma_f32_16x16x32_f16 v[88:91], v[172:175], v[152:155], v[88:91]
    ds_read_b128 v[148:151], v19 offset:4928
    v_pk_mul_f16 v183, v183, v207
    v_mfma_f32_16x16x32_f16 v[68:71], v[160:163], v[156:159], v[68:71]
    ds_read_b128 v[124:127], v18 offset:53248
    v_pk_mul_f16 v184, v184, v204
    v_mfma_f32_16x16x32_f16 v[76:79], v[164:167], v[156:159], v[76:79]
    ds_read_b128 v[128:131], v18 offset:54272
    v_pk_mul_f16 v185, v185, v205
    v_mfma_f32_16x16x32_f16 v[84:87], v[168:171], v[156:159], v[84:87]
    ds_read_b128 v[104:107], v16 offset:28672
    v_pk_mul_f16 v186, v186, v206
    v_mfma_f32_16x16x32_f16 v[92:95], v[172:175], v[156:159], v[92:95]
    v_pk_mul_f16 v187, v187, v207
    s_waitcnt lgkmcnt(10)
    v_mfma_f32_16x16x32_f16 v[64:67], v[188:191], v[180:183], v[64:67]
    ds_read_b128 v[108:111], v16 offset:29696
    s_waitcnt lgkmcnt(6)
    v_pk_mul_f16 v96, v96, v120
    v_mfma_f32_16x16x32_f16 v[72:75], v[192:195], v[180:183], v[72:75]
    ds_read_b128 v[112:115], v16 offset:30720
    v_pk_mul_f16 v97, v97, v121
    v_mfma_f32_16x16x32_f16 v[80:83], v[196:199], v[180:183], v[80:83]
    ds_read_b128 v[116:119], v16 offset:31744
    v_pk_mul_f16 v98, v98, v122
    v_mfma_f32_16x16x32_f16 v[88:91], v[200:203], v[180:183], v[88:91]
    ds_read_b128 v[132:135], v16 offset:35840
    v_pk_mul_f16 v99, v99, v123
    v_mfma_f32_16x16x32_f16 v[68:71], v[188:191], v[184:187], v[68:71]
    ds_read_b128 v[136:139], v16 offset:36864
    s_waitcnt lgkmcnt(9)
    v_pk_mul_f16 v100, v100, v120
    v_mfma_f32_16x16x32_f16 v[76:79], v[192:195], v[184:187], v[76:79]
    ds_read_b128 v[140:143], v16 offset:37888
    v_pk_mul_f16 v101, v101, v121
    v_mfma_f32_16x16x32_f16 v[84:87], v[196:199], v[184:187], v[84:87]
    ds_read_b128 v[144:147], v16 offset:38912
    v_pk_mul_f16 v102, v102, v122
    v_mfma_f32_16x16x32_f16 v[92:95], v[200:203], v[184:187], v[92:95]
    v_pk_mul_f16 v103, v103, v123
    s_barrier
    s_waitcnt lgkmcnt(7)
    v_mfma_f32_16x16x32_f16 v[64:67], v[104:107], v[96:99], v[64:67]
    ds_read_b128 v[176:179], v19 offset:4992
    v_pk_mul_f16 v124, v124, v148
    s_waitcnt lgkmcnt(7)
    v_mfma_f32_16x16x32_f16 v[72:75], v[108:111], v[96:99], v[72:75]
    ds_read_b128 v[152:155], v18 offset:8192
    v_pk_mul_f16 v125, v125, v149
    s_waitcnt lgkmcnt(7)
    v_mfma_f32_16x16x32_f16 v[80:83], v[112:115], v[96:99], v[80:83]
    ds_read_b128 v[156:159], v18 offset:9216
    v_pk_mul_f16 v126, v126, v150
    s_waitcnt lgkmcnt(7)
    v_mfma_f32_16x16x32_f16 v[88:91], v[116:119], v[96:99], v[88:91]
    ds_read_b128 v[204:207], v19 offset:5056
    v_pk_mul_f16 v127, v127, v151
    v_mfma_f32_16x16x32_f16 v[68:71], v[104:107], v[100:103], v[68:71]
    ds_read_b128 v[180:183], v18 offset:12288
    v_pk_mul_f16 v128, v128, v148
    v_mfma_f32_16x16x32_f16 v[76:79], v[108:111], v[100:103], v[76:79]
    ds_read_b128 v[184:187], v18 offset:13312
    v_pk_mul_f16 v129, v129, v149
    v_mfma_f32_16x16x32_f16 v[84:87], v[112:115], v[100:103], v[84:87]
    ds_read_b128 v[160:163], v16 offset:43008
    v_pk_mul_f16 v130, v130, v150
    v_mfma_f32_16x16x32_f16 v[92:95], v[116:119], v[100:103], v[92:95]
    v_pk_mul_f16 v131, v131, v151
    s_waitcnt lgkmcnt(10)
    v_mfma_f32_16x16x32_f16 v[64:67], v[132:135], v[124:127], v[64:67]
    ds_read_b128 v[164:167], v16 offset:44032
    s_waitcnt lgkmcnt(6)
    v_pk_mul_f16 v152, v152, v176
    v_mfma_f32_16x16x32_f16 v[72:75], v[136:139], v[124:127], v[72:75]
    ds_read_b128 v[168:171], v16 offset:45056
    v_pk_mul_f16 v153, v153, v177
    v_mfma_f32_16x16x32_f16 v[80:83], v[140:143], v[124:127], v[80:83]
    ds_read_b128 v[172:175], v16 offset:46080
    v_pk_mul_f16 v154, v154, v178
    v_mfma_f32_16x16x32_f16 v[88:91], v[144:147], v[124:127], v[88:91]
    ds_read_b128 v[188:191], v16 offset:50176
    v_pk_mul_f16 v155, v155, v179
    v_mfma_f32_16x16x32_f16 v[68:71], v[132:135], v[128:131], v[68:71]
    ds_read_b128 v[192:195], v16 offset:51200
    s_waitcnt lgkmcnt(9)
    v_pk_mul_f16 v156, v156, v176
    v_mfma_f32_16x16x32_f16 v[76:79], v[136:139], v[128:131], v[76:79]
    ds_read_b128 v[196:199], v16 offset:52224
    v_pk_mul_f16 v157, v157, v177
    v_mfma_f32_16x16x32_f16 v[84:87], v[140:143], v[128:131], v[84:87]
    ds_read_b128 v[200:203], v16 offset:53248
    v_pk_mul_f16 v158, v158, v178
    v_mfma_f32_16x16x32_f16 v[92:95], v[144:147], v[128:131], v[92:95]
    v_pk_mul_f16 v159, v159, v179
    v_add_u32 v19, 768, v19
    s_sub_u32 s37, s37, 1
    s_cmp_lg_u32 s37, 0
    s_cbranch_scc1 P4_loop0
    s_waitcnt lgkmcnt(7)
    v_mfma_f32_16x16x32_f16 v[64:67], v[160:163], v[152:155], v[64:67]
    v_pk_mul_f16 v180, v180, v204
    v_pk_mul_f16 v181, v181, v205
    s_waitcnt lgkmcnt(6)
    v_mfma_f32_16x16x32_f16 v[72:75], v[164:167], v[152:155], v[72:75]
    v_pk_mul_f16 v182, v182, v206
    v_pk_mul_f16 v183, v183, v207
    s_waitcnt lgkmcnt(5)
    v_mfma_f32_16x16x32_f16 v[80:83], v[168:171], v[152:155], v[80:83]
    v_pk_mul_f16 v184, v184, v204
    v_pk_mul_f16 v185, v185, v205
    s_waitcnt lgkmcnt(4)
    v_mfma_f32_16x16x32_f16 v[88:91], v[172:175], v[152:155], v[88:91]
    v_pk_mul_f16 v186, v186, v206
    v_pk_mul_f16 v187, v187, v207
    v_mfma_f32_16x16x32_f16 v[68:71], v[160:163], v[156:159], v[68:71]
    v_mfma_f32_16x16x32_f16 v[76:79], v[164:167], v[156:159], v[76:79]
    v_mfma_f32_16x16x32_f16 v[84:87], v[168:171], v[156:159], v[84:87]
    v_mfma_f32_16x16x32_f16 v[92:95], v[172:175], v[156:159], v[92:95]
    s_waitcnt lgkmcnt(3)
    v_mfma_f32_16x16x32_f16 v[64:67], v[188:191], v[180:183], v[64:67]
    s_waitcnt lgkmcnt(2)
    v_mfma_f32_16x16x32_f16 v[72:75], v[192:195], v[180:183], v[72:75]
    s_waitcnt lgkmcnt(1)
    v_mfma_f32_16x16x32_f16 v[80:83], v[196:199], v[180:183], v[80:83]
    s_waitcnt lgkmcnt(0)
    v_mfma_f32_16x16x32_f16 v[88:91], v[200:203], v[180:183], v[88:91]
    v_mfma_f32_16x16x32_f16 v[68:71], v[188:191], v[184:187], v[68:71]
    v_mfma_f32_16x16x32_f16 v[76:79], v[192:195], v[184:187], v[76:79]
    v_mfma_f32_16x16x32_f16 v[84:87], v[196:199], v[184:187], v[84:87]
    v_mfma_f32_16x16x32_f16 v[92:95], v[200:203], v[184:187], v[92:95]
    s_barrier
    ds_read_b64 v[24:25], v21 offset:3072
    s_waitcnt lgkmcnt(0)
    v_pk_fma_f32 v[64:65], v[64:65], s[58:59], v[24:25] op_sel:[0,0,0] op_sel_hi:[1,1,0]
    v_pk_fma_f32 v[66:67], v[66:67], s[58:59], v[24:25] op_sel:[0,0,0] op_sel_hi:[1,1,0]
    v_pk_fma_f32 v[72:73], v[72:73], s[58:59], v[24:25] op_sel:[0,0,0] op_sel_hi:[1,1,0]
    v_pk_fma_f32 v[74:75], v[74:75], s[58:59], v[24:25] op_sel:[0,0,0] op_sel_hi:[1,1,0]
    v_pk_mul_f32 v[64:65], v[64:65], v[32:33]
    v_pk_mul_f32 v[66:67], v[66:67], v[34:35]
    v_pk_mul_f32 v[72:73], v[72:73], v[40:41]
    v_pk_mul_f32 v[74:75], v[74:75], v[42:43]
    v_cvt_pk_bf16_f32 v96, v64, v65
    v_cvt_pk_bf16_f32 v97, v66, v67
    v_cvt_pk_bf16_f32 v98, v72, v73
    v_cvt_pk_bf16_f32 v99, v74, v75
    buffer_store_dwordx4 v[96:99], v3, s[4:7], s47 offen offset:0 sc1
    v_pk_fma_f32 v[68:69], v[68:69], s[58:59], v[24:25] op_sel:[0,0,1] op_sel_hi:[1,1,1]
    v_pk_fma_f32 v[70:71], v[70:71], s[58:59], v[24:25] op_sel:[0,0,1] op_sel_hi:[1,1,1]
    v_pk_fma_f32 v[76:77], v[76:77], s[58:59], v[24:25] op_sel:[0,0,1] op_sel_hi:[1,1,1]
    v_pk_fma_f32 v[78:79], v[78:79], s[58:59], v[24:25] op_sel:[0,0,1] op_sel_hi:[1,1,1]
    v_pk_mul_f32 v[68:69], v[68:69], v[36:37]
    v_pk_mul_f32 v[70:71], v[70:71], v[38:39]
    v_pk_mul_f32 v[76:77], v[76:77], v[44:45]
    v_pk_mul_f32 v[78:79], v[78:79], v[46:47]
    v_cvt_pk_bf16_f32 v100, v68, v69
    v_cvt_pk_bf16_f32 v101, v70, v71
    v_cvt_pk_bf16_f32 v102, v76, v77
    v_cvt_pk_bf16_f32 v103, v78, v79
    buffer_store_dwordx4 v[100:103], v3, s[4:7], s47 offen offset:1024 sc1
    v_pk_fma_f32 v[80:81], v[80:81], s[58:59], v[24:25] op_sel:[0,0,0] op_sel_hi:[1,1,0]
    v_pk_fma_f32 v[82:83], v[82:83], s[58:59], v[24:25] op_sel:[0,0,0] op_sel_hi:[1,1,0]
    v_pk_fma_f32 v[88:89], v[88:89], s[58:59], v[24:25] op_sel:[0,0,0] op_sel_hi:[1,1,0]
    v_pk_fma_f32 v[90:91], v[90:91], s[58:59], v[24:25] op_sel:[0,0,0] op_sel_hi:[1,1,0]
    v_pk_mul_f32 v[80:81], v[80:81], v[48:49]
    v_pk_mul_f32 v[82:83], v[82:83], v[50:51]
    v_pk_mul_f32 v[88:89], v[88:89], v[56:57]
    v_pk_mul_f32 v[90:91], v[90:91], v[58:59]
    v_cvt_pk_bf16_f32 v104, v80, v81
    v_cvt_pk_bf16_f32 v105, v82, v83
    v_cvt_pk_bf16_f32 v106, v88, v89
    v_cvt_pk_bf16_f32 v107, v90, v91
    buffer_store_dwordx4 v[104:107], v3, s[4:7], s56 offen offset:0 sc1
    v_pk_fma_f32 v[84:85], v[84:85], s[58:59], v[24:25] op_sel:[0,0,1] op_sel_hi:[1,1,1]
    v_pk_fma_f32 v[86:87], v[86:87], s[58:59], v[24:25] op_sel:[0,0,1] op_sel_hi:[1,1,1]
    v_pk_fma_f32 v[92:93], v[92:93], s[58:59], v[24:25] op_sel:[0,0,1] op_sel_hi:[1,1,1]
    v_pk_fma_f32 v[94:95], v[94:95], s[58:59], v[24:25] op_sel:[0,0,1] op_sel_hi:[1,1,1]
    v_pk_mul_f32 v[84:85], v[84:85], v[52:53]
    v_pk_mul_f32 v[86:87], v[86:87], v[54:55]
    v_pk_mul_f32 v[92:93], v[92:93], v[60:61]
    v_pk_mul_f32 v[94:95], v[94:95], v[62:63]
    v_cvt_pk_bf16_f32 v108, v84, v85
    v_cvt_pk_bf16_f32 v109, v86, v87
    v_cvt_pk_bf16_f32 v110, v92, v93
    v_cvt_pk_bf16_f32 v111, v94, v95
    buffer_store_dwordx4 v[108:111], v3, s[4:7], s56 offen offset:1024 sc1
    s_branch P4_done
P3b_done1:
    s_nop 1
    s_barrier
    ds_read_b128 v[120:123], v19 offset:4096
    ds_read_b128 v[96:99], v18 offset:0
    ds_read_b128 v[100:103], v18 offset:1024
    ds_read_b128 v[148:151], v19 offset:4160
    ds_read_b128 v[124:127], v18 offset:4096
    ds_read_b128 v[128:131], v18 offset:5120
    ds_read_b128 v[104:107], v16 offset:32768
    ds_read_b128 v[108:111], v16 offset:33792
    ds_read_b128 v[112:115], v16 offset:34816
    ds_read_b128 v[116:119], v20 offset:8192
    ds_read_b128 v[132:135], v16 offset:39936
    ds_read_b128 v[136:139], v16 offset:40960
    ds_read_b128 v[140:143], v16 offset:41984
    ds_read_b128 v[144:147], v20 offset:8320
    s_waitcnt lgkmcnt(12)
    v_pk_mul_f16 v96, v96, v120
    v_pk_mul_f16 v97, v97, v121
    v_pk_mul_f16 v98, v98, v122
    v_pk_mul_f16 v99, v99, v123
    s_waitcnt lgkmcnt(11)
    v_pk_mul_f16 v100, v100, v120
    v_pk_mul_f16 v101, v101, v121
    v_pk_mul_f16 v102, v102, v122
    v_pk_mul_f16 v103, v103, v123
    s_barrier
    s_waitcnt lgkmcnt(7)
    v_mfma_f32_16x16x32_f16 v[64:67], v[104:107], v[96:99], 0
    ds_read_b128 v[176:179], v19 offset:4224
    v_pk_mul_f16 v124, v124, v148
    s_waitcnt lgkmcnt(7)
    v_mfma_f32_16x16x32_f16 v[72:75], v[108:111], v[96:99], 0
    ds_read_b128 v[152:155], v18 offset:8192
    v_pk_mul_f16 v125, v125, v149
    s_waitcnt lgkmcnt(7)
    v_mfma_f32_16x16x32_f16 v[80:83], v[112:115], v[96:99], 0
    ds_read_b128 v[156:159], v18 offset:9216
    v_pk_mul_f16 v126, v126, v150
    s_waitcnt lgkmcnt(7)
    v_mfma_f32_16x16x32_f16 v[88:91], v[116:119], v[96:99], 0
    ds_read_b128 v[204:207], v19 offset:4288
    v_pk_mul_f16 v127, v127, v151
    v_mfma_f32_16x16x32_f16 v[68:71], v[104:107], v[100:103], 0
    ds_read_b128 v[180:183], v18 offset:12288
    v_pk_mul_f16 v128, v128, v148
    v_mfma_f32_16x16x32_f16 v[76:79], v[108:111], v[100:103], 0
    ds_read_b128 v[184:187], v18 offset:13312
    v_pk_mul_f16 v129, v129, v149
    v_mfma_f32_16x16x32_f16 v[84:87], v[112:115], v[100:103], 0
    ds_read_b128 v[160:163], v16 offset:47104
    v_pk_mul_f16 v130, v130, v150
    v_mfma_f32_16x16x32_f16 v[92:95], v[116:119], v[100:103], 0
    v_pk_mul_f16 v131, v131, v151
    s_waitcnt lgkmcnt(10)
    v_mfma_f32_16x16x32_f16 v[64:67], v[132:135], v[124:127], v[64:67]
    ds_read_b128 v[164:167], v16 offset:48128
    s_waitcnt lgkmcnt(6)
    v_pk_mul_f16 v152, v152, v176
    v_mfma_f32_16x16x32_f16 v[72:75], v[136:139], v[124:127], v[72:75]
    ds_read_b128 v[168:171], v16 offset:49152
    v_pk_mul_f16 v153, v153, v177
    v_mfma_f32_16x16x32_f16 v[80:83], v[140:143], v[124:127], v[80:83]
    ds_read_b128 v[172:175], v20 offset:8448
    v_pk_mul_f16 v154, v154, v178
    v_mfma_f32_16x16x32_f16 v[88:91], v[144:147], v[124:127], v[88:91]
    ds_read_b128 v[188:191], v16 offset:54272
    v_pk_mul_f16 v155, v155, v179
    v_mfma_f32_16x16x32_f16 v[68:71], v[132:135], v[128:131], v[68:71]
    ds_read_b128 v[192:195], v16 offset:55296
    s_waitcnt lgkmcnt(9)
    v_pk_mul_f16 v156, v156, v176
    v_mfma_f32_16x16x32_f16 v[76:79], v[136:139], v[128:131], v[76:79]
    ds_read_b128 v[196:199], v16 offset:56320
    v_pk_mul_f16 v157, v157, v177
    v_mfma_f32_16x16x32_f16 v[84:87], v[140:143], v[128:131], v[84:87]
    ds_read_b128 v[200:203], v20 offset:8576
    v_pk_mul_f16 v158, v158, v178
    v_mfma_f32_16x16x32_f16 v[92:95], v[144:147], v[128:131], v[92:95]
    v_pk_mul_f16 v159, v159, v179
    s_mov_b32 s37, 5
P4_loop1:
    s_barrier
    s_waitcnt lgkmcnt(7)
    v_mfma_f32_16x16x32_f16 v[64:67], v[160:163], v[152:155], v[64:67]
    ds_read_b128 v[120:123], v19 offset:4352
    v_pk_mul_f16 v180, v180, v204
    s_waitcnt lgkmcnt(7)
    v_mfma_f32_16x16x32_f16 v[72:75], v[164:167], v[152:155], v[72:75]
    ds_read_b128 v[96:99], v18 offset:16384
    v_pk_mul_f16 v181, v181, v205
    s_waitcnt lgkmcnt(7)
    v_mfma_f32_16x16x32_f16 v[80:83], v[168:171], v[152:155], v[80:83]
    ds_read_b128 v[100:103], v18 offset:17408
    v_pk_mul_f16 v182, v182, v206
    s_waitcnt lgkmcnt(7)
    v_mfma_f32_16x16x32_f16 v[88:91], v[172:175], v[152:155], v[88:91]
    ds_read_b128 v[148:151], v19 offset:4416
    v_pk_mul_f16 v183, v183, v207
    v_mfma_f32_16x16x32_f16 v[68:71], v[160:163], v[156:159], v[68:71]
    ds_read_b128 v[124:127], v18 offset:20480
    v_pk_mul_f16 v184, v184, v204
    v_mfma_f32_16x16x32_f16 v[76:79], v[164:167], v[156:159], v[76:79]
    ds_read_b128 v[128:131], v18 offset:21504
    v_pk_mul_f16 v185, v185, v205
    v_mfma_f32_16x16x32_f16 v[84:87], v[168:171], v[156:159], v[84:87]
    ds_read_b128 v[104:107], v16 offset:61440
    v_pk_mul_f16 v186, v186, v206
    v_mfma_f32_16x16x32_f16 v[92:95], v[172:175], v[156:159], v[92:95]
    v_pk_mul_f16 v187, v187, v207
    s_waitcnt lgkmcnt(10)
    v_mfma_f32_16x16x32_f16 v[64:67], v[188:191], v[180:183], v[64:67]
    ds_read_b128 v[108:111], v16 offset:62464
    s_waitcnt lgkmcnt(6)
    v_pk_mul_f16 v96, v96, v120
    v_mfma_f32_16x16x32_f16 v[72:75], v[192:195], v[180:183], v[72:75]
    ds_read_b128 v[112:115], v16 offset:63488
    v_pk_mul_f16 v97, v97, v121
    v_mfma_f32_16x16x32_f16 v[80:83], v[196:199], v[180:183], v[80:83]
    ds_read_b128 v[116:119], v20 offset:8704
    v_pk_mul_f16 v98, v98, v122
    v_mfma_f32_16x16x32_f16 v[88:91], v[200:203], v[180:183], v[88:91]
    ds_read_b128 v[132:135], v17 offset:3072
    v_pk_mul_f16 v99, v99, v123
    v_mfma_f32_16x16x32_f16 v[68:71], v[188:191], v[184:187], v[68:71]
    ds_read_b128 v[136:139], v17 offset:4096
    s_waitcnt lgkmcnt(9)
    v_pk_mul_f16 v100, v100, v120
    v_mfma_f32_16x16x32_f16 v[76:79], v[192:195], v[184:187], v[76:79]
    ds_read_b128 v[140:143], v17 offset:5120
    v_pk_mul_f16 v101, v101, v121
    v_mfma_f32_16x16x32_f16 v[84:87], v[196:199], v[184:187], v[84:87]
    ds_read_b128 v[144:147], v20 offset:8832
    v_pk_mul_f16 v102, v102, v122
    v_mfma_f32_16x16x32_f16 v[92:95], v[200:203], v[184:187], v[92:95]
    v_pk_mul_f16 v103, v103, v123
    s_barrier
    s_waitcnt lgkmcnt(7)
    v_mfma_f32_16x16x32_f16 v[64:67], v[104:107], v[96:99], v[64:67]
    ds_read_b128 v[176:179], v19 offset:4480
    v_pk_mul_f16 v124, v124, v148
    s_waitcnt lgkmcnt(7)
    v_mfma_f32_16x16x32_f16 v[72:75], v[108:111], v[96:99], v[72:75]
    ds_read_b128 v[152:155], v18 offset:24576
    v_pk_mul_f16 v125, v125, v149
    s_waitcnt lgkmcnt(7)
    v_mfma_f32_16x16x32_f16 v[80:83], v[112:115], v[96:99], v[80:83]
    ds_read_b128 v[156:159], v18 offset:25600
    v_pk_mul_f16 v126, v126, v150
    s_waitcnt lgkmcnt(7)
    v_mfma_f32_16x16x32_f16 v[88:91], v[116:119], v[96:99], v[88:91]
    ds_read_b128 v[204:207], v19 offset:4544
    v_pk_mul_f16 v127, v127, v151
    v_mfma_f32_16x16x32_f16 v[68:71], v[104:107], v[100:103], v[68:71]
    ds_read_b128 v[180:183], v18 offset:28672
    v_pk_mul_f16 v128, v128, v148
    v_mfma_f32_16x16x32_f16 v[76:79], v[108:111], v[100:103], v[76:79]
    ds_read_b128 v[184:187], v18 offset:29696
    v_pk_mul_f16 v129, v129, v149
    v_mfma_f32_16x16x32_f16 v[84:87], v[112:115], v[100:103], v[84:87]
    ds_read_b128 v[160:163], v17 offset:10240
    v_pk_mul_f16 v130, v130, v150
    v_mfma_f32_16x16x32_f16 v[92:95], v[116:119], v[100:103], v[92:95]
    v_pk_mul_f16 v131, v131, v151
    s_waitcnt lgkmcnt(10)
    v_mfma_f32_16x16x32_f16 v[64:67], v[132:135], v[124:127], v[64:67]
    ds_read_b128 v[164:167], v17 offset:11264
    s_waitcnt lgkmcnt(6)
    v_pk_mul_f16 v152, v152, v176
    v_mfma_f32_16x16x32_f16 v[72:75], v[136:139], v[124:127], v[72:75]
    ds_read_b128 v[168:171], v17 offset:12288
    v_pk_mul_f16 v153, v153, v177
    v_mfma_f32_16x16x32_f16 v[80:83], v[140:143], v[124:127], v[80:83]
    ds_read_b128 v[172:175], v20 offset:8960
    v_pk_mul_f16 v154, v154, v178
    v_mfma_f32_16x16x32_f16 v[88:91], v[144:147], v[124:127], v[88:91]
    ds_read_b128 v[188:191], v17 offset:17408
    v_pk_mul_f16 v155, v155, v179
    v_mfma_f32_16x16x32_f16 v[68:71], v[132:135], v[128:131], v[68:71]
    ds_read_b128 v[192:195], v17 offset:18432
    s_waitcnt lgkmcnt(9)
    v_pk_mul_f16 v156, v156, v176
    v_mfma_f32_16x16x32_f16 v[76:79], v[136:139], v[128:131], v[76:79]
    ds_read_b128 v[196:199], v17 offset:19456
    v_pk_mul_f16 v157, v157, v177
    v_mfma_f32_16x16x32_f16 v[84:87], v[140:143], v[128:131], v[84:87]
    ds_read_b128 v[200:203], v20 offset:9088
    v_pk_mul_f16 v158, v158, v178
    v_mfma_f32_16x16x32_f16 v[92:95], v[144:147], v[128:131], v[92:95]
    v_pk_mul_f16 v159, v159, v179
    s_barrier
    s_waitcnt lgkmcnt(7)
    v_mfma_f32_16x16x32_f16 v[64:67], v[160:163], v[152:155], v[64:67]
    ds_read_b128 v[120:123], v19 offset:4608
    v_pk_mul_f16 v180, v180, v204
    s_waitcnt lgkmcnt(7)
    v_mfma_f32_16x16x32_f16 v[72:75], v[164:167], v[152:155], v[72:75]
    ds_read_b128 v[96:99], v18 offset:32768
    v_pk_mul_f16 v181, v181, v205
    s_waitcnt lgkmcnt(7)
    v_mfma_f32_16x16x32_f16 v[80:83], v[168:171], v[152:155], v[80:83]
    ds_read_b128 v[100:103], v18 offset:33792
    v_pk_mul_f16 v182, v182, v206
    s_waitcnt lgkmcnt(7)
    v_mfma_f32_16x16x32_f16 v[88:91], v[172:175], v[152:155], v[88:91]
    ds_read_b128 v[148:151], v19 offset:4672
    v_pk_mul_f16 v183, v183, v207
    v_mfma_f32_16x16x32_f16 v[68:71], v[160:163], v[156:159], v[68:71]
    ds_read_b128 v[124:127], v18 offset:36864
    v_pk_mul_f16 v184, v184, v204
    v_mfma_f32_16x16x32_f16 v[76:79], v[164:167], v[156:159], v[76:79]
    ds_read_b128 v[128:131], v18 offset:37888
    v_pk_mul_f16 v185, v185, v205
    v_mfma_f32_16x16x32_f16 v[84:87], v[168:171], v[156:159], v[84:87]
    ds_read_b128 v[104:107], v16 offset:4096
    v_pk_mul_f16 v186, v186, v206
    v_mfma_f32_16x16x32_f16 v[92:95], v[172:175], v[156:159], v[92:95]
    v_pk_mul_f16 v187, v187, v207
    s_waitcnt lgkmcnt(10)
    v_mfma_f32_16x16x32_f16 v[64:67], v[188:191], v[180:183], v[64:67]
    ds_read_b128 v[108:111], v16 offset:5120
    s_waitcnt lgkmcnt(6)
    v_pk_mul_f16 v96, v96, v120
    v_mfma_f32_16x16x32_f16 v[72:75], v[192:195], v[180:183], v[72:75]
    ds_read_b128 v[112:115], v16 offset:6144
    v_pk_mul_f16 v97, v97, v121
    v_mfma_f32_16x16x32_f16 v[80:83], v[196:199], v[180:183], v[80:83]
    ds_read_b128 v[116:119], v20 offset:9216
    v_pk_mul_f16 v98, v98, v122
    v_mfma_f32_16x16x32_f16 v[88:91], v[200:203], v[180:183], v[88:91]
    ds_read_b128 v[132:135], v16 offset:11264
    v_pk_mul_f16 v99, v99, v123
    v_mfma_f32_16x16x32_f16 v[68:71], v[188:191], v[184:187], v[68:71]
    ds_read_b128 v[136:139], v16 offset:12288
    s_waitcnt lgkmcnt(9)
    v_pk_mul_f16 v100, v100, v120
    v_mfma_f32_16x16x32_f16 v[76:79], v[192:195], v[184:187], v[76:79]
    ds_read_b128 v[140:143], v16 offset:13312
    v_pk_mul_f16 v101, v101, v121
    v_mfma_f32_16x16x32_f16 v[84:87], v[196:199], v[184:187], v[84:87]
    ds_read_b128 v[144:147], v20 offset:9344
    v_pk_mul_f16 v102, v102, v122
    v_mfma_f32_16x16x32_f16 v[92:95], v[200:203], v[184:187], v[92:95]
    v_pk_mul_f16 v103, v103, v123
    s_barrier
    s_waitcnt lgkmcnt(7)
    v_mfma_f32_16x16x32_f16 v[64:67], v[104:107], v[96:99], v[64:67]
    ds_read_b128 v[176:179], v19 offset:4736
    v_pk_mul_f16 v124, v124, v148
    s_waitcnt lgkmcnt(7)
    v_mfma_f32_16x16x32_f16 v[72:75], v[108:111], v[96:99], v[72:75]
    ds_read_b128 v[152:155], v18 offset:40960
    v_pk_mul_f16 v125, v125, v149
    s_waitcnt lgkmcnt(7)
    v_mfma_f32_16x16x32_f16 v[80:83], v[112:115], v[96:99], v[80:83]
    ds_read_b128 v[156:159], v18 offset:41984
    v_pk_mul_f16 v126, v126, v150
    s_waitcnt lgkmcnt(7)
    v_mfma_f32_16x16x32_f16 v[88:91], v[116:119], v[96:99], v[88:91]
    ds_read_b128 v[204:207], v19 offset:4800
    v_pk_mul_f16 v127, v127, v151
    v_mfma_f32_16x16x32_f16 v[68:71], v[104:107], v[100:103], v[68:71]
    ds_read_b128 v[180:183], v18 offset:45056
    v_pk_mul_f16 v128, v128, v148
    v_mfma_f32_16x16x32_f16 v[76:79], v[108:111], v[100:103], v[76:79]
    ds_read_b128 v[184:187], v18 offset:46080
    v_pk_mul_f16 v129, v129, v149
    v_mfma_f32_16x16x32_f16 v[84:87], v[112:115], v[100:103], v[84:87]
    ds_read_b128 v[160:163], v16 offset:18432
    v_pk_mul_f16 v130, v130, v150
    v_mfma_f32_16x16x32_f16 v[92:95], v[116:119], v[100:103], v[92:95]
    v_pk_mul_f16 v131, v131, v151
    s_waitcnt lgkmcnt(10)
    v_mfma_f32_16x16x32_f16 v[64:67], v[132:135], v[124:127], v[64:67]
    ds_read_b128 v[164:167], v16 offset:19456
    s_waitcnt lgkmcnt(6)
    v_pk_mul_f16 v152, v152, v176
    v_mfma_f32_16x16x32_f16 v[72:75], v[136:139], v[124:127], v[72:75]
    ds_read_b128 v[168:171], v16 offset:20480
    v_pk_mul_f16 v153, v153, v177
    v_mfma_f32_16x16x32_f16 v[80:83], v[140:143], v[124:127], v[80:83]
    ds_read_b128 v[172:175], v20 offset:9472
    v_pk_mul_f16 v154, v154, v178
    v_mfma_f32_16x16x32_f16 v[88:91], v[144:147], v[124:127], v[88:91]
    ds_read_b128 v[188:191], v16 offset:25600
    v_pk_mul_f16 v155, v155, v179
    v_mfma_f32_16x16x32_f16 v[68:71], v[132:135], v[128:131], v[68:71]
    ds_read_b128 v[192:195], v16 offset:26624
    s_waitcnt lgkmcnt(9)
    v_pk_mul_f16 v156, v156, v176
    v_mfma_f32_16x16x32_f16 v[76:79], v[136:139], v[128:131], v[76:79]
    ds_read_b128 v[196:199], v16 offset:27648
    v_pk_mul_f16 v157, v157, v177
    v_mfma_f32_16x16x32_f16 v[84:87], v[140:143], v[128:131], v[84:87]
    ds_read_b128 v[200:203], v20 offset:9600
    v_pk_mul_f16 v158, v158, v178
    v_mfma_f32_16x16x32_f16 v[92:95], v[144:147], v[128:131], v[92:95]
    v_pk_mul_f16 v159, v159, v179
    s_barrier
    s_waitcnt lgkmcnt(7)
    v_mfma_f32_16x16x32_f16 v[64:67], v[160:163], v[152:155], v[64:67]
    ds_read_b128 v[120:123], v19 offset:4864
    v_pk_mul_f16 v180, v180, v204
    s_waitcnt lgkmcnt(7)
    v_mfma_f32_16x16x32_f16 v[72:75], v[164:167], v[152:155], v[72:75]
    ds_read_b128 v[96:99], v18 offset:49152
    v_pk_mul_f16 v181, v181, v205
    s_waitcnt lgkmcnt(7)
    v_mfma_f32_16x16x32_f16 v[80:83], v[168:171], v[152:155], v[80:83]
    ds_read_b128 v[100:103], v18 offset:50176
    v_pk_mul_f16 v182, v182, v206
    s_waitcnt lgkmcnt(7)
    v_mfma_f32_16x16x32_f16 v[88:91], v[172:175], v[152:155], v[88:91]
    ds_read_b128 v[148:151], v19 offset:4928
    v_pk_mul_f16 v183, v183, v207
    v_mfma_f32_16x16x32_f16 v[68:71], v[160:163], v[156:159], v[68:71]
    ds_read_b128 v[124:127], v18 offset:53248
    v_pk_mul_f16 v184, v184, v204
    v_mfma_f32_16x16x32_f16 v[76:79], v[164:167], v[156:159], v[76:79]
    ds_read_b128 v[128:131], v18 offset:54272
    v_pk_mul_f16 v185, v185, v205
    v_mfma_f32_16x16x32_f16 v[84:87], v[168:171], v[156:159], v[84:87]
    ds_read_b128 v[104:107], v16 offset:32768
    v_pk_mul_f16 v186, v186, v206
    v_mfma_f32_16x16x32_f16 v[92:95], v[172:175], v[156:159], v[92:95]
    v_pk_mul_f16 v187, v187, v207
    s_waitcnt lgkmcnt(10)
    v_mfma_f32_16x16x32_f16 v[64:67], v[188:191], v[180:183], v[64:67]
    ds_read_b128 v[108:111], v16 offset:33792
    s_waitcnt lgkmcnt(6)
    v_pk_mul_f16 v96, v96, v120
    v_mfma_f32_16x16x32_f16 v[72:75], v[192:195], v[180:183], v[72:75]
    ds_read_b128 v[112:115], v16 offset:34816
    v_pk_mul_f16 v97, v97, v121
    v_mfma_f32_16x16x32_f16 v[80:83], v[196:199], v[180:183], v[80:83]
    ds_read_b128 v[116:119], v20 offset:9728
    v_pk_mul_f16 v98, v98, v122
    v_mfma_f32_16x16x32_f16 v[88:91], v[200:203], v[180:183], v[88:91]
    ds_read_b128 v[132:135], v16 offset:39936
    v_pk_mul_f16 v99, v99, v123
    v_mfma_f32_16x16x32_f16 v[68:71], v[188:191], v[184:187], v[68:71]
    ds_read_b128 v[136:139], v16 offset:40960
    s_waitcnt lgkmcnt(9)
    v_pk_mul_f16 v100, v100, v120
    v_mfma_f32_16x16x32_f16 v[76:79], v[192:195], v[184:187], v[76:79]
    ds_read_b128 v[140:143], v16 offset:41984
    v_pk_mul_f16 v101, v101, v121
    v_mfma_f32_16x16x32_f16 v[84:87], v[196:199], v[184:187], v[84:87]
    ds_read_b128 v[144:147], v20 offset:9856
    v_pk_mul_f16 v102, v102, v122
    v_mfma_f32_16x16x32_f16 v[92:95], v[200:203], v[184:187], v[92:95]
    v_pk_mul_f16 v103, v103, v123
    s_barrier
    s_waitcnt lgkmcnt(7)
    v_mfma_f32_16x16x32_f16 v[64:67], v[104:107], v[96:99], v[64:67]
    ds_read_b128 v[176:179], v19 offset:4992
    v_pk_mul_f16 v124, v124, v148
    s_waitcnt lgkmcnt(7)
    v_mfma_f32_16x16x32_f16 v[72:75], v[108:111], v[96:99], v[72:75]
    ds_read_b128 v[152:155], v18 offset:8192
    v_pk_mul_f16 v125, v125, v149
    s_waitcnt lgkmcnt(7)
    v_mfma_f32_16x16x32_f16 v[80:83], v[112:115], v[96:99], v[80:83]
    ds_read_b128 v[156:159], v18 offset:9216
    v_pk_mul_f16 v126, v126, v150
    s_waitcnt lgkmcnt(7)
    v_mfma_f32_16x16x32_f16 v[88:91], v[116:119], v[96:99], v[88:91]
    ds_read_b128 v[204:207], v19 offset:5056
    v_pk_mul_f16 v127, v127, v151
    v_mfma_f32_16x16x32_f16 v[68:71], v[104:107], v[100:103], v[68:71]
    ds_read_b128 v[180:183], v18 offset:12288
    v_pk_mul_f16 v128, v128, v148
    v_mfma_f32_16x16x32_f16 v[76:79], v[108:111], v[100:103], v[76:79]
    ds_read_b128 v[184:187], v18 offset:13312
    v_pk_mul_f16 v129, v129, v149
    v_mfma_f32_16x16x32_f16 v[84:87], v[112:115], v[100:103], v[84:87]
    ds_read_b128 v[160:163], v16 offset:47104
    v_pk_mul_f16 v130, v130, v150
    v_mfma_f32_16x16x32_f16 v[92:95], v[116:119], v[100:103], v[92:95]
    v_pk_mul_f16 v131, v131, v151
    s_waitcnt lgkmcnt(10)
    v_mfma_f32_16x16x32_f16 v[64:67], v[132:135], v[124:127], v[64:67]
    ds_read_b128 v[164:167], v16 offset:48128
    s_waitcnt lgkmcnt(6)
    v_pk_mul_f16 v152, v152, v176
    v_mfma_f32_16x16x32_f16 v[72:75], v[136:139], v[124:127], v[72:75]
    ds_read_b128 v[168:171], v16 offset:49152
    v_pk_mul_f16 v153, v153, v177
    v_mfma_f32_16x16x32_f16 v[80:83], v[140:143], v[124:127], v[80:83]
    ds_read_b128 v[172:175], v20 offset:9984
    v_pk_mul_f16 v154, v154, v178
    v_mfma_f32_16x16x32_f16 v[88:91], v[144:147], v[124:127], v[88:91]
    ds_read_b128 v[188:191], v16 offset:54272
    v_pk_mul_f16 v155, v155, v179
    v_mfma_f32_16x16x32_f16 v[68:71], v[132:135], v[128:131], v[68:71]
    ds_read_b128 v[192:195], v16 offset:55296
    s_waitcnt lgkmcnt(9)
    v_pk_mul_f16 v156, v156, v176
    v_mfma_f32_16x16x32_f16 v[76:79], v[136:139], v[128:131], v[76:79]
    ds_read_b128 v[196:199], v16 offset:56320
    v_pk_mul_f16 v157, v157, v177
    v_mfma_f32_16x16x32_f16 v[84:87], v[140:143], v[128:131], v[84:87]
    ds_read_b128 v[200:203], v20 offset:10112
    v_pk_mul_f16 v158, v158, v178
    v_mfma_f32_16x16x32_f16 v[92:95], v[144:147], v[128:131], v[92:95]
    v_pk_mul_f16 v159, v159, v179
    v_add_u32 v19, 768, v19
    v_add_u32 v20, 1536, v20
    s_sub_u32 s37, s37, 1
    s_cmp_lg_u32 s37, 0
    s_cbranch_scc1 P4_loop1
    s_waitcnt lgkmcnt(7)
    v_mfma_f32_16x16x32_f16 v[64:67], v[160:163], v[152:155], v[64:67]
    v_pk_mul_f16 v180, v180, v204
    v_pk_mul_f16 v181, v181, v205
    s_waitcnt lgkmcnt(6)
    v_mfma_f32_16x16x32_f16 v[72:75], v[164:167], v[152:155], v[72:75]
    v_pk_mul_f16 v182, v182, v206
    v_pk_mul_f16 v183, v183, v207
    s_waitcnt lgkmcnt(5)
    v_mfma_f32_16x16x32_f16 v[80:83], v[168:171], v[152:155], v[80:83]
    v_pk_mul_f16 v184, v184, v204
    v_pk_mul_f16 v185, v185, v205
    s_waitcnt lgkmcnt(4)
    v_mfma_f32_16x16x32_f16 v[88:91], v[172:175], v[152:155], v[88:91]
    v_pk_mul_f16 v186, v186, v206
    v_pk_mul_f16 v187, v187, v207
    v_mfma_f32_16x16x32_f16 v[68:71], v[160:163], v[156:159], v[68:71]
    v_mfma_f32_16x16x32_f16 v[76:79], v[164:167], v[156:159], v[76:79]
    v_mfma_f32_16x16x32_f16 v[84:87], v[168:171], v[156:159], v[84:87]
    v_mfma_f32_16x16x32_f16 v[92:95], v[172:175], v[156:159], v[92:95]
    s_waitcnt lgkmcnt(0)
    v_mfma_f32_16x16x32_f16 v[88:91], v[200:203], v[180:183], v[88:91]
    v_mfma_f32_16x16x32_f16 v[92:95], v[200:203], v[184:187], v[92:95]
    v_mfma_f32_16x16x32_f16 v[64:67], v[188:191], v[180:183], v[64:67]
    v_mfma_f32_16x16x32_f16 v[72:75], v[192:195], v[180:183], v[72:75]
    v_mfma_f32_16x16x32_f16 v[80:83], v[196:199], v[180:183], v[80:83]
    s_nop 3
    v_add_f32 v208, v88, v89
    v_add_f32 v209, v92, v93
    v_fma_f32 v24, -v208, s58, v24
    v_fma_f32 v25, -v209, s58, v25
    ds_write_b64 v21, v[24:25] offset:3072
    v_mfma_f32_16x16x32_f16 v[68:71], v[188:191], v[184:187], v[68:71]
    v_mfma_f32_16x16x32_f16 v[76:79], v[192:195], v[184:187], v[76:79]
    v_mfma_f32_16x16x32_f16 v[84:87], v[196:199], v[184:187], v[84:87]
    s_waitcnt lgkmcnt(0)
    s_barrier
    v_pk_fma_f32 v[64:65], v[64:65], s[58:59], v[24:25] op_sel:[0,0,0] op_sel_hi:[1,1,0]
    v_pk_fma_f32 v[66:67], v[66:67], s[58:59], v[24:25] op_sel:[0,0,0] op_sel_hi:[1,1,0]
    v_pk_fma_f32 v[72:73], v[72:73], s[58:59], v[24:25] op_sel:[0,0,0] op_sel_hi:[1,1,0]
    v_pk_fma_f32 v[74:75], v[74:75], s[58:59], v[24:25] op_sel:[0,0,0] op_sel_hi:[1,1,0]
    v_pk_mul_f32 v[64:65], v[64:65], v[32:33]
    v_pk_mul_f32 v[66:67], v[66:67], v[34:35]
    v_pk_mul_f32 v[72:73], v[72:73], v[40:41]
    v_pk_mul_f32 v[74:75], v[74:75], v[42:43]
    v_cvt_pk_bf16_f32 v96, v64, v65
    v_cvt_pk_bf16_f32 v97, v66, v67
    v_cvt_pk_bf16_f32 v98, v72, v73
    v_cvt_pk_bf16_f32 v99, v74, v75
    buffer_store_dwordx4 v[96:99], v3, s[4:7], s47 offen offset:0 sc1
    v_pk_fma_f32 v[68:69], v[68:69], s[58:59], v[24:25] op_sel:[0,0,1] op_sel_hi:[1,1,1]
    v_pk_fma_f32 v[70:71], v[70:71], s[58:59], v[24:25] op_sel:[0,0,1] op_sel_hi:[1,1,1]
    v_pk_fma_f32 v[76:77], v[76:77], s[58:59], v[24:25] op_sel:[0,0,1] op_sel_hi:[1,1,1]
    v_pk_fma_f32 v[78:79], v[78:79], s[58:59], v[24:25] op_sel:[0,0,1] op_sel_hi:[1,1,1]
    v_pk_mul_f32 v[68:69], v[68:69], v[36:37]
    v_pk_mul_f32 v[70:71], v[70:71], v[38:39]
    v_pk_mul_f32 v[76:77], v[76:77], v[44:45]
    v_pk_mul_f32 v[78:79], v[78:79], v[46:47]
    v_cvt_pk_bf16_f32 v100, v68, v69
    v_cvt_pk_bf16_f32 v101, v70, v71
    v_cvt_pk_bf16_f32 v102, v76, v77
    v_cvt_pk_bf16_f32 v103, v78, v79
    buffer_store_dwordx4 v[100:103], v3, s[4:7], s47 offen offset:1024 sc1
    s_cmp_eq_u32 s38, 2
    s_cbranch_scc1 P4_done
    v_pk_fma_f32 v[80:81], v[80:81], s[58:59], v[24:25] op_sel:[0,0,0] op_sel_hi:[1,1,0]
    v_pk_fma_f32 v[82:83], v[82:83], s[58:59], v[24:25] op_sel:[0,0,0] op_sel_hi:[1,1,0]
    v_pk_mul_f32 v[80:81], v[80:81], v[48:49]
    v_pk_mul_f32 v[82:83], v[82:83], v[50:51]
    v_cvt_pk_bf16_f32 v104, v80, v81
    v_cvt_pk_bf16_f32 v105, v82, v83
    buffer_store_dwordx2 v[104:105], v22, s[4:7], s46 offen offset:0 sc1
    v_pk_fma_f32 v[84:85], v[84:85], s[58:59], v[24:25] op_sel:[0,0,1] op_sel_hi:[1,1,1]
    v_pk_fma_f32 v[86:87], v[86:87], s[58:59], v[24:25] op_sel:[0,0,1] op_sel_hi:[1,1,1]
    v_pk_mul_f32 v[84:85], v[84:85], v[52:53]
    v_pk_mul_f32 v[86:87], v[86:87], v[54:55]
    v_cvt_pk_bf16_f32 v108, v84, v85
    v_cvt_pk_bf16_f32 v109, v86, v87
    buffer_store_dwordx2 v[108:109], v22, s[4:7], s46 offen offset:1024 sc1
P4_done:
    s_nop 1
    v_lshlrev_b32 v8, 3, v0
    s_lshl_b32 s33, s50, 2
    s_add_u32 s33, s33, s13
    s_lshl_b32 s34, s33, 10
    s_lshl_b32 s31, s51, 18
    s_add_u32 s31, s31, s34
    s_lshr_b32 s32, s51, 1
    s_add_u32 s32, s32, 16
    s_lshl_b32 s32, s32, 17
    s_add_u32 s32, s32, s34
    s_and_b32 s35, s51, 1
    s_lshl_b32 s35, s35, 9
    s_add_u32 s32, s32, s35
    s_add_u32 s35, s12, 5373952
    s_add_u32 s36, s35, s31
    s_add_u32 s37, s36, 131072
    s_add_u32 s35, s35, s32
    buffer_load_dwordx4 v[160:163], v3, s[4:7], s36 offen sc1
    buffer_load_dwordx4 v[164:167], v3, s[4:7], s37 offen sc1
    buffer_load_dwordx2 v[168:169], v8, s[4:7], s35 offen sc1
    s_lshl_b32 s30, s13, 10
    v_add_u32 v13, s30, v3
    v_add_u32 v4, 20480, v13
    v_add_u32 v6, 81920, v3
    v_add_u32 v7, 147456, v3
    s_add_u32 s30, s30, 20480
    v_add_u32 v5, s30, v8
    s_add_u32 s35, s12, 19677184
    s_add_u32 s36, s35, s31
    s_add_u32 s37, s36, 131072
    s_add_u32 s35, s35, s32
    s_lshl_b32 s39, s51, 14
    s_lshl_b32 s40, s33, 7
    s_add_u32 s39, s39, s40
    s_add_u32 s39, s39, s12
    s_add_u32 s39, s39, 22298624
    v_mov_b32 v172, 0
    v_mov_b32 v173, 0
    v_mov_b32 v174, 0x3f803f80
    v_lshlrev_b32 v177, 3, v2
    s_waitcnt vmcnt(3)
    s_barrier
    v_mov_b32 v178, 0
    v_mov_b32 v179, 0
    s_mul_i32 s41, s13, 2816
    s_add_u32 s41, s41, 4096
    v_mul_u32_u24 v200, 176, v2
    v_lshl_add_u32 v200, v1, 3, v200
    v_add_u32 v200, s41, v200
    v_add_u32 v201, 0, v0
    v_mul_u32_u24 v202, 205, v201
    v_lshrrev_b32 v202, 11, v202
    v_mul_u32_u24 v203, 10, v202
    v_sub_u32 v203, v201, v203
    v_lshlrev_b32 v203, 4, v203
    v_mul_u32_u24 v180, 176, v202
    v_add3_u32 v180, v180, v203, s41
    v_mul_u32_u24 v184, 1280, v202
    v_add_u32 v184, v184, v203
    v_add_u32 v201, 64, v0
    v_mul_u32_u24 v202, 205, v201
    v_lshrrev_b32 v202, 11, v202
    v_mul_u32_u24 v203, 10, v202
    v_sub_u32 v203, v201, v203
    v_lshlrev_b32 v203, 4, v203
    v_mul_u32_u24 v181, 176, v202
    v_add3_u32 v181, v181, v203, s41
    v_mul_u32_u24 v185, 1280, v202
    v_add_u32 v185, v185, v203
    v_add_u32 v201, 128, v0
    v_mul_u32_u24 v202, 205, v201
    v_lshrrev_b32 v202, 11, v202
    v_mul_u32_u24 v203, 10, v202
    v_sub_u32 v203, v201, v203
    v_lshlrev_b32 v203, 4, v203
    v_mul_u32_u24 v182, 176, v202
    v_add3_u32 v182, v182, v203, s41
    v_mul_u32_u24 v186, 1280, v202
    v_add_u32 v186, v186, v203
    s_mul_i32 s42, s33, 20480
    s_mul_i32 s43, s51, 160
    s_add_u32 s42, s42, s43
    s_mov_b32 s8, s24
    s_and_b32 s9, s25, 0xffff
    s_mov_b32 s10, 2621440
    s_mov_b32 s11, 0x00020000
    s_mov_b32 s38, 0xffff0000
    s_waitcnt vmcnt(0)
    v_lshlrev_b32 v32, 16, v160
    v_and_b32 v33, s38, v160
    v_lshlrev_b32 v34, 16, v161
    v_and_b32 v35, s38, v161
    v_lshlrev_b32 v36, 16, v162
    v_and_b32 v37, s38, v162
    v_lshlrev_b32 v38, 16, v163
    v_and_b32 v39, s38, v163
    v_lshlrev_b32 v40, 16, v164
    v_and_b32 v41, s38, v164
    v_lshlrev_b32 v42, 16, v165
    v_and_b32 v43, s38, v165
    v_lshlrev_b32 v44, 16, v166
    v_and_b32 v45, s38, v166
    v_lshlrev_b32 v46, 16, v167
    v_and_b32 v47, s38, v167
    v_lshlrev_b32 v48, 16, v168
    v_and_b32 v49, s38, v168
    v_lshlrev_b32 v50, 16, v169
    v_and_b32 v51, s38, v169
    s_cmp_lg_u32 s13, 3
    s_cbranch_scc1 CPL5_ok
    s_lshl_b32 s73, s14, 15
    s_add_u32 s73, s73, 6891520
    s_lshl_b32 s72, s50, 7
    s_add_u32 s72, s72, s73
    s_mov_b64 exec, 1
    s_mov_b32 s73, 0
    buffer_load_dword v253, off, s[4:7], s72 sc1
    s_sleep 2
    buffer_load_dword v254, off, s[4:7], s72 sc1
    s_sleep 2
CPL5:
    buffer_load_dword v255, off, s[4:7], s72 sc1
    s_waitcnt vmcnt(2)
    v_cmp_ne_u32 vcc, 8, v253
    s_nop 1
    s_cmp_eq_u64 vcc, 0
    s_cbranch_scc1 CPL5_x
    s_sleep 1
    buffer_load_dword v253, off, s[4:7], s72 sc1
    s_waitcnt vmcnt(2)
    v_cmp_ne_u32 vcc, 8, v254
    s_nop 1
    s_cmp_eq_u64 vcc, 0
    s_cbranch_scc1 CPL5_x
    s_sleep 1
    buffer_load_dword v254, off, s[4:7], s72 sc1
    s_waitcnt vmcnt(2)
    v_cmp_ne_u32 vcc, 8, v255
    s_nop 1
    s_cmp_eq_u64 vcc, 0
    s_cbranch_scc1 CPL5_x
    s_sleep 1
    s_add_u32 s73, s73, 1
    s_cmp_lt_u32 s73, 0x20000
    s_cbranch_scc1 CPL5
CPL5_x:
    s_mov_b64 exec, -1
CPL5_ok:
    s_barrier
    s_barrier
    ds_read_b128 v[64:67], v4 offset:0
    ds_read_b128 v[68:71], v6 offset:0
    ds_read_b128 v[72:75], v6 offset:1024
    ds_read_b128 v[76:79], v6 offset:2048
    ds_read_b128 v[80:83], v6 offset:3072
    ds_read_b128 v[84:87], v6 offset:4096
    ds_read_b128 v[88:91], v4 offset:4096
    ds_read_b128 v[92:95], v6 offset:5120
    ds_read_b128 v[96:99], v6 offset:6144
    ds_read_b128 v[100:103], v6 offset:7168
    ds_read_b128 v[104:107], v6 offset:8192
    ds_read_b128 v[108:111], v6 offset:9216
    s_barrier
    s_waitcnt lgkmcnt(10)
    v_mfma_f32_16x16x32_bf16 v[32:35], v[68:71], v[64:67], v[32:35]
    ds_read_b128 v[112:115], v4 offset:8192
    s_waitcnt lgkmcnt(10)
    v_mfma_f32_16x16x32_bf16 v[36:39], v[72:75], v[64:67], v[36:39]
    ds_read_b128 v[116:119], v6 offset:10240
    s_waitcnt lgkmcnt(10)
    v_mfma_f32_16x16x32_bf16 v[40:43], v[76:79], v[64:67], v[40:43]
    ds_read_b128 v[120:123], v6 offset:11264
    s_waitcnt lgkmcnt(10)
    v_mfma_f32_16x16x32_bf16 v[44:47], v[80:83], v[64:67], v[44:47]
    ds_read_b128 v[124:127], v6 offset:12288
    ds_read_b128 v[128:131], v6 offset:13312
    s_waitcnt lgkmcnt(11)
    v_mfma_f32_16x16x32_bf16 v[48:51], v[84:87], v[64:67], v[48:51]
    ds_read_b128 v[132:135], v6 offset:14336
    s_waitcnt lgkmcnt(10)
    v_mfma_f32_16x16x32_bf16 v[32:35], v[92:95], v[88:91], v[32:35]
    ds_read_b128 v[136:139], v4 offset:12288
    s_waitcnt lgkmcnt(10)
    v_mfma_f32_16x16x32_bf16 v[36:39], v[96:99], v[88:91], v[36:39]
    ds_read_b128 v[140:143], v6 offset:15360
    s_waitcnt lgkmcnt(10)
    v_mfma_f32_16x16x32_bf16 v[40:43], v[100:103], v[88:91], v[40:43]
    ds_read_b128 v[144:147], v6 offset:16384
    ds_read_b128 v[148:151], v6 offset:17408
    s_waitcnt lgkmcnt(11)
    v_mfma_f32_16x16x32_bf16 v[44:47], v[104:107], v[88:91], v[44:47]
    ds_read_b128 v[152:155], v6 offset:18432
    s_waitcnt lgkmcnt(11)
    v_mfma_f32_16x16x32_bf16 v[48:51], v[108:111], v[88:91], v[48:51]
    ds_read_b128 v[156:159], v6 offset:19456
    s_barrier
    s_waitcnt lgkmcnt(10)
    v_mfma_f32_16x16x32_bf16 v[32:35], v[116:119], v[112:115], v[32:35]
    ds_read_b128 v[64:67], v4 offset:16384
    s_waitcnt lgkmcnt(10)
    v_mfma_f32_16x16x32_bf16 v[36:39], v[120:123], v[112:115], v[36:39]
    ds_read_b128 v[68:71], v6 offset:20480
    s_waitcnt lgkmcnt(10)
    v_mfma_f32_16x16x32_bf16 v[40:43], v[124:127], v[112:115], v[40:43]
    ds_read_b128 v[72:75], v6 offset:21504
    s_waitcnt lgkmcnt(10)
    v_mfma_f32_16x16x32_bf16 v[44:47], v[128:131], v[112:115], v[44:47]
    ds_read_b128 v[76:79], v6 offset:22528
    ds_read_b128 v[80:83], v6 offset:23552
    s_waitcnt lgkmcnt(11)
    v_mfma_f32_16x16x32_bf16 v[48:51], v[132:135], v[112:115], v[48:51]
    ds_read_b128 v[84:87], v6 offset:24576
    s_waitcnt lgkmcnt(10)
    v_mfma_f32_16x16x32_bf16 v[32:35], v[140:143], v[136:139], v[32:35]
    ds_read_b128 v[88:91], v4 offset:20480
    s_waitcnt lgkmcnt(10)
    v_mfma_f32_16x16x32_bf16 v[36:39], v[144:147], v[136:139], v[36:39]
    ds_read_b128 v[92:95], v6 offset:25600
    s_waitcnt lgkmcnt(10)
    v_mfma_f32_16x16x32_bf16 v[40:43], v[148:151], v[136:139], v[40:43]
    ds_read_b128 v[96:99], v6 offset:26624
    ds_read_b128 v[100:103], v6 offset:27648
    s_waitcnt lgkmcnt(11)
    v_mfma_f32_16x16x32_bf16 v[44:47], v[152:155], v[136:139], v[44:47]
    ds_read_b128 v[104:107], v6 offset:28672
    s_waitcnt lgkmcnt(11)
    v_mfma_f32_16x16x32_bf16 v[48:51], v[156:159], v[136:139], v[48:51]
    ds_read_b128 v[108:111], v6 offset:29696
    s_barrier
    s_waitcnt lgkmcnt(10)
    v_mfma_f32_16x16x32_bf16 v[32:35], v[68:71], v[64:67], v[32:35]
    ds_read_b128 v[112:115], v4 offset:24576
    s_waitcnt lgkmcnt(10)
    v_mfma_f32_16x16x32_bf16 v[36:39], v[72:75], v[64:67], v[36:39]
    ds_read_b128 v[116:119], v6 offset:30720
    s_waitcnt lgkmcnt(10)
    v_mfma_f32_16x16x32_bf16 v[40:43], v[76:79], v[64:67], v[40:43]
    ds_read_b128 v[120:123], v6 offset:31744
    s_waitcnt lgkmcnt(10)
    v_mfma_f32_16x16x32_bf16 v[44:47], v[80:83], v[64:67], v[44:47]
    ds_read_b128 v[124:127], v6 offset:32768
    ds_read_b128 v[128:131], v6 offset:33792
    s_waitcnt lgkmcnt(11)
    v_mfma_f32_16x16x32_bf16 v[48:51], v[84:87], v[64:67], v[48:51]
    ds_read_b128 v[132:135], v6 offset:34816
    s_waitcnt lgkmcnt(10)
    v_mfma_f32_16x16x32_bf16 v[32:35], v[92:95], v[88:91], v[32:35]
    ds_read_b128 v[136:139], v4 offset:28672
    s_waitcnt lgkmcnt(10)
    v_mfma_f32_16x16x32_bf16 v[36:39], v[96:99], v[88:91], v[36:39]
    ds_read_b128 v[140:143], v6 offset:35840
    s_waitcnt lgkmcnt(10)
    v_mfma_f32_16x16x32_bf16 v[40:43], v[100:103], v[88:91], v[40:43]
    ds_read_b128 v[144:147], v6 offset:36864
    ds_read_b128 v[148:151], v6 offset:37888
    s_waitcnt lgkmcnt(11)
    v_mfma_f32_16x16x32_bf16 v[44:47], v[104:107], v[88:91], v[44:47]
    ds_read_b128 v[152:155], v6 offset:38912
    s_waitcnt lgkmcnt(11)
    v_mfma_f32_16x16x32_bf16 v[48:51], v[108:111], v[88:91], v[48:51]
    ds_read_b128 v[156:159], v6 offset:39936
    s_barrier
    s_waitcnt lgkmcnt(10)
    v_mfma_f32_16x16x32_bf16 v[32:35], v[116:119], v[112:115], v[32:35]
    ds_read_b128 v[64:67], v4 offset:32768
    s_waitcnt lgkmcnt(10)
    v_mfma_f32_16x16x32_bf16 v[36:39], v[120:123], v[112:115], v[36:39]
    ds_read_b128 v[68:71], v6 offset:40960
    s_waitcnt lgkmcnt(10)
    v_mfma_f32_16x16x32_bf16 v[40:43], v[124:127], v[112:115], v[40:43]
    ds_read_b128 v[72:75], v6 offset:41984
    s_waitcnt lgkmcnt(10)
    v_mfma_f32_16x16x32_bf16 v[44:47], v[128:131], v[112:115], v[44:47]
    ds_read_b128 v[76:79], v6 offset:43008
    ds_read_b128 v[80:83], v6 offset:44032
    s_waitcnt lgkmcnt(11)
    v_mfma_f32_16x16x32_bf16 v[48:51], v[132:135], v[112:115], v[48:51]
    ds_read_b128 v[84:87], v6 offset:45056
    s_waitcnt lgkmcnt(10)
    v_mfma_f32_16x16x32_bf16 v[32:35], v[140:143], v[136:139], v[32:35]
    ds_read_b128 v[88:91], v4 offset:36864
    s_waitcnt lgkmcnt(10)
    v_mfma_f32_16x16x32_bf16 v[36:39], v[144:147], v[136:139], v[36:39]
    ds_read_b128 v[92:95], v6 offset:46080
    s_waitcnt lgkmcnt(10)
    v_mfma_f32_16x16x32_bf16 v[40:43], v[148:151], v[136:139], v[40:43]
    ds_read_b128 v[96:99], v6 offset:47104
    ds_read_b128 v[100:103], v6 offset:48128
    s_waitcnt lgkmcnt(11)
    v_mfma_f32_16x16x32_bf16 v[44:47], v[152:155], v[136:139], v[44:47]
    ds_read_b128 v[104:107], v6 offset:49152
    s_waitcnt lgkmcnt(11)
    v_mfma_f32_16x16x32_bf16 v[48:51], v[156:159], v[136:139], v[48:51]
    ds_read_b128 v[108:111], v6 offset:50176
    s_barrier
    s_waitcnt lgkmcnt(10)
    v_mfma_f32_16x16x32_bf16 v[32:35], v[68:71], v[64:67], v[32:35]
    ds_read_b128 v[112:115], v4 offset:40960
    s_waitcnt lgkmcnt(10)
    v_mfma_f32_16x16x32_bf16 v[36:39], v[72:75], v[64:67], v[36:39]
    ds_read_b128 v[116:119], v6 offset:51200
    s_waitcnt lgkmcnt(10)
    v_mfma_f32_16x16x32_bf16 v[40:43], v[76:79], v[64:67], v[40:43]
    ds_read_b128 v[120:123], v6 offset:52224
    s_waitcnt lgkmcnt(10)
    v_mfma_f32_16x16x32_bf16 v[44:47], v[80:83], v[64:67], v[44:47]
    ds_read_b128 v[124:127], v6 offset:53248
    ds_read_b128 v[128:131], v6 offset:54272
    s_waitcnt lgkmcnt(11)
    v_mfma_f32_16x16x32_bf16 v[48:51], v[84:87], v[64:67], v[48:51]
    ds_read_b128 v[132:135], v6 offset:55296
    s_waitcnt lgkmcnt(10)
    v_mfma_f32_16x16x32_bf16 v[32:35], v[92:95], v[88:91], v[32:35]
    ds_read_b128 v[136:139], v4 offset:45056
    s_waitcnt lgkmcnt(10)
    v_mfma_f32_16x16x32_bf16 v[36:39], v[96:99], v[88:91], v[36:39]
    ds_read_b128 v[140:143], v6 offset:56320
    s_waitcnt lgkmcnt(10)
    v_mfma_f32_16x16x32_bf16 v[40:43], v[100:103], v[88:91], v[40:43]
    ds_read_b128 v[144:147], v6 offset:57344
    ds_read_b128 v[148:151], v6 offset:58368
    s_waitcnt lgkmcnt(11)
    v_mfma_f32_16x16x32_bf16 v[44:47], v[104:107], v[88:91], v[44:47]
    ds_read_b128 v[152:155], v6 offset:59392
    s_waitcnt lgkmcnt(11)
    v_mfma_f32_16x16x32_bf16 v[48:51], v[108:111], v[88:91], v[48:51]
    ds_read_b128 v[156:159], v6 offset:60416
    s_barrier
    s_waitcnt lgkmcnt(10)
    v_mfma_f32_16x16x32_bf16 v[32:35], v[116:119], v[112:115], v[32:35]
    ds_read_b128 v[64:67], v4 offset:49152
    s_waitcnt lgkmcnt(10)
    v_mfma_f32_16x16x32_bf16 v[36:39], v[120:123], v[112:115], v[36:39]
    ds_read_b128 v[68:71], v6 offset:61440
    s_waitcnt lgkmcnt(10)
    v_mfma_f32_16x16x32_bf16 v[40:43], v[124:127], v[112:115], v[40:43]
    ds_read_b128 v[72:75], v6 offset:62464
    s_waitcnt lgkmcnt(10)
    v_mfma_f32_16x16x32_bf16 v[44:47], v[128:131], v[112:115], v[44:47]
    ds_read_b128 v[76:79], v6 offset:63488
    ds_read_b128 v[80:83], v6 offset:64512
    s_waitcnt lgkmcnt(11)
    v_mfma_f32_16x16x32_bf16 v[48:51], v[132:135], v[112:115], v[48:51]
    ds_read_b128 v[84:87], v7 offset:0
    s_waitcnt lgkmcnt(10)
    v_mfma_f32_16x16x32_bf16 v[32:35], v[140:143], v[136:139], v[32:35]
    ds_read_b128 v[88:91], v4 offset:53248
    s_waitcnt lgkmcnt(10)
    v_mfma_f32_16x16x32_bf16 v[36:39], v[144:147], v[136:139], v[36:39]
    ds_read_b128 v[92:95], v7 offset:1024
    s_waitcnt lgkmcnt(10)
    v_mfma_f32_16x16x32_bf16 v[40:43], v[148:151], v[136:139], v[40:43]
    ds_read_b128 v[96:99], v7 offset:2048
    ds_read_b128 v[100:103], v7 offset:3072
    s_waitcnt lgkmcnt(11)
    v_mfma_f32_16x16x32_bf16 v[44:47], v[152:155], v[136:139], v[44:47]
    ds_read_b128 v[104:107], v7 offset:4096
    s_waitcnt lgkmcnt(11)
    v_mfma_f32_16x16x32_bf16 v[48:51], v[156:159], v[136:139], v[48:51]
    ds_read_b128 v[108:111], v7 offset:5120
    s_barrier
    s_waitcnt lgkmcnt(10)
    v_mfma_f32_16x16x32_bf16 v[32:35], v[68:71], v[64:67], v[32:35]
    ds_read_b128 v[112:115], v4 offset:0
    s_waitcnt lgkmcnt(10)
    v_mfma_f32_16x16x32_bf16 v[36:39], v[72:75], v[64:67], v[36:39]
    ds_read_b128 v[116:119], v7 offset:6144
    s_waitcnt lgkmcnt(10)
    v_mfma_f32_16x16x32_bf16 v[40:43], v[76:79], v[64:67], v[40:43]
    ds_read_b128 v[120:123], v7 offset:7168
    s_waitcnt lgkmcnt(10)
    v_mfma_f32_16x16x32_bf16 v[44:47], v[80:83], v[64:67], v[44:47]
    ds_read_b128 v[124:127], v7 offset:8192
    ds_read_b128 v[128:131], v7 offset:9216
    s_waitcnt lgkmcnt(11)
    v_mfma_f32_16x16x32_bf16 v[48:51], v[84:87], v[64:67], v[48:51]
    ds_read_b128 v[132:135], v7 offset:10240
    s_waitcnt lgkmcnt(10)
    v_mfma_f32_16x16x32_bf16 v[32:35], v[92:95], v[88:91], v[32:35]
    ds_read_b128 v[136:139], v4 offset:4096
    s_waitcnt lgkmcnt(10)
    v_mfma_f32_16x16x32_bf16 v[36:39], v[96:99], v[88:91], v[36:39]
    ds_read_b128 v[140:143], v7 offset:11264
    s_waitcnt lgkmcnt(10)
    v_mfma_f32_16x16x32_bf16 v[40:43], v[100:103], v[88:91], v[40:43]
    ds_read_b128 v[144:147], v7 offset:12288
    ds_read_b128 v[148:151], v7 offset:13312
    s_waitcnt lgkmcnt(11)
    v_mfma_f32_16x16x32_bf16 v[44:47], v[104:107], v[88:91], v[44:47]
    ds_read_b128 v[152:155], v7 offset:14336
    s_waitcnt lgkmcnt(11)
    v_mfma_f32_16x16x32_bf16 v[48:51], v[108:111], v[88:91], v[48:51]
    ds_read_b128 v[156:159], v7 offset:15360
    s_barrier
    s_waitcnt lgkmcnt(10)
    v_mfma_f32_16x16x32_bf16 v[32:35], v[116:119], v[112:115], v[32:35]
    ds_read_b128 v[64:67], v4 offset:8192
    s_waitcnt lgkmcnt(10)
    v_mfma_f32_16x16x32_bf16 v[36:39], v[120:123], v[112:115], v[36:39]
    ds_read_b128 v[68:71], v6 offset:0
    s_waitcnt lgkmcnt(10)
    v_mfma_f32_16x16x32_bf16 v[40:43], v[124:127], v[112:115], v[40:43]
    ds_read_b128 v[72:75], v6 offset:1024
    s_waitcnt lgkmcnt(10)
    v_mfma_f32_16x16x32_bf16 v[44:47], v[128:131], v[112:115], v[44:47]
    ds_read_b128 v[76:79], v6 offset:2048
    ds_read_b128 v[80:83], v6 offset:3072
    s_waitcnt lgkmcnt(11)
    v_mfma_f32_16x16x32_bf16 v[48:51], v[132:135], v[112:115], v[48:51]
    ds_read_b128 v[84:87], v6 offset:4096
    s_waitcnt lgkmcnt(10)
    v_mfma_f32_16x16x32_bf16 v[32:35], v[140:143], v[136:139], v[32:35]
    ds_read_b128 v[88:91], v4 offset:12288
    s_waitcnt lgkmcnt(10)
    v_mfma_f32_16x16x32_bf16 v[36:39], v[144:147], v[136:139], v[36:39]
    ds_read_b128 v[92:95], v6 offset:5120
    s_waitcnt lgkmcnt(10)
    v_mfma_f32_16x16x32_bf16 v[40:43], v[148:151], v[136:139], v[40:43]
    ds_read_b128 v[96:99], v6 offset:6144
    ds_read_b128 v[100:103], v6 offset:7168
    s_waitcnt lgkmcnt(11)
    v_mfma_f32_16x16x32_bf16 v[44:47], v[152:155], v[136:139], v[44:47]
    ds_read_b128 v[104:107], v6 offset:8192
    s_waitcnt lgkmcnt(11)
    v_mfma_f32_16x16x32_bf16 v[48:51], v[156:159], v[136:139], v[48:51]
    ds_read_b128 v[108:111], v6 offset:9216
    s_barrier
    s_waitcnt lgkmcnt(10)
    v_mfma_f32_16x16x32_bf16 v[32:35], v[68:71], v[64:67], v[32:35]
    ds_read_b128 v[112:115], v4 offset:16384
    s_waitcnt lgkmcnt(10)
    v_mfma_f32_16x16x32_bf16 v[36:39], v[72:75], v[64:67], v[36:39]
    ds_read_b128 v[116:119], v6 offset:10240
    s_waitcnt lgkmcnt(10)
    v_mfma_f32_16x16x32_bf16 v[40:43], v[76:79], v[64:67], v[40:43]
    ds_read_b128 v[120:123], v6 offset:11264
    s_waitcnt lgkmcnt(10)
    v_mfma_f32_16x16x32_bf16 v[44:47], v[80:83], v[64:67], v[44:47]
    ds_read_b128 v[124:127], v6 offset:12288
    ds_read_b128 v[128:131], v6 offset:13312
    s_waitcnt lgkmcnt(11)
    v_mfma_f32_16x16x32_bf16 v[48:51], v[84:87], v[64:67], v[48:51]
    ds_read_b128 v[132:135], v6 offset:14336
    s_waitcnt lgkmcnt(10)
    v_mfma_f32_16x16x32_bf16 v[32:35], v[92:95], v[88:91], v[32:35]
    ds_read_b128 v[136:139], v4 offset:20480
    s_waitcnt lgkmcnt(10)
    v_mfma_f32_16x16x32_bf16 v[36:39], v[96:99], v[88:91], v[36:39]
    ds_read_b128 v[140:143], v6 offset:15360
    s_waitcnt lgkmcnt(10)
    v_mfma_f32_16x16x32_bf16 v[40:43], v[100:103], v[88:91], v[40:43]
    ds_read_b128 v[144:147], v6 offset:16384
    ds_read_b128 v[148:151], v6 offset:17408
    s_waitcnt lgkmcnt(11)
    v_mfma_f32_16x16x32_bf16 v[44:47], v[104:107], v[88:91], v[44:47]
    ds_read_b128 v[152:155], v6 offset:18432
    s_waitcnt lgkmcnt(11)
    v_mfma_f32_16x16x32_bf16 v[48:51], v[108:111], v[88:91], v[48:51]
    ds_read_b128 v[156:159], v6 offset:19456
    s_barrier
    s_waitcnt lgkmcnt(10)
    v_mfma_f32_16x16x32_bf16 v[32:35], v[116:119], v[112:115], v[32:35]
    ds_read_b128 v[64:67], v4 offset:24576
    s_waitcnt lgkmcnt(10)
    v_mfma_f32_16x16x32_bf16 v[36:39], v[120:123], v[112:115], v[36:39]
    ds_read_b128 v[68:71], v6 offset:20480
    s_waitcnt lgkmcnt(10)
    v_mfma_f32_16x16x32_bf16 v[40:43], v[124:127], v[112:115], v[40:43]
    ds_read_b128 v[72:75], v6 offset:21504
    s_waitcnt lgkmcnt(10)
    v_mfma_f32_16x16x32_bf16 v[44:47], v[128:131], v[112:115], v[44:47]
    ds_read_b128 v[76:79], v6 offset:22528
    ds_read_b128 v[80:83], v6 offset:23552
    s_waitcnt lgkmcnt(11)
    v_mfma_f32_16x16x32_bf16 v[48:51], v[132:135], v[112:115], v[48:51]
    ds_read_b128 v[84:87], v6 offset:24576
    s_waitcnt lgkmcnt(10)
    v_mfma_f32_16x16x32_bf16 v[32:35], v[140:143], v[136:139], v[32:35]
    ds_read_b128 v[88:91], v4 offset:28672
    s_waitcnt lgkmcnt(10)
    v_mfma_f32_16x16x32_bf16 v[36:39], v[144:147], v[136:139], v[36:39]
    ds_read_b128 v[92:95], v6 offset:25600
    s_waitcnt lgkmcnt(10)
    v_mfma_f32_16x16x32_bf16 v[40:43], v[148:151], v[136:139], v[40:43]
    ds_read_b128 v[96:99], v6 offset:26624
    ds_read_b128 v[100:103], v6 offset:27648
    s_waitcnt lgkmcnt(11)
    v_mfma_f32_16x16x32_bf16 v[44:47], v[152:155], v[136:139], v[44:47]
    ds_read_b128 v[104:107], v6 offset:28672
    s_waitcnt lgkmcnt(11)
    v_mfma_f32_16x16x32_bf16 v[48:51], v[156:159], v[136:139], v[48:51]
    ds_read_b128 v[108:111], v6 offset:29696
    s_barrier
    s_waitcnt lgkmcnt(10)
    v_mfma_f32_16x16x32_bf16 v[32:35], v[68:71], v[64:67], v[32:35]
    ds_read_b128 v[112:115], v4 offset:32768
    s_waitcnt lgkmcnt(10)
    v_mfma_f32_16x16x32_bf16 v[36:39], v[72:75], v[64:67], v[36:39]
    ds_read_b128 v[116:119], v6 offset:30720
    s_waitcnt lgkmcnt(10)
    v_mfma_f32_16x16x32_bf16 v[40:43], v[76:79], v[64:67], v[40:43]
    ds_read_b128 v[120:123], v6 offset:31744
    s_waitcnt lgkmcnt(10)
    v_mfma_f32_16x16x32_bf16 v[44:47], v[80:83], v[64:67], v[44:47]
    ds_read_b128 v[124:127], v6 offset:32768
    ds_read_b128 v[128:131], v6 offset:33792
    s_waitcnt lgkmcnt(11)
    v_mfma_f32_16x16x32_bf16 v[48:51], v[84:87], v[64:67], v[48:51]
    ds_read_b128 v[132:135], v6 offset:34816
    s_waitcnt lgkmcnt(10)
    v_mfma_f32_16x16x32_bf16 v[32:35], v[92:95], v[88:91], v[32:35]
    ds_read_b128 v[136:139], v4 offset:36864
    s_waitcnt lgkmcnt(10)
    v_mfma_f32_16x16x32_bf16 v[36:39], v[96:99], v[88:91], v[36:39]
    ds_read_b128 v[140:143], v6 offset:35840
    s_waitcnt lgkmcnt(10)
    v_mfma_f32_16x16x32_bf16 v[40:43], v[100:103], v[88:91], v[40:43]
    ds_read_b128 v[144:147], v6 offset:36864
    ds_read_b128 v[148:151], v6 offset:37888
    s_waitcnt lgkmcnt(11)
    v_mfma_f32_16x16x32_bf16 v[44:47], v[104:107], v[88:91], v[44:47]
    ds_read_b128 v[152:155], v6 offset:38912
    s_waitcnt lgkmcnt(11)
    v_mfma_f32_16x16x32_bf16 v[48:51], v[108:111], v[88:91], v[48:51]
    ds_read_b128 v[156:159], v6 offset:39936
    s_barrier
    s_waitcnt lgkmcnt(10)
    v_mfma_f32_16x16x32_bf16 v[32:35], v[116:119], v[112:115], v[32:35]
    ds_read2st64_b64 v[64:67], v5 offset0:80 offset1:81
    s_waitcnt lgkmcnt(10)
    v_mfma_f32_16x16x32_bf16 v[36:39], v[120:123], v[112:115], v[36:39]
    ds_read_b128 v[68:71], v6 offset:40960
    s_waitcnt lgkmcnt(10)
    v_mfma_f32_16x16x32_bf16 v[40:43], v[124:127], v[112:115], v[40:43]
    ds_read_b128 v[72:75], v6 offset:41984
    s_waitcnt lgkmcnt(10)
    v_mfma_f32_16x16x32_bf16 v[44:47], v[128:131], v[112:115], v[44:47]
    ds_read_b128 v[76:79], v6 offset:43008
    ds_read_b128 v[80:83], v6 offset:44032
    s_waitcnt lgkmcnt(11)
    v_mfma_f32_16x16x32_bf16 v[48:51], v[132:135], v[112:115], v[48:51]
    ds_read_b128 v[84:87], v6 offset:45056
    s_waitcnt lgkmcnt(10)
    v_mfma_f32_16x16x32_bf16 v[32:35], v[140:143], v[136:139], v[32:35]
    ds_read2st64_b64 v[88:91], v5 offset0:88 offset1:89
    s_waitcnt lgkmcnt(10)
    v_mfma_f32_16x16x32_bf16 v[36:39], v[144:147], v[136:139], v[36:39]
    ds_read_b128 v[92:95], v6 offset:46080
    s_waitcnt lgkmcnt(10)
    v_mfma_f32_16x16x32_bf16 v[40:43], v[148:151], v[136:139], v[40:43]
    ds_read_b128 v[96:99], v6 offset:47104
    ds_read_b128 v[100:103], v6 offset:48128
    s_waitcnt lgkmcnt(11)
    v_mfma_f32_16x16x32_bf16 v[44:47], v[152:155], v[136:139], v[44:47]
    ds_read_b128 v[104:107], v6 offset:49152
    s_waitcnt lgkmcnt(11)
    v_mfma_f32_16x16x32_bf16 v[48:51], v[156:159], v[136:139], v[48:51]
    ds_read_b128 v[108:111], v6 offset:50176
    s_barrier
    s_waitcnt lgkmcnt(10)
    v_mfma_f32_16x16x32_bf16 v[32:35], v[68:71], v[64:67], v[32:35]
    ds_read2st64_b64 v[112:115], v5 offset0:96 offset1:97
    s_waitcnt lgkmcnt(10)
    v_mfma_f32_16x16x32_bf16 v[36:39], v[72:75], v[64:67], v[36:39]
    ds_read_b128 v[116:119], v6 offset:51200
    s_waitcnt lgkmcnt(10)
    v_mfma_f32_16x16x32_bf16 v[40:43], v[76:79], v[64:67], v[40:43]
    ds_read_b128 v[120:123], v6 offset:52224
    s_waitcnt lgkmcnt(10)
    v_mfma_f32_16x16x32_bf16 v[44:47], v[80:83], v[64:67], v[44:47]
    ds_read_b128 v[124:127], v6 offset:53248
    ds_read_b128 v[128:131], v6 offset:54272
    s_waitcnt lgkmcnt(11)
    v_mfma_f32_16x16x32_bf16 v[48:51], v[84:87], v[64:67], v[48:51]
    ds_read_b128 v[132:135], v6 offset:55296
    s_waitcnt lgkmcnt(10)
    v_mfma_f32_16x16x32_bf16 v[32:35], v[92:95], v[88:91], v[32:35]
    s_waitcnt lgkmcnt(9)
    v_mfma_f32_16x16x32_bf16 v[36:39], v[96:99], v[88:91], v[36:39]
    s_waitcnt lgkmcnt(8)
    v_mfma_f32_16x16x32_bf16 v[40:43], v[100:103], v[88:91], v[40:43]
    s_waitcnt lgkmcnt(7)
    v_mfma_f32_16x16x32_bf16 v[44:47], v[104:107], v[88:91], v[44:47]
    s_waitcnt lgkmcnt(6)
    v_mfma_f32_16x16x32_bf16 v[48:51], v[108:111], v[88:91], v[48:51]
    s_waitcnt lgkmcnt(4)
    v_mfma_f32_16x16x32_bf16 v[32:35], v[116:119], v[112:115], v[32:35]
    s_waitcnt lgkmcnt(3)
    v_mfma_f32_16x16x32_bf16 v[36:39], v[120:123], v[112:115], v[36:39]
    s_waitcnt lgkmcnt(2)
    v_mfma_f32_16x16x32_bf16 v[40:43], v[124:127], v[112:115], v[40:43]
    s_waitcnt lgkmcnt(1)
    v_mfma_f32_16x16x32_bf16 v[44:47], v[128:131], v[112:115], v[44:47]
    s_waitcnt lgkmcnt(0)
    v_mfma_f32_16x16x32_bf16 v[48:51], v[132:135], v[112:115], v[48:51]
    s_barrier
    v_cvt_pk_bf16_f32 v160, v32, v33
    v_cvt_pk_bf16_f32 v161, v34, v35
    v_cvt_pk_bf16_f32 v162, v36, v37
    v_cvt_pk_bf16_f32 v163, v38, v39
    v_cvt_pk_bf16_f32 v164, v40, v41
    v_cvt_pk_bf16_f32 v165, v42, v43
    v_cvt_pk_bf16_f32 v166, v44, v45
    v_cvt_pk_bf16_f32 v167, v46, v47
    v_cvt_pk_bf16_f32 v168, v48, v49
    v_cvt_pk_bf16_f32 v169, v50, v51
    s_cmp_eq_u32 s14, 1
    s_cbranch_scc1 P5_final
    buffer_store_dwordx4 v[160:163], v3, s[4:7], s36 offen sc1
    buffer_store_dwordx4 v[164:167], v3, s[4:7], s37 offen sc1
    buffer_store_dwordx2 v[168:169], v8, s[4:7], s35 offen sc1
    v_dot2_f32_bf16 v172, v160, v174, v172
    v_dot2_f32_bf16 v173, v160, v160, v173
    v_dot2_f32_bf16 v178, v161, v174, v178
    v_dot2_f32_bf16 v179, v161, v161, v179
    v_dot2_f32_bf16 v172, v162, v174, v172
    v_dot2_f32_bf16 v173, v162, v162, v173
    v_dot2_f32_bf16 v178, v163, v174, v178
    v_dot2_f32_bf16 v179, v163, v163, v179
    v_dot2_f32_bf16 v172, v164, v174, v172
    v_dot2_f32_bf16 v173, v164, v164, v173
    v_dot2_f32_bf16 v178, v165, v174, v178
    v_dot2_f32_bf16 v179, v165, v165, v179
    v_dot2_f32_bf16 v172, v166, v174, v172
    v_dot2_f32_bf16 v173, v166, v166, v173
    v_dot2_f32_bf16 v178, v167, v174, v178
    v_dot2_f32_bf16 v179, v167, v167, v179
    v_dot2_f32_bf16 v172, v168, v174, v172
    v_dot2_f32_bf16 v173, v168, v168, v173
    v_dot2_f32_bf16 v178, v169, v174, v178
    v_dot2_f32_bf16 v179, v169, v169, v179
    s_nop 2
    v_pk_add_f32 v[172:173], v[172:173], v[178:179]
    v_mov_b32 v178, v172
    v_mov_b32 v179, v173
    s_nop 0
    v_permlane32_swap_b32 v178, v172
    v_permlane32_swap_b32 v179, v173
    v_pk_add_f32 v[172:173], v[172:173], v[178:179]
    v_mov_b32 v178, v172
    v_mov_b32 v179, v173
    s_nop 0
    v_permlane16_swap_b32 v178, v172
    v_permlane16_swap_b32 v179, v173
    v_pk_add_f32 v[172:173], v[172:173], v[178:179]
    s_mov_b64 exec, 0xffff
    buffer_store_dwordx2 v[172:173], v177, s[4:7], s39 offen sc1
    s_mov_b64 exec, -1
    s_mov_b32 s14, 1
    s_add_u32 s12, s12, 19677184
    s_branch C_loop
P5_final:
    s_nop 1
    ds_write_b64 v200, v[160:161] offset:0
    ds_write_b64 v200, v[162:163] offset:32
    ds_write_b64 v200, v[164:165] offset:64
    ds_write_b64 v200, v[166:167] offset:96
    ds_write_b64 v200, v[168:169] offset:128
    s_waitcnt lgkmcnt(0)
    ds_read_b128 v[188:191], v180
    ds_read_b128 v[192:195], v181
    ds_read_b128 v[196:199], v182
    s_waitcnt lgkmcnt(2)
    buffer_store_dwordx4 v[188:191], v184, s[8:11], s42 offen sc1
    s_waitcnt lgkmcnt(1)
    buffer_store_dwordx4 v[192:195], v185, s[8:11], s42 offen sc1
    s_waitcnt lgkmcnt(0)
    s_mov_b64 exec, 0xffffffff
    buffer_store_dwordx4 v[196:199], v186, s[8:11], s42 offen sc1
    s_mov_b64 exec, -1
    s_branch FIN
LDA:
    s_and_b32 s19, s13, 1
    s_mul_i32 s41, s19, 4096
    s_mul_i32 s42, s19, 5120
    s_mul_i32 s43, s19, 7168
    s_mul_i32 s44, s19, 8192
    s_mul_i32 s45, s19, 9216
    s_cmp_eq_u32 s48, 0
    s_cselect_b32 s56, 0, 1024
    v_and_b32 v9, 0xffffff7f, v3
    s_and_b32 s66, s51, 3
    s_cmp_eq_u32 s66, 3
    s_cselect_b32 s66, 1024, 0
    s_mul_i32 s35, s49, 163840
    s_add_u32 s35, s35, 0
    s_mul_i32 s46, s19, 8192
    s_add_u32 s35, s35, s46
    s_add_u32 m0, s44, 131072
    s_add_u32 s54, s35, 0
    buffer_load_dwordx4 v3, s[4:7], s54 offen offset:0 lds
    buffer_load_dwordx4 v3, s[4:7], s54 offen offset:1024 lds
    buffer_load_dwordx4 v3, s[4:7], s54 offen offset:2048 lds
    buffer_load_dwordx4 v3, s[4:7], s54 offen offset:3072 lds
    s_add_u32 m0, s44, 147456
    s_add_u32 s54, s35, 16384
    buffer_load_dwordx4 v3, s[4:7], s54 offen offset:0 lds
    buffer_load_dwordx4 v3, s[4:7], s54 offen offset:1024 lds
    buffer_load_dwordx4 v3, s[4:7], s54 offen offset:2048 lds
    buffer_load_dwordx4 v3, s[4:7], s54 offen offset:3072 lds
    s_add_u32 m0, s44, 98304
    s_add_u32 s54, s35, 32768
    buffer_load_dwordx4 v3, s[4:7], s54 offen offset:0 lds
    buffer_load_dwordx4 v3, s[4:7], s54 offen offset:1024 lds
    buffer_load_dwordx4 v3, s[4:7], s54 offen offset:2048 lds
    buffer_load_dwordx4 v3, s[4:7], s54 offen offset:3072 lds
    s_add_u32 m0, s44, 114688
    s_add_u32 s54, s35, 49152
    buffer_load_dwordx4 v3, s[4:7], s54 offen offset:0 lds
    buffer_load_dwordx4 v3, s[4:7], s54 offen offset:1024 lds
    buffer_load_dwordx4 v3, s[4:7], s54 offen offset:2048 lds
    buffer_load_dwordx4 v3, s[4:7], s54 offen offset:3072 lds
    s_lshl_b32 s30, s48, 13
    s_add_u32 s30, s30, 0
    s_mul_i32 s46, s19, 131072
    s_add_u32 s30, s30, s46
    s_add_u32 s30, s30, s12
    s_lshl_b32 s31, s50, 12
    s_add_u32 s31, s31, 2752512
    s_mul_i32 s46, s19, 131072
    s_add_u32 s31, s31, s46
    s_add_u32 s31, s31, s12
    s_lshl_b32 s32, s50, 12
    s_add_u32 s32, s32, 5373952
    s_mul_i32 s46, s19, 131072
    s_add_u32 s32, s32, s46
    s_add_u32 s32, s32, s12
    s_mul_i32 s33, s51, 7168
    s_add_u32 s33, s33, 12320768
    s_mul_i32 s46, s19, 57344
    s_add_u32 s33, s33, s46
    s_add_u32 s33, s33, s12
    s_lshl_b32 s34, s50, 12
    s_add_u32 s34, s34, 16007168
    s_mul_i32 s46, s19, 131072
    s_add_u32 s34, s34, s46
    s_add_u32 s34, s34, s12
    s_mul_i32 s36, s51, 102400
    s_add_u32 s36, s36, 2621440
    s_mul_i32 s46, s19, 5120
    s_add_u32 s36, s36, s46
    s_mul_i32 s37, s51, 143360
    s_add_u32 s37, s37, 4587520
    s_mul_i32 s46, s19, 7168
    s_add_u32 s37, s37, s46
    s_mul_i32 s38, s51, 143360
    s_add_u32 s38, s38, 3440640
    s_mul_i32 s46, s19, 7168
    s_add_u32 s38, s38, s46
    s_lshl_b32 s39, s50, 18
    s_add_u32 s39, s39, 6950912
    s_mul_i32 s46, s19, 4096
    s_add_u32 s39, s39, s46
    s_mul_i32 s40, s51, 138240
    s_add_u32 s40, s40, 5734400
    s_mul_i32 s46, s19, 5120
    s_add_u32 s40, s40, s46
    v_and_b32 v20, 31, v0
    v_lshlrev_b32 v20, 7, v20
    v_add_u32 v20, 6144, v20
    v_mov_b32 v13, 1
    v_min_u32 v21, 2, v0
    s_lshl_b32 s46, s48, 1
    v_add_u32 v21, s46, v21
    v_max_u32 v21, 1, v21
    v_lshlrev_b32 v21, 7, v21
    v_add_u32 v21, 6895488, v21
    v_bfe_u32 v18, v0, 1, 2
    v_lshlrev_b32 v17, 4, v18
    v_bfe_u32 v18, v0, 3, 1
    v_lshl_add_u32 v17, v18, 3, v17
    v_and_b32 v18, 1, v0
    v_lshl_add_u32 v17, v18, 2, v17
    s_sub_u32 s46, s13, 4
    s_lshl_b32 s47, s46, 10
    s_add_u32 s47, s47, 31330304
    s_lshl_b32 s54, s46, 2
    v_add_u32 v18, s54, v1
    v_lshl_add_u32 v16, v18, 6, v17
    v_lshl_add_u32 v17, v18, 7, v17
    s_mov_b32 s8, s20
    s_and_b32 s9, s21, 0xffff
    s_mov_b32 s10, 8388608
    s_mov_b32 s11, 0x00020000
    v_lshrrev_b32 v10, 3, v0
    v_and_b32 v7, 7, v0
    v_lshlrev_b32 v7, 4, v7
    v_lshl_add_u32 v4, v10, 12, v7
    v_lshlrev_b32 v5, 4, v10
    v_and_b32 v11, 1, v0
    v_lshl_add_u32 v5, v11, 9, v5
    v_and_b32 v11, 4, v0
    v_lshl_add_u32 v5, v11, 10, v5
    v_and_b32 v11, 2, v0
    v_lshl_add_u32 v5, v11, 2, v5
    s_lshl_b32 s57, s50, 18
    s_lshl_b32 s54, s46, 13
    s_add_u32 s59, s57, s54
    s_lshr_b32 s54, s51, 1
    s_lshl_b32 s54, s54, 10
    s_add_u32 s59, s59, s54
    s_and_b32 s54, s51, 1
    s_lshl_b32 s54, s54, 7
    s_add_u32 s59, s59, s54
    s_add_u32 s59, s59, 6950912
    s_lshl_b32 s54, s46, 7
    s_add_u32 s57, s57, s54
    s_lshl_b32 s54, s51, 15
    s_add_u32 s57, s57, s54
    s_mov_b32 s67, 0x4280
    s_mov_b32 s68, 0x42800000
    v_lshlrev_b32 v6, 15, v1
    v_lshl_add_u32 v6, v2, 3, v6
    s_lshl_b32 s54, s46, 6
    v_lshlrev_b32 v18, 2, v2
    v_add_u32 v18, s54, v18
    v_and_b32 v7, 1, v1
    v_lshl_add_u32 v7, v7, 8, v18
    v_lshlrev_b32 v10, 2, v2
    v_add_u32 v10, 512, v10
    v_cmp_eq_u32 vcc, 2, v1
    s_nop 1
    v_cndmask_b32 v7, v7, v10, vcc
    s_lshl_b32 s71, s48, 10
    s_lshl_b32 s54, s46, 7
    s_add_u32 s69, s71, s54
    s_add_u32 s70, s69, 2621824
    s_max_u32 s69, s69, 128
    s_add_u32 s69, s69, 2621312
    s_add_u32 s71, s71, 2622336
    s_lshl_b32 s58, s50, 9
    s_add_u32 s58, s58, s54
    s_add_u32 s58, s58, 7995392
LDA_loop:
    s_add_u32 m0, s45, 38912
    s_add_u32 s54, s30, 0
    s_sub_u32 s54, s54, s56
    buffer_load_dwordx4 v3, s[4:7], s54 offen sc1 lds
    s_add_u32 m0, s45, 39936
    s_add_u32 s54, s30, 0
    buffer_load_dwordx4 v3, s[4:7], s54 offen offset:0 sc1 lds
    buffer_load_dwordx4 v3, s[4:7], s54 offen offset:1024 sc1 lds
    buffer_load_dwordx4 v3, s[4:7], s54 offen offset:2048 sc1 lds
    buffer_load_dwordx4 v3, s[4:7], s54 offen offset:3072 sc1 lds
    s_add_u32 m0, s45, 57344
    s_add_u32 s54, s30, 262144
    s_sub_u32 s54, s54, s56
    buffer_load_dwordx4 v3, s[4:7], s54 offen sc1 lds
    s_add_u32 m0, s45, 58368
    s_add_u32 s54, s30, 262144
    buffer_load_dwordx4 v3, s[4:7], s54 offen offset:0 sc1 lds
    buffer_load_dwordx4 v3, s[4:7], s54 offen offset:1024 sc1 lds
    buffer_load_dwordx4 v3, s[4:7], s54 offen offset:2048 sc1 lds
    buffer_load_dwordx4 v3, s[4:7], s54 offen offset:3072 sc1 lds
    s_add_u32 m0, s45, 75776
    s_add_u32 s54, s30, 524288
    s_sub_u32 s54, s54, s56
    buffer_load_dwordx4 v3, s[4:7], s54 offen sc1 lds
    s_add_u32 m0, s45, 76800
    s_add_u32 s54, s30, 524288
    buffer_load_dwordx4 v3, s[4:7], s54 offen offset:0 sc1 lds
    buffer_load_dwordx4 v3, s[4:7], s54 offen offset:1024 sc1 lds
    buffer_load_dwordx4 v3, s[4:7], s54 offen offset:2048 sc1 lds
    buffer_load_dwordx4 v3, s[4:7], s54 offen offset:3072 sc1 lds
    s_add_u32 m0, s45, 20480
    s_add_u32 s54, s30, 786432
    s_sub_u32 s54, s54, s56
    buffer_load_dwordx4 v3, s[4:7], s54 offen sc1 lds
    s_add_u32 m0, s45, 21504
    s_add_u32 s54, s30, 786432
    buffer_load_dwordx4 v3, s[4:7], s54 offen offset:0 sc1 lds
    buffer_load_dwordx4 v3, s[4:7], s54 offen offset:1024 sc1 lds
    buffer_load_dwordx4 v3, s[4:7], s54 offen offset:2048 sc1 lds
    buffer_load_dwordx4 v3, s[4:7], s54 offen offset:3072 sc1 lds
    s_waitcnt vmcnt(15)
    s_barrier
    s_cmp_eq_u32 s14, 1
    s_cbranch_scc1 WLA0
    buffer_load_dwordx4 v[64:67], v4, s[8:11], s57 offen offset:0
    buffer_load_dwordx4 v[68:71], v4, s[8:11], s57 offen offset:512
    buffer_load_dwordx4 v[72:75], v4, s[8:11], s57 offen offset:1024
    buffer_load_dwordx4 v[76:79], v4, s[8:11], s57 offen offset:1536
    buffer_load_dwordx4 v[80:83], v4, s[8:11], s57 offen offset:2048
    buffer_load_dwordx4 v[84:87], v4, s[8:11], s57 offen offset:2560
    buffer_load_dwordx4 v[88:91], v4, s[8:11], s57 offen offset:3072
    buffer_load_dwordx4 v[92:95], v4, s[8:11], s57 offen offset:3584
WLA0:
    s_cmp_eq_u32 s14, 0
    s_cbranch_scc1 WW_7
    s_waitcnt vmcnt(10)
WW_7:
    s_waitcnt vmcnt(18)
    s_barrier
    s_add_u32 m0, s45, 38912
    s_add_u32 s54, s30, 1048576
    s_sub_u32 s54, s54, s56
    buffer_load_dwordx4 v3, s[4:7], s54 offen sc1 lds
    s_add_u32 m0, s45, 39936
    s_add_u32 s54, s30, 1048576
    buffer_load_dwordx4 v3, s[4:7], s54 offen offset:0 sc1 lds
    buffer_load_dwordx4 v3, s[4:7], s54 offen offset:1024 sc1 lds
    buffer_load_dwordx4 v3, s[4:7], s54 offen offset:2048 sc1 lds
    buffer_load_dwordx4 v3, s[4:7], s54 offen offset:3072 sc1 lds
    s_add_u32 m0, s44, 131072
    s_add_u32 s54, s35, 65536
    buffer_load_dwordx4 v3, s[4:7], s54 offen offset:0 lds
    buffer_load_dwordx4 v3, s[4:7], s54 offen offset:1024 lds
    buffer_load_dwordx4 v3, s[4:7], s54 offen offset:2048 lds
    buffer_load_dwordx4 v3, s[4:7], s54 offen offset:3072 lds
    s_cmp_eq_u32 s14, 0
    s_cbranch_scc1 WW_8
    s_waitcnt vmcnt(14)
WW_8:
    s_waitcnt vmcnt(22)
    s_barrier
    s_add_u32 m0, s45, 57344
    s_add_u32 s54, s30, 1310720
    s_sub_u32 s54, s54, s56
    buffer_load_dwordx4 v3, s[4:7], s54 offen sc1 lds
    s_add_u32 m0, s45, 58368
    s_add_u32 s54, s30, 1310720
    buffer_load_dwordx4 v3, s[4:7], s54 offen offset:0 sc1 lds
    buffer_load_dwordx4 v3, s[4:7], s54 offen offset:1024 sc1 lds
    buffer_load_dwordx4 v3, s[4:7], s54 offen offset:2048 sc1 lds
    buffer_load_dwordx4 v3, s[4:7], s54 offen offset:3072 sc1 lds
    s_add_u32 m0, s44, 147456
    s_add_u32 s54, s35, 81920
    buffer_load_dwordx4 v3, s[4:7], s54 offen offset:0 lds
    buffer_load_dwordx4 v3, s[4:7], s54 offen offset:1024 lds
    buffer_load_dwordx4 v3, s[4:7], s54 offen offset:2048 lds
    buffer_load_dwordx4 v3, s[4:7], s54 offen offset:3072 lds
    s_cmp_eq_u32 s14, 0
    s_cbranch_scc1 WW_9
    s_waitcnt vmcnt(18)
WW_9:
    s_waitcnt vmcnt(26)
    s_barrier
    s_add_u32 m0, s45, 75776
    s_add_u32 s54, s30, 1572864
    s_sub_u32 s54, s54, s56
    buffer_load_dwordx4 v3, s[4:7], s54 offen sc1 lds
    s_add_u32 m0, s45, 76800
    s_add_u32 s54, s30, 1572864
    buffer_load_dwordx4 v3, s[4:7], s54 offen offset:0 sc1 lds
    buffer_load_dwordx4 v3, s[4:7], s54 offen offset:1024 sc1 lds
    buffer_load_dwordx4 v3, s[4:7], s54 offen offset:2048 sc1 lds
    buffer_load_dwordx4 v3, s[4:7], s54 offen offset:3072 sc1 lds
    s_add_u32 m0, s44, 98304
    s_add_u32 s54, s35, 98304
    buffer_load_dwordx4 v3, s[4:7], s54 offen offset:0 lds
    buffer_load_dwordx4 v3, s[4:7], s54 offen offset:1024 lds
    buffer_load_dwordx4 v3, s[4:7], s54 offen offset:2048 lds
    buffer_load_dwordx4 v3, s[4:7], s54 offen offset:3072 lds
    s_waitcnt vmcnt(18)
    s_barrier
    s_add_u32 m0, s45, 20480
    s_add_u32 s54, s30, 1835008
    s_sub_u32 s54, s54, s56
    buffer_load_dwordx4 v3, s[4:7], s54 offen sc1 lds
    s_add_u32 m0, s45, 21504
    s_add_u32 s54, s30, 1835008
    buffer_load_dwordx4 v3, s[4:7], s54 offen offset:0 sc1 lds
    buffer_load_dwordx4 v3, s[4:7], s54 offen offset:1024 sc1 lds
    buffer_load_dwordx4 v3, s[4:7], s54 offen offset:2048 sc1 lds
    buffer_load_dwordx4 v3, s[4:7], s54 offen offset:3072 sc1 lds
    s_add_u32 m0, s44, 114688
    s_add_u32 s54, s35, 114688
    buffer_load_dwordx4 v3, s[4:7], s54 offen offset:0 lds
    buffer_load_dwordx4 v3, s[4:7], s54 offen offset:1024 lds
    buffer_load_dwordx4 v3, s[4:7], s54 offen offset:2048 lds
    buffer_load_dwordx4 v3, s[4:7], s54 offen offset:3072 lds
    s_waitcnt vmcnt(18)
    s_barrier
    s_add_u32 m0, s45, 38912
    s_add_u32 s54, s30, 2097152
    s_sub_u32 s54, s54, s56
    buffer_load_dwordx4 v3, s[4:7], s54 offen sc1 lds
    s_add_u32 m0, s45, 39936
    s_add_u32 s54, s30, 2097152
    buffer_load_dwordx4 v3, s[4:7], s54 offen offset:0 sc1 lds
    buffer_load_dwordx4 v3, s[4:7], s54 offen offset:1024 sc1 lds
    buffer_load_dwordx4 v3, s[4:7], s54 offen offset:2048 sc1 lds
    buffer_load_dwordx4 v3, s[4:7], s54 offen offset:3072 sc1 lds
    s_add_u32 m0, s44, 131072
    s_add_u32 s54, s35, 131072
    buffer_load_dwordx4 v3, s[4:7], s54 offen offset:0 lds
    buffer_load_dwordx4 v3, s[4:7], s54 offen offset:1024 lds
    buffer_load_dwordx4 v3, s[4:7], s54 offen offset:2048 lds
    buffer_load_dwordx4 v3, s[4:7], s54 offen offset:3072 lds
    s_add_u32 s54, s12, s69
    s_add_u32 s55, s54, 16384
    buffer_load_dwordx2 v[40:41], v6, s[4:7], s54 offen sc1
    buffer_load_dwordx2 v[42:43], v6, s[4:7], s55 offen sc1
    s_add_u32 s54, s12, s70
    s_add_u32 s55, s54, 16384
    buffer_load_dwordx2 v[44:45], v6, s[4:7], s54 offen sc1
    buffer_load_dwordx2 v[46:47], v6, s[4:7], s55 offen sc1
    s_add_u32 s54, s12, s71
    s_add_u32 s55, s54, 16384
    buffer_load_dwordx2 v[48:49], v6, s[4:7], s54 offen sc1
    buffer_load_dwordx2 v[50:51], v6, s[4:7], s55 offen sc1
    s_waitcnt vmcnt(24)
    s_barrier
    s_add_u32 m0, s45, 57344
    s_add_u32 s54, s30, 2359296
    s_sub_u32 s54, s54, s56
    buffer_load_dwordx4 v3, s[4:7], s54 offen sc1 lds
    s_add_u32 m0, s45, 58368
    s_add_u32 s54, s30, 2359296
    buffer_load_dwordx4 v3, s[4:7], s54 offen offset:0 sc1 lds
    buffer_load_dwordx4 v3, s[4:7], s54 offen offset:1024 sc1 lds
    buffer_load_dwordx4 v3, s[4:7], s54 offen offset:2048 sc1 lds
    buffer_load_dwordx4 v3, s[4:7], s54 offen offset:3072 sc1 lds
    s_add_u32 m0, s44, 147456
    s_add_u32 s54, s35, 147456
    buffer_load_dwordx4 v3, s[4:7], s54 offen offset:0 lds
    buffer_load_dwordx4 v3, s[4:7], s54 offen offset:1024 lds
    buffer_load_dwordx4 v3, s[4:7], s54 offen offset:2048 lds
    buffer_load_dwordx4 v3, s[4:7], s54 offen offset:3072 lds
    s_cmp_eq_u32 s14, 1
    s_cbranch_scc1 WCA0
    s_waitcnt vmcnt(62)
    v_dot2_f32_bf16 v96, v64, s67, 0
    v_dot2_f32_bf16 v97, v64, s68, 0
    v_dot2_f32_bf16 v98, v65, s67, 0
    v_dot2_f32_bf16 v99, v65, s68, 0
    v_dot2_f32_bf16 v100, v66, s67, 0
    v_dot2_f32_bf16 v101, v66, s68, 0
    v_dot2_f32_bf16 v102, v67, s67, 0
    v_dot2_f32_bf16 v103, v67, s68, 0
    v_cvt_pk_f16_f32 v64, v96, v97
    v_cvt_pk_f16_f32 v65, v98, v99
    v_cvt_pk_f16_f32 v66, v100, v101
    v_cvt_pk_f16_f32 v67, v102, v103
    s_add_u32 s54, s59, 0
    buffer_store_dwordx2 v[64:65], v5, s[4:7], s54 offen offset:0 sc1
    buffer_store_dwordx2 v[66:67], v5, s[4:7], s54 offen offset:256 sc1
    s_waitcnt vmcnt(62)
    v_dot2_f32_bf16 v104, v68, s67, 0
    v_dot2_f32_bf16 v105, v68, s68, 0
    v_dot2_f32_bf16 v106, v69, s67, 0
    v_dot2_f32_bf16 v107, v69, s68, 0
    v_dot2_f32_bf16 v108, v70, s67, 0
    v_dot2_f32_bf16 v109, v70, s68, 0
    v_dot2_f32_bf16 v110, v71, s67, 0
    v_dot2_f32_bf16 v111, v71, s68, 0
    v_cvt_pk_f16_f32 v68, v104, v105
    v_cvt_pk_f16_f32 v69, v106, v107
    v_cvt_pk_f16_f32 v70, v108, v109
    v_cvt_pk_f16_f32 v71, v110, v111
    s_add_u32 s54, s59, 32768
    buffer_store_dwordx2 v[68:69], v5, s[4:7], s54 offen offset:0 sc1
    buffer_store_dwordx2 v[70:71], v5, s[4:7], s54 offen offset:256 sc1
WCA0:
    s_waitcnt vmcnt(24)
    s_barrier
    s_add_u32 m0, s42, 81920
    s_add_u32 s54, s36, 0
    buffer_load_dwordx4 v3, s[4:7], s54 offen offset:0 lds
    buffer_load_dwordx4 v3, s[4:7], s54 offen offset:1024 lds
    s_add_u32 m0, s42, 92160
    s_add_u32 s54, s36, 10240
    buffer_load_dwordx4 v3, s[4:7], s54 offen offset:0 lds
    buffer_load_dwordx4 v3, s[4:7], s54 offen offset:1024 lds
    s_cmp_eq_u32 s14, 1
    s_cbranch_scc1 WCA2
    s_waitcnt vmcnt(62)
    v_dot2_f32_bf16 v96, v72, s67, 0
    v_dot2_f32_bf16 v97, v72, s68, 0
    v_dot2_f32_bf16 v98, v73, s67, 0
    v_dot2_f32_bf16 v99, v73, s68, 0
    v_dot2_f32_bf16 v100, v74, s67, 0
    v_dot2_f32_bf16 v101, v74, s68, 0
    v_dot2_f32_bf16 v102, v75, s67, 0
    v_dot2_f32_bf16 v103, v75, s68, 0
    v_cvt_pk_f16_f32 v72, v96, v97
    v_cvt_pk_f16_f32 v73, v98, v99
    v_cvt_pk_f16_f32 v74, v100, v101
    v_cvt_pk_f16_f32 v75, v102, v103
    s_add_u32 s54, s59, 65536
    buffer_store_dwordx2 v[72:73], v5, s[4:7], s54 offen offset:0 sc1
    buffer_store_dwordx2 v[74:75], v5, s[4:7], s54 offen offset:256 sc1
    s_waitcnt vmcnt(62)
    v_dot2_f32_bf16 v104, v76, s67, 0
    v_dot2_f32_bf16 v105, v76, s68, 0
    v_dot2_f32_bf16 v106, v77, s67, 0
    v_dot2_f32_bf16 v107, v77, s68, 0
    v_dot2_f32_bf16 v108, v78, s67, 0
    v_dot2_f32_bf16 v109, v78, s68, 0
    v_dot2_f32_bf16 v110, v79, s67, 0
    v_dot2_f32_bf16 v111, v79, s68, 0
    v_cvt_pk_f16_f32 v76, v104, v105
    v_cvt_pk_f16_f32 v77, v106, v107
    v_cvt_pk_f16_f32 v78, v108, v109
    v_cvt_pk_f16_f32 v79, v110, v111
    s_add_u32 s54, s59, 98304
    buffer_store_dwordx2 v[76:77], v5, s[4:7], s54 offen offset:0 sc1
    buffer_store_dwordx2 v[78:79], v5, s[4:7], s54 offen offset:256 sc1
WCA2:
    s_waitcnt vmcnt(19)
    s_barrier
    s_add_u32 m0, s42, 102400
    s_add_u32 s54, s36, 20480
    buffer_load_dwordx4 v3, s[4:7], s54 offen offset:0 lds
    buffer_load_dwordx4 v3, s[4:7], s54 offen offset:1024 lds
    s_add_u32 m0, s42, 112640
    s_add_u32 s54, s36, 30720
    buffer_load_dwordx4 v3, s[4:7], s54 offen offset:0 lds
    buffer_load_dwordx4 v3, s[4:7], s54 offen offset:1024 lds
    s_waitcnt vmcnt(17)
    v_pk_add_f32 v[40:41], v[40:41], v[42:43]
    v_pk_add_f32 v[44:45], v[44:45], v[46:47]
    v_pk_add_f32 v[48:49], v[48:49], v[50:51]
    v_mov_b32 v46, v44
    v_mov_b32 v47, v45
    v_permlane32_swap_b32 v40, v48
    v_permlane32_swap_b32 v41, v49
    v_permlane32_swap_b32 v44, v46
    v_permlane32_swap_b32 v45, v47
    v_pk_add_f32 v[40:41], v[40:41], v[48:49]
    v_pk_add_f32 v[42:43], v[44:45], v[46:47]
    s_nop 1
    v_permlane16_swap_b32 v40, v42
    v_permlane16_swap_b32 v41, v43
    v_pk_add_f32 v[40:41], v[40:41], v[42:43]
    v_mul_f32 v42, 0x3acccccd, v40
    v_mul_f32 v41, 0x3acccccd, v41
    v_fma_f32 v41, -v42, v42, v41
    v_max_f32 v41, 0, v41
    v_add_f32 v41, 0x3727c5ac, v41
    v_rsq_f32 v40, v41
    s_nop 0
    v_mul_f32 v41, -v42, v40
    ds_write2_b32 v7, v40, v41 offset0:0 offset1:192
    s_waitcnt lgkmcnt(0)
    s_waitcnt vmcnt(8)
    s_barrier
    s_add_u32 m0, s42, 122880
    s_add_u32 s54, s36, 40960
    buffer_load_dwordx4 v3, s[4:7], s54 offen offset:0 lds
    buffer_load_dwordx4 v3, s[4:7], s54 offen offset:1024 lds
    s_add_u32 m0, s42, 133120
    s_add_u32 s54, s36, 51200
    buffer_load_dwordx4 v3, s[4:7], s54 offen offset:0 lds
    buffer_load_dwordx4 v3, s[4:7], s54 offen offset:1024 lds
    s_cmp_eq_u32 s14, 1
    s_cbranch_scc1 WCA4
    s_waitcnt vmcnt(62)
    v_dot2_f32_bf16 v96, v80, s67, 0
    v_dot2_f32_bf16 v97, v80, s68, 0
    v_dot2_f32_bf16 v98, v81, s67, 0
    v_dot2_f32_bf16 v99, v81, s68, 0
    v_dot2_f32_bf16 v100, v82, s67, 0
    v_dot2_f32_bf16 v101, v82, s68, 0
    v_dot2_f32_bf16 v102, v83, s67, 0
    v_dot2_f32_bf16 v103, v83, s68, 0
    v_cvt_pk_f16_f32 v80, v96, v97
    v_cvt_pk_f16_f32 v81, v98, v99
    v_cvt_pk_f16_f32 v82, v100, v101
    v_cvt_pk_f16_f32 v83, v102, v103
    s_add_u32 s54, s59, 131072
    buffer_store_dwordx2 v[80:81], v5, s[4:7], s54 offen offset:0 sc1
    buffer_store_dwordx2 v[82:83], v5, s[4:7], s54 offen offset:256 sc1
    s_waitcnt vmcnt(62)
    v_dot2_f32_bf16 v104, v84, s67, 0
    v_dot2_f32_bf16 v105, v84, s68, 0
    v_dot2_f32_bf16 v106, v85, s67, 0
    v_dot2_f32_bf16 v107, v85, s68, 0
    v_dot2_f32_bf16 v108, v86, s67, 0
    v_dot2_f32_bf16 v109, v86, s68, 0
    v_dot2_f32_bf16 v110, v87, s67, 0
    v_dot2_f32_bf16 v111, v87, s68, 0
    v_cvt_pk_f16_f32 v84, v104, v105
    v_cvt_pk_f16_f32 v85, v106, v107
    v_cvt_pk_f16_f32 v86, v108, v109
    v_cvt_pk_f16_f32 v87, v110, v111
    s_add_u32 s54, s59, 163840
    buffer_store_dwordx2 v[84:85], v5, s[4:7], s54 offen offset:0 sc1
    buffer_store_dwordx2 v[86:87], v5, s[4:7], s54 offen offset:256 sc1
WCA4:
    s_barrier
    s_cmp_eq_u32 s14, 1
    s_cbranch_scc1 WCA6
    s_waitcnt vmcnt(62)
    v_dot2_f32_bf16 v96, v88, s67, 0
    v_dot2_f32_bf16 v97, v88, s68, 0
    v_dot2_f32_bf16 v98, v89, s67, 0
    v_dot2_f32_bf16 v99, v89, s68, 0
    v_dot2_f32_bf16 v100, v90, s67, 0
    v_dot2_f32_bf16 v101, v90, s68, 0
    v_dot2_f32_bf16 v102, v91, s67, 0
    v_dot2_f32_bf16 v103, v91, s68, 0
    v_cvt_pk_f16_f32 v88, v96, v97
    v_cvt_pk_f16_f32 v89, v98, v99
    v_cvt_pk_f16_f32 v90, v100, v101
    v_cvt_pk_f16_f32 v91, v102, v103
    s_add_u32 s54, s59, 196608
    buffer_store_dwordx2 v[88:89], v5, s[4:7], s54 offen offset:0 sc1
    buffer_store_dwordx2 v[90:91], v5, s[4:7], s54 offen offset:256 sc1
    s_waitcnt vmcnt(62)
    v_dot2_f32_bf16 v104, v92, s67, 0
    v_dot2_f32_bf16 v105, v92, s68, 0
    v_dot2_f32_bf16 v106, v93, s67, 0
    v_dot2_f32_bf16 v107, v93, s68, 0
    v_dot2_f32_bf16 v108, v94, s67, 0
    v_dot2_f32_bf16 v109, v94, s68, 0
    v_dot2_f32_bf16 v110, v95, s67, 0
    v_dot2_f32_bf16 v111, v95, s68, 0
    v_cvt_pk_f16_f32 v92, v104, v105
    v_cvt_pk_f16_f32 v93, v106, v107
    v_cvt_pk_f16_f32 v94, v108, v109
    v_cvt_pk_f16_f32 v95, v110, v111
    s_add_u32 s54, s59, 229376
    buffer_store_dwordx2 v[92:93], v5, s[4:7], s54 offen offset:0 sc1
    buffer_store_dwordx2 v[94:95], v5, s[4:7], s54 offen offset:256 sc1
WCA6:
    s_barrier
    s_barrier
    s_add_u32 m0, s42, 143360
    s_add_u32 s54, s36, 61440
    buffer_load_dwordx4 v3, s[4:7], s54 offen offset:0 lds
    buffer_load_dwordx4 v3, s[4:7], s54 offen offset:1024 lds
    s_add_u32 m0, s42, 153600
    s_add_u32 s54, s36, 71680
    buffer_load_dwordx4 v3, s[4:7], s54 offen offset:0 lds
    buffer_load_dwordx4 v3, s[4:7], s54 offen offset:1024 lds
    s_barrier
    s_add_u32 m0, s41, 20480
    s_add_u32 s54, s31, 0
    buffer_load_dwordx4 v3, s[4:7], s54 offen offset:0 sc1 lds
    buffer_load_dwordx4 v3, s[4:7], s54 offen offset:1024 sc1 lds
    s_add_u32 m0, s41, 28672
    s_add_u32 s54, s31, 262144
    buffer_load_dwordx4 v3, s[4:7], s54 offen offset:0 sc1 lds
    buffer_load_dwordx4 v3, s[4:7], s54 offen offset:1024 sc1 lds
    s_add_u32 m0, s41, 36864
    s_add_u32 s54, s31, 524288
    buffer_load_dwordx4 v3, s[4:7], s54 offen offset:0 sc1 lds
    buffer_load_dwordx4 v3, s[4:7], s54 offen offset:1024 sc1 lds
    s_add_u32 m0, s41, 45056
    s_add_u32 s54, s31, 786432
    buffer_load_dwordx4 v3, s[4:7], s54 offen offset:0 sc1 lds
    buffer_load_dwordx4 v3, s[4:7], s54 offen offset:1024 sc1 lds
    s_add_u32 m0, s41, 53248
    s_add_u32 s54, s31, 1048576
    buffer_load_dwordx4 v3, s[4:7], s54 offen offset:0 sc1 lds
    buffer_load_dwordx4 v3, s[4:7], s54 offen offset:1024 sc1 lds
    s_add_u32 m0, s41, 61440
    s_add_u32 s54, s31, 1310720
    buffer_load_dwordx4 v3, s[4:7], s54 offen offset:0 sc1 lds
    buffer_load_dwordx4 v3, s[4:7], s54 offen offset:1024 sc1 lds
    s_add_u32 m0, s41, 69632
    s_add_u32 s54, s31, 1572864
    buffer_load_dwordx4 v3, s[4:7], s54 offen offset:0 sc1 lds
    buffer_load_dwordx4 v3, s[4:7], s54 offen offset:1024 sc1 lds
    s_waitcnt vmcnt(12)
    s_barrier
    s_waitcnt vmcnt(10)
    s_barrier
    s_waitcnt vmcnt(8)
    s_barrier
    s_add_u32 m0, s41, 20480
    s_add_u32 s54, s31, 1835008
    buffer_load_dwordx4 v3, s[4:7], s54 offen offset:0 sc1 lds
    buffer_load_dwordx4 v3, s[4:7], s54 offen offset:1024 sc1 lds
    s_add_u32 m0, s42, 81920
    s_add_u32 s54, s36, 81920
    buffer_load_dwordx4 v3, s[4:7], s54 offen offset:0 lds
    buffer_load_dwordx4 v3, s[4:7], s54 offen offset:1024 lds
    s_waitcnt vmcnt(10)
    s_barrier
    s_add_u32 m0, s41, 28672
    s_add_u32 s54, s31, 2097152
    buffer_load_dwordx4 v3, s[4:7], s54 offen offset:0 sc1 lds
    buffer_load_dwordx4 v3, s[4:7], s54 offen offset:1024 sc1 lds
    s_add_u32 m0, s42, 92160
    s_add_u32 s54, s36, 92160
    buffer_load_dwordx4 v3, s[4:7], s54 offen offset:0 lds
    buffer_load_dwordx4 v3, s[4:7], s54 offen offset:1024 lds
    s_waitcnt vmcnt(12)
    s_barrier
    s_add_u32 m0, s41, 36864
    s_add_u32 s54, s31, 2359296
    buffer_load_dwordx4 v3, s[4:7], s54 offen offset:0 sc1 lds
    buffer_load_dwordx4 v3, s[4:7], s54 offen offset:1024 sc1 lds
    s_waitcnt vmcnt(12)
    s_barrier
    s_add_u32 m0, s43, 106496
    s_add_u32 s54, s37, 0
    buffer_load_dwordx4 v3, s[4:7], s54 offen offset:0 lds
    buffer_load_dwordx4 v3, s[4:7], s54 offen offset:1024 lds
    buffer_load_dwordx4 v3, s[4:7], s54 offen offset:2048 lds
    s_waitcnt vmcnt(13)
    s_barrier
    s_waitcnt vmcnt(11)
    s_barrier
    s_add_u32 m0, s43, 120832
    s_add_u32 s54, s37, 14336
    buffer_load_dwordx4 v3, s[4:7], s54 offen offset:0 lds
    buffer_load_dwordx4 v3, s[4:7], s54 offen offset:1024 lds
    buffer_load_dwordx4 v3, s[4:7], s54 offen offset:2048 lds
    s_waitcnt vmcnt(10)
    s_barrier
    s_add_u32 m0, s43, 135168
    s_add_u32 s54, s37, 28672
    buffer_load_dwordx4 v3, s[4:7], s54 offen offset:0 lds
    buffer_load_dwordx4 v3, s[4:7], s54 offen offset:1024 lds
    buffer_load_dwordx4 v3, s[4:7], s54 offen offset:2048 lds
    s_waitcnt vmcnt(9)
    s_barrier
    s_add_u32 m0, s43, 149504
    s_add_u32 s54, s37, 43008
    buffer_load_dwordx4 v3, s[4:7], s54 offen offset:0 lds
    buffer_load_dwordx4 v3, s[4:7], s54 offen offset:1024 lds
    buffer_load_dwordx4 v3, s[4:7], s54 offen offset:2048 lds
    s_barrier
    s_waitcnt vmcnt(0)
    s_barrier
    s_barrier
    s_add_u32 m0, s41, 20480
    s_add_u32 s54, s32, 0
    buffer_load_dwordx4 v3, s[4:7], s54 offen offset:0 sc1 lds
    buffer_load_dwordx4 v3, s[4:7], s54 offen offset:1024 sc1 lds
    s_add_u32 m0, s41, 28672
    s_add_u32 s54, s32, 262144
    buffer_load_dwordx4 v3, s[4:7], s54 offen offset:0 sc1 lds
    buffer_load_dwordx4 v3, s[4:7], s54 offen offset:1024 sc1 lds
    s_add_u32 m0, s41, 36864
    s_add_u32 s54, s32, 524288
    buffer_load_dwordx4 v3, s[4:7], s54 offen offset:0 sc1 lds
    buffer_load_dwordx4 v3, s[4:7], s54 offen offset:1024 sc1 lds
    s_add_u32 m0, s41, 45056
    s_add_u32 s54, s32, 786432
    buffer_load_dwordx4 v3, s[4:7], s54 offen offset:0 sc1 lds
    buffer_load_dwordx4 v3, s[4:7], s54 offen offset:1024 sc1 lds
    s_add_u32 m0, s41, 53248
    s_add_u32 s54, s32, 1048576
    buffer_load_dwordx4 v3, s[4:7], s54 offen offset:0 sc1 lds
    buffer_load_dwordx4 v3, s[4:7], s54 offen offset:1024 sc1 lds
    s_add_u32 m0, s41, 61440
    s_add_u32 s54, s32, 1310720
    buffer_load_dwordx4 v3, s[4:7], s54 offen offset:0 sc1 lds
    buffer_load_dwordx4 v3, s[4:7], s54 offen offset:1024 sc1 lds
    s_add_u32 m0, s41, 69632
    s_add_u32 s54, s32, 1572864
    buffer_load_dwordx4 v3, s[4:7], s54 offen offset:0 sc1 lds
    buffer_load_dwordx4 v3, s[4:7], s54 offen offset:1024 sc1 lds
    s_waitcnt vmcnt(12)
    s_barrier
    s_add_u32 m0, s41, 77824
    s_add_u32 s54, s32, 1835008
    buffer_load_dwordx4 v3, s[4:7], s54 offen offset:0 sc1 lds
    buffer_load_dwordx4 v3, s[4:7], s54 offen offset:1024 sc1 lds
    s_add_u32 m0, s41, 86016
    s_add_u32 s54, s32, 2097152
    buffer_load_dwordx4 v3, s[4:7], s54 offen offset:0 sc1 lds
    buffer_load_dwordx4 v3, s[4:7], s54 offen offset:1024 sc1 lds
    s_waitcnt vmcnt(14)
    s_barrier
    s_add_u32 m0, s43, 106496
    s_add_u32 s54, s37, 57344
    buffer_load_dwordx4 v3, s[4:7], s54 offen offset:0 lds
    buffer_load_dwordx4 v3, s[4:7], s54 offen offset:1024 lds
    buffer_load_dwordx4 v3, s[4:7], s54 offen offset:2048 lds
    s_add_u32 m0, s41, 94208
    s_add_u32 s54, s32, 2359296
    buffer_load_dwordx4 v3, s[4:7], s54 offen offset:0 sc1 lds
    buffer_load_dwordx4 v3, s[4:7], s54 offen offset:1024 sc1 lds
    s_waitcnt vmcnt(17)
    s_barrier
    s_add_u32 m0, s43, 120832
    s_add_u32 s54, s37, 71680
    buffer_load_dwordx4 v3, s[4:7], s54 offen offset:0 lds
    buffer_load_dwordx4 v3, s[4:7], s54 offen offset:1024 lds
    buffer_load_dwordx4 v3, s[4:7], s54 offen offset:2048 lds
    s_waitcnt vmcnt(18)
    s_barrier
    s_add_u32 m0, s43, 135168
    s_add_u32 s54, s37, 86016
    buffer_load_dwordx4 v3, s[4:7], s54 offen offset:0 lds
    buffer_load_dwordx4 v3, s[4:7], s54 offen offset:1024 lds
    buffer_load_dwordx4 v3, s[4:7], s54 offen offset:2048 lds
    s_waitcnt vmcnt(8)
    s_barrier
    s_add_u32 m0, s43, 149504
    s_add_u32 s54, s37, 100352
    buffer_load_dwordx4 v3, s[4:7], s54 offen offset:0 lds
    buffer_load_dwordx4 v3, s[4:7], s54 offen offset:1024 lds
    buffer_load_dwordx4 v3, s[4:7], s54 offen offset:2048 lds
    s_waitcnt vmcnt(6)
    s_barrier
    s_add_u32 m0, s43, 106496
    s_add_u32 s54, s37, 114688
    buffer_load_dwordx4 v3, s[4:7], s54 offen offset:0 lds
    buffer_load_dwordx4 v3, s[4:7], s54 offen offset:1024 lds
    buffer_load_dwordx4 v3, s[4:7], s54 offen offset:2048 lds
    s_add_u32 s54, s12, s58
    s_add_u32 s55, s54, 16384
    buffer_load_dwordx2 v[40:41], v6, s[4:7], s54 offen sc1
    buffer_load_dwordx2 v[42:43], v6, s[4:7], s55 offen sc1
    s_waitcnt vmcnt(8)
    s_barrier
    s_add_u32 m0, s43, 120832
    s_add_u32 s54, s37, 129024
    buffer_load_dwordx4 v3, s[4:7], s54 offen offset:0 lds
    buffer_load_dwordx4 v3, s[4:7], s54 offen offset:1024 lds
    buffer_load_dwordx4 v3, s[4:7], s54 offen offset:2048 lds
    s_waitcnt vmcnt(8)
    s_barrier
    s_add_u32 m0, s43, 135168
    s_add_u32 s54, s38, 0
    buffer_load_dwordx4 v3, s[4:7], s54 offen offset:0 lds
    buffer_load_dwordx4 v3, s[4:7], s54 offen offset:1024 lds
    buffer_load_dwordx4 v3, s[4:7], s54 offen offset:2048 lds
    buffer_load_dwordx4 v3, s[4:7], s54 offen offset:3072 lds
    s_waitcnt vmcnt(9)
    s_barrier
    s_add_u32 m0, s43, 149504
    s_add_u32 s54, s38, 14336
    buffer_load_dwordx4 v3, s[4:7], s54 offen offset:0 lds
    buffer_load_dwordx4 v3, s[4:7], s54 offen offset:1024 lds
    buffer_load_dwordx4 v3, s[4:7], s54 offen offset:2048 lds
    s_waitcnt vmcnt(10)
    v_pk_add_f32 v[40:41], v[40:41], v[42:43]
    v_mov_b32 v42, v40
    v_mov_b32 v43, v41
    s_nop 0
    v_permlane32_swap_b32 v40, v42
    v_permlane32_swap_b32 v41, v43
    v_pk_add_f32 v[40:41], v[40:41], v[42:43]
    v_mov_b32 v42, v40
    v_mov_b32 v43, v41
    s_nop 0
    v_permlane16_swap_b32 v40, v42
    v_permlane16_swap_b32 v41, v43
    v_pk_add_f32 v[40:41], v[40:41], v[42:43]
    v_mul_f32 v42, 0x3acccccd, v40
    v_mul_f32 v41, 0x3acccccd, v41
    v_fma_f32 v41, -v42, v42, v41
    v_max_f32 v41, 0, v41
    v_add_f32 v41, 0x3727c5ac, v41
    v_rsq_f32 v40, v41
    s_nop 0
    v_mul_f32 v41, -v42, v40
    ds_write2_b32 v18, v40, v41 offset0:0 offset1:192
    s_waitcnt lgkmcnt(0)
    s_waitcnt vmcnt(7)
    s_barrier
    s_add_u32 m0, s43, 106496
    s_add_u32 s54, s38, 28672
    buffer_load_dwordx4 v3, s[4:7], s54 offen offset:0 lds
    buffer_load_dwordx4 v3, s[4:7], s54 offen offset:1024 lds
    buffer_load_dwordx4 v3, s[4:7], s54 offen offset:2048 lds
    buffer_load_dwordx4 v3, s[4:7], s54 offen offset:3072 lds
    s_barrier
    s_add_u32 m0, s43, 120832
    s_add_u32 s54, s38, 43008
    buffer_load_dwordx4 v3, s[4:7], s54 offen offset:0 lds
    buffer_load_dwordx4 v3, s[4:7], s54 offen offset:1024 lds
    buffer_load_dwordx4 v3, s[4:7], s54 offen offset:2048 lds
    s_waitcnt vmcnt(10)
    s_barrier
    s_waitcnt vmcnt(7)
    s_barrier
    s_add_u32 m0, s43, 135168
    s_add_u32 s54, s38, 57344
    buffer_load_dwordx4 v3, s[4:7], s54 offen offset:0 lds
    buffer_load_dwordx4 v3, s[4:7], s54 offen offset:1024 lds
    buffer_load_dwordx4 v3, s[4:7], s54 offen offset:2048 lds
    buffer_load_dwordx4 v3, s[4:7], s54 offen offset:3072 lds
    s_waitcnt vmcnt(8)
    s_waitcnt vmcnt(7)
    s_barrier
    s_add_u32 m0, s43, 149504
    s_add_u32 s54, s38, 71680
    buffer_load_dwordx4 v3, s[4:7], s54 offen offset:0 lds
    buffer_load_dwordx4 v3, s[4:7], s54 offen offset:1024 lds
    buffer_load_dwordx4 v3, s[4:7], s54 offen offset:2048 lds
    s_waitcnt vmcnt(7)
    s_barrier
    s_add_u32 m0, s43, 106496
    s_add_u32 s54, s38, 86016
    buffer_load_dwordx4 v3, s[4:7], s54 offen offset:0 lds
    buffer_load_dwordx4 v3, s[4:7], s54 offen offset:1024 lds
    buffer_load_dwordx4 v3, s[4:7], s54 offen offset:2048 lds
    buffer_load_dwordx4 v3, s[4:7], s54 offen offset:3072 lds
    s_waitcnt vmcnt(7)
    s_barrier
    s_add_u32 m0, s43, 120832
    s_add_u32 s54, s38, 100352
    buffer_load_dwordx4 v3, s[4:7], s54 offen offset:0 lds
    buffer_load_dwordx4 v3, s[4:7], s54 offen offset:1024 lds
    buffer_load_dwordx4 v3, s[4:7], s54 offen offset:2048 lds
    s_waitcnt vmcnt(7)
    s_barrier
    s_add_u32 m0, s43, 135168
    s_add_u32 s54, s38, 114688
    buffer_load_dwordx4 v3, s[4:7], s54 offen offset:0 lds
    buffer_load_dwordx4 v3, s[4:7], s54 offen offset:1024 lds
    buffer_load_dwordx4 v3, s[4:7], s54 offen offset:2048 lds
    buffer_load_dwordx4 v3, s[4:7], s54 offen offset:3072 lds
    s_waitcnt vmcnt(7)
    s_barrier
    s_add_u32 m0, s43, 149504
    s_add_u32 s54, s38, 129024
    buffer_load_dwordx4 v3, s[4:7], s54 offen offset:0 lds
    buffer_load_dwordx4 v3, s[4:7], s54 offen offset:1024 lds
    buffer_load_dwordx4 v3, s[4:7], s54 offen offset:2048 lds
    s_waitcnt vmcnt(7)
    s_barrier
    s_add_u32 m0, s41, 106496
    s_add_u32 s54, s39, 0
    buffer_load_dwordx4 v3, s[4:7], s54 offen offset:0 sc1 lds
    buffer_load_dwordx4 v3, s[4:7], s54 offen offset:1024 sc1 lds
    s_waitcnt vmcnt(5)
    s_barrier
    s_cmp_lg_u32 s19, 0
    s_cbranch_scc1 PL4_i
    buffer_load_dword v22, v20, s[4:7], s52 offen sc1
PL4_i:
    s_add_u32 m0, s41, 114688
    s_add_u32 s54, s39, 8192
    buffer_load_dwordx4 v3, s[4:7], s54 offen offset:0 sc1 lds
    buffer_load_dwordx4 v3, s[4:7], s54 offen offset:1024 sc1 lds
    s_add_u32 m0, s41, 122880
    s_add_u32 s54, s39, 16384
    buffer_load_dwordx4 v3, s[4:7], s54 offen offset:0 sc1 lds
    buffer_load_dwordx4 v3, s[4:7], s54 offen offset:1024 sc1 lds
    s_waitcnt vmcnt(6)
    s_barrier
    s_add_u32 m0, s41, 131072
    s_add_u32 s54, s39, 24576
    buffer_load_dwordx4 v3, s[4:7], s54 offen offset:0 sc1 lds
    buffer_load_dwordx4 v3, s[4:7], s54 offen offset:1024 sc1 lds
    s_add_u32 m0, s41, 139264
    s_add_u32 s54, s39, 32768
    buffer_load_dwordx4 v3, s[4:7], s54 offen offset:0 sc1 lds
    buffer_load_dwordx4 v3, s[4:7], s54 offen offset:1024 sc1 lds
    s_cmp_lg_u32 s19, 0
    s_cbranch_scc1 PL4_done
    s_mov_b32 s55, 0
    s_waitcnt vmcnt(8)
    s_branch PL4_chk
PL4:
    buffer_load_dword v22, v20, s[4:7], s52 offen sc1
    s_waitcnt vmcnt(0)
PL4_chk:
    v_cmp_ne_u32 vcc, 8, v22
    s_nop 1
    s_cmp_eq_u64 vcc, 0
    s_cbranch_scc1 PL4_ok
    s_mov_b32 exec_lo, vcc_lo
    s_mov_b32 exec_hi, 0
    s_sleep 1
    s_add_u32 s55, s55, 1
    s_cmp_lt_u32 s55, 0x40000
    s_cbranch_scc1 PL4
PL4_ok:
    s_mov_b64 exec, -1
PL4_done:
    s_barrier
    buffer_load_dwordx4 v[24:27], v3, s[4:7], s47 offen sc1
    s_add_u32 m0, s43, 49152
    s_add_u32 s54, s33, 0
    buffer_load_dwordx4 v3, s[4:7], s54 offen offset:0 sc1 lds
    buffer_load_dwordx4 v3, s[4:7], s54 offen offset:1024 sc1 lds
    buffer_load_dwordx4 v3, s[4:7], s54 offen offset:2048 sc1 lds
    buffer_load_dwordx4 v3, s[4:7], s54 offen offset:3072 sc1 lds
    s_add_u32 m0, s43, 63488
    s_add_u32 s54, s33, 114688
    buffer_load_dwordx4 v3, s[4:7], s54 offen offset:0 sc1 lds
    buffer_load_dwordx4 v3, s[4:7], s54 offen offset:1024 sc1 lds
    buffer_load_dwordx4 v3, s[4:7], s54 offen offset:2048 sc1 lds
    s_add_u32 m0, s43, 77824
    s_add_u32 s54, s33, 229376
    buffer_load_dwordx4 v3, s[4:7], s54 offen offset:0 sc1 lds
    buffer_load_dwordx4 v3, s[4:7], s54 offen offset:1024 sc1 lds
    buffer_load_dwordx4 v3, s[4:7], s54 offen offset:2048 sc1 lds
    buffer_load_dwordx4 v3, s[4:7], s54 offen offset:3072 sc1 lds
    s_add_u32 m0, s43, 92160
    s_add_u32 s54, s33, 344064
    buffer_load_dwordx4 v3, s[4:7], s54 offen offset:0 sc1 lds
    buffer_load_dwordx4 v3, s[4:7], s54 offen offset:1024 sc1 lds
    buffer_load_dwordx4 v3, s[4:7], s54 offen offset:2048 sc1 lds
    s_add_u32 m0, s41, 147456
    s_add_u32 s54, s39, 40960
    buffer_load_dwordx4 v3, s[4:7], s54 offen offset:0 sc1 lds
    buffer_load_dwordx4 v3, s[4:7], s54 offen offset:1024 sc1 lds
    s_add_u32 m0, s41, 155648
    s_add_u32 s54, s39, 49152
    buffer_load_dwordx4 v3, s[4:7], s54 offen offset:0 sc1 lds
    buffer_load_dwordx4 v3, s[4:7], s54 offen offset:1024 sc1 lds
    s_add_u32 s54, s47, 4096
    buffer_load_dwordx4 v[28:31], v3, s[4:7], s54 offen sc1
    s_add_u32 s54, s47, 8192
    buffer_load_dwordx4 v[32:35], v3, s[4:7], s54 offen sc1
    s_add_u32 s54, s47, 12288
    buffer_load_dwordx4 v[36:39], v3, s[4:7], s54 offen sc1
    s_waitcnt vmcnt(21)
    v_mul_f32 v24, 0x3a97b426, v24
    v_mul_f32 v25, 0x3a97b426, v25
    v_mul_f32 v26, 0x3a97b426, v26
    v_mul_f32 v27, 0x3a97b426, v27
    v_fma_f32 v25, -v24, v24, v25
    v_fma_f32 v27, -v26, v26, v27
    v_max_f32 v25, 0, v25
    v_max_f32 v27, 0, v27
    v_add_f32 v25, 0x3727c5ac, v25
    v_add_f32 v27, 0x3727c5ac, v27
    v_rsq_f32 v25, v25
    v_rsq_f32 v27, v27
    v_cvt_pk_f16_f32 v14, v24, v26
    v_cvt_pk_f16_f32 v25, v25, v27
    v_cvt_f32_f16 v15, v14
    v_cvt_f32_f16_sdwa v23, v14 dst_sel:DWORD dst_unused:UNUSED_PAD src0_sel:WORD_1
    ds_write_b32 v16, v25 offset:4096
    ds_write_b32 v17, v14 offset:8192
    v_sub_f32 v15, v24, v15
    v_sub_f32 v23, v26, v23
    v_cvt_pk_f16_f32 v15, v15, v23
    ds_write_b32 v17, v15 offset:8256
    s_waitcnt lgkmcnt(0)
    s_waitcnt vmcnt(17)
    s_barrier
    s_add_u32 m0, s43, 20480
    s_add_u32 s54, s33, 458752
    buffer_load_dwordx4 v3, s[4:7], s54 offen offset:0 sc1 lds
    buffer_load_dwordx4 v3, s[4:7], s54 offen offset:1024 sc1 lds
    buffer_load_dwordx4 v3, s[4:7], s54 offen offset:2048 sc1 lds
    buffer_load_dwordx4 v3, s[4:7], s54 offen offset:3072 sc1 lds
    s_add_u32 m0, s43, 34816
    s_add_u32 s54, s33, 573440
    buffer_load_dwordx4 v3, s[4:7], s54 offen offset:0 sc1 lds
    buffer_load_dwordx4 v3, s[4:7], s54 offen offset:1024 sc1 lds
    buffer_load_dwordx4 v3, s[4:7], s54 offen offset:2048 sc1 lds
    s_waitcnt vmcnt(21)
    s_barrier
    s_waitcnt vmcnt(17)
    s_barrier
    s_add_u32 m0, s43, 49152
    s_add_u32 s54, s33, 688128
    buffer_load_dwordx4 v3, s[4:7], s54 offen offset:0 sc1 lds
    buffer_load_dwordx4 v3, s[4:7], s54 offen offset:1024 sc1 lds
    buffer_load_dwordx4 v3, s[4:7], s54 offen offset:2048 sc1 lds
    buffer_load_dwordx4 v3, s[4:7], s54 offen offset:3072 sc1 lds
    s_waitcnt vmcnt(13)
    v_mul_f32 v28, 0x3a97b426, v28
    v_mul_f32 v29, 0x3a97b426, v29
    v_mul_f32 v30, 0x3a97b426, v30
    v_mul_f32 v31, 0x3a97b426, v31
    v_fma_f32 v29, -v28, v28, v29
    v_fma_f32 v31, -v30, v30, v31
    v_max_f32 v29, 0, v29
    v_max_f32 v31, 0, v31
    v_add_f32 v29, 0x3727c5ac, v29
    v_add_f32 v31, 0x3727c5ac, v31
    v_rsq_f32 v29, v29
    v_rsq_f32 v31, v31
    v_cvt_pk_f16_f32 v10, v28, v30
    v_cvt_pk_f16_f32 v29, v29, v31
    v_cvt_f32_f16 v11, v10
    v_cvt_f32_f16_sdwa v12, v10 dst_sel:DWORD dst_unused:UNUSED_PAD src0_sel:WORD_1
    ds_write_b32 v16, v29 offset:5120
    ds_write_b32 v17, v10 offset:10240
    v_sub_f32 v11, v28, v11
    v_sub_f32 v12, v30, v12
    v_cvt_pk_f16_f32 v11, v11, v12
    ds_write_b32 v17, v11 offset:10304
    s_waitcnt lgkmcnt(0)
    s_waitcnt vmcnt(18)
    s_barrier
    s_add_u32 m0, s43, 63488
    s_add_u32 s54, s33, 802816
    buffer_load_dwordx4 v3, s[4:7], s54 offen offset:0 sc1 lds
    buffer_load_dwordx4 v3, s[4:7], s54 offen offset:1024 sc1 lds
    buffer_load_dwordx4 v3, s[4:7], s54 offen offset:2048 sc1 lds
    s_add_u32 m0, s41, 114688
    s_add_u32 s54, s39, 57344
    buffer_load_dwordx4 v3, s[4:7], s54 offen offset:0 sc1 lds
    buffer_load_dwordx4 v3, s[4:7], s54 offen offset:1024 sc1 lds
    s_waitcnt vmcnt(12)
    s_barrier
    s_add_u32 m0, s43, 77824
    s_add_u32 s54, s33, 917504
    buffer_load_dwordx4 v3, s[4:7], s54 offen offset:0 sc1 lds
    buffer_load_dwordx4 v3, s[4:7], s54 offen offset:1024 sc1 lds
    buffer_load_dwordx4 v3, s[4:7], s54 offen offset:2048 sc1 lds
    buffer_load_dwordx4 v3, s[4:7], s54 offen offset:3072 sc1 lds
    s_add_u32 m0, s41, 122880
    s_add_u32 s54, s39, 65536
    buffer_load_dwordx4 v3, s[4:7], s54 offen offset:0 sc1 lds
    buffer_load_dwordx4 v3, s[4:7], s54 offen offset:1024 sc1 lds
    s_waitcnt vmcnt(23)
    v_mul_f32 v32, 0x3a97b426, v32
    v_mul_f32 v33, 0x3a97b426, v33
    v_mul_f32 v34, 0x3a97b426, v34
    v_mul_f32 v35, 0x3a97b426, v35
    v_fma_f32 v33, -v32, v32, v33
    v_fma_f32 v35, -v34, v34, v35
    v_max_f32 v33, 0, v33
    v_max_f32 v35, 0, v35
    v_add_f32 v33, 0x3727c5ac, v33
    v_add_f32 v35, 0x3727c5ac, v35
    v_rsq_f32 v33, v33
    v_rsq_f32 v35, v35
    v_cvt_pk_f16_f32 v14, v32, v34
    v_cvt_pk_f16_f32 v33, v33, v35
    v_cvt_f32_f16 v15, v14
    v_cvt_f32_f16_sdwa v23, v14 dst_sel:DWORD dst_unused:UNUSED_PAD src0_sel:WORD_1
    ds_write_b32 v16, v33 offset:6144
    ds_write_b32 v17, v14 offset:12288
    v_sub_f32 v15, v32, v15
    v_sub_f32 v23, v34, v23
    v_cvt_pk_f16_f32 v15, v15, v23
    ds_write_b32 v17, v15 offset:12352
    s_waitcnt lgkmcnt(0)
    s_waitcnt vmcnt(15)
    s_barrier
    s_add_u32 m0, s43, 92160
    s_add_u32 s54, s33, 1032192
    buffer_load_dwordx4 v3, s[4:7], s54 offen offset:0 sc1 lds
    buffer_load_dwordx4 v3, s[4:7], s54 offen offset:1024 sc1 lds
    buffer_load_dwordx4 v3, s[4:7], s54 offen offset:2048 sc1 lds
    s_add_u32 m0, s41, 131072
    s_add_u32 s54, s39, 73728
    buffer_load_dwordx4 v3, s[4:7], s54 offen offset:0 sc1 lds
    buffer_load_dwordx4 v3, s[4:7], s54 offen offset:1024 sc1 lds
    s_waitcnt vmcnt(16)
    s_barrier
    s_add_u32 m0, s43, 20480
    s_add_u32 s54, s33, 1146880
    buffer_load_dwordx4 v3, s[4:7], s54 offen offset:0 sc1 lds
    buffer_load_dwordx4 v3, s[4:7], s54 offen offset:1024 sc1 lds
    buffer_load_dwordx4 v3, s[4:7], s54 offen offset:2048 sc1 lds
    buffer_load_dwordx4 v3, s[4:7], s54 offen offset:3072 sc1 lds
    s_add_u32 m0, s41, 139264
    s_add_u32 s54, s39, 81920
    buffer_load_dwordx4 v3, s[4:7], s54 offen offset:0 sc1 lds
    buffer_load_dwordx4 v3, s[4:7], s54 offen offset:1024 sc1 lds
    s_waitcnt vmcnt(33)
    v_mul_f32 v36, 0x3a97b426, v36
    v_mul_f32 v37, 0x3a97b426, v37
    v_mul_f32 v38, 0x3a97b426, v38
    v_mul_f32 v39, 0x3a97b426, v39
    v_fma_f32 v37, -v36, v36, v37
    v_fma_f32 v39, -v38, v38, v39
    v_max_f32 v37, 0, v37
    v_max_f32 v39, 0, v39
    v_add_f32 v37, 0x3727c5ac, v37
    v_add_f32 v39, 0x3727c5ac, v39
    v_rsq_f32 v37, v37
    v_rsq_f32 v39, v39
    v_cvt_pk_f16_f32 v10, v36, v38
    v_cvt_pk_f16_f32 v37, v37, v39
    v_cvt_f32_f16 v11, v10
    v_cvt_f32_f16_sdwa v12, v10 dst_sel:DWORD dst_unused:UNUSED_PAD src0_sel:WORD_1
    ds_write_b32 v16, v37 offset:7168
    ds_write_b32 v17, v10 offset:14336
    v_sub_f32 v11, v36, v11
    v_sub_f32 v12, v38, v12
    v_cvt_pk_f16_f32 v11, v11, v12
    ds_write_b32 v17, v11 offset:14400
    s_waitcnt lgkmcnt(0)
    s_waitcnt vmcnt(17)
    s_barrier
    s_add_u32 m0, s43, 34816
    s_add_u32 s54, s33, 1261568
    buffer_load_dwordx4 v3, s[4:7], s54 offen offset:0 sc1 lds
    buffer_load_dwordx4 v3, s[4:7], s54 offen offset:1024 sc1 lds
    buffer_load_dwordx4 v3, s[4:7], s54 offen offset:2048 sc1 lds
    s_add_u32 m0, s41, 147456
    s_add_u32 s54, s39, 90112
    buffer_load_dwordx4 v3, s[4:7], s54 offen offset:0 sc1 lds
    buffer_load_dwordx4 v3, s[4:7], s54 offen offset:1024 sc1 lds
    s_waitcnt vmcnt(16)
    s_barrier
    s_add_u32 m0, s43, 49152
    s_add_u32 s54, s33, 1376256
    buffer_load_dwordx4 v3, s[4:7], s54 offen offset:0 sc1 lds
    buffer_load_dwordx4 v3, s[4:7], s54 offen offset:1024 sc1 lds
    buffer_load_dwordx4 v3, s[4:7], s54 offen offset:2048 sc1 lds
    buffer_load_dwordx4 v3, s[4:7], s54 offen offset:3072 sc1 lds
    s_add_u32 m0, s41, 155648
    s_add_u32 s54, s39, 98304
    buffer_load_dwordx4 v3, s[4:7], s54 offen offset:0 sc1 lds
    buffer_load_dwordx4 v3, s[4:7], s54 offen offset:1024 sc1 lds
    s_waitcnt vmcnt(17)
    s_barrier
    s_add_u32 m0, s43, 63488
    s_add_u32 s54, s33, 1490944
    buffer_load_dwordx4 v3, s[4:7], s54 offen offset:0 sc1 lds
    buffer_load_dwordx4 v3, s[4:7], s54 offen offset:1024 sc1 lds
    buffer_load_dwordx4 v3, s[4:7], s54 offen offset:2048 sc1 lds
    s_add_u32 m0, s41, 114688
    s_add_u32 s54, s39, 106496
    buffer_load_dwordx4 v3, s[4:7], s54 offen offset:0 sc1 lds
    buffer_load_dwordx4 v3, s[4:7], s54 offen offset:1024 sc1 lds
    s_waitcnt vmcnt(16)
    s_barrier
    s_add_u32 m0, s43, 77824
    s_add_u32 s54, s33, 1605632
    buffer_load_dwordx4 v3, s[4:7], s54 offen offset:0 sc1 lds
    buffer_load_dwordx4 v3, s[4:7], s54 offen offset:1024 sc1 lds
    buffer_load_dwordx4 v3, s[4:7], s54 offen offset:2048 sc1 lds
    buffer_load_dwordx4 v3, s[4:7], s54 offen offset:3072 sc1 lds
    s_add_u32 m0, s41, 122880
    s_add_u32 s54, s39, 114688
    buffer_load_dwordx4 v3, s[4:7], s54 offen offset:0 sc1 lds
    buffer_load_dwordx4 v3, s[4:7], s54 offen offset:1024 sc1 lds
    s_waitcnt vmcnt(17)
    s_barrier
    s_add_u32 m0, s43, 92160
    s_add_u32 s54, s33, 1720320
    buffer_load_dwordx4 v3, s[4:7], s54 offen offset:0 sc1 lds
    buffer_load_dwordx4 v3, s[4:7], s54 offen offset:1024 sc1 lds
    buffer_load_dwordx4 v3, s[4:7], s54 offen offset:2048 sc1 lds
    s_add_u32 m0, s41, 131072
    s_add_u32 s54, s39, 122880
    buffer_load_dwordx4 v3, s[4:7], s54 offen offset:0 sc1 lds
    buffer_load_dwordx4 v3, s[4:7], s54 offen offset:1024 sc1 lds
    s_waitcnt vmcnt(16)
    s_barrier
    s_add_u32 m0, s43, 20480
    s_add_u32 s54, s33, 1835008
    buffer_load_dwordx4 v3, s[4:7], s54 offen offset:0 sc1 lds
    buffer_load_dwordx4 v3, s[4:7], s54 offen offset:1024 sc1 lds
    buffer_load_dwordx4 v3, s[4:7], s54 offen offset:2048 sc1 lds
    buffer_load_dwordx4 v3, s[4:7], s54 offen offset:3072 sc1 lds
    s_add_u32 m0, s41, 139264
    s_add_u32 s54, s39, 131072
    buffer_load_dwordx4 v3, s[4:7], s54 offen offset:0 sc1 lds
    buffer_load_dwordx4 v3, s[4:7], s54 offen offset:1024 sc1 lds
    s_waitcnt vmcnt(17)
    s_barrier
    s_add_u32 m0, s43, 34816
    s_add_u32 s54, s33, 1949696
    buffer_load_dwordx4 v3, s[4:7], s54 offen offset:0 sc1 lds
    buffer_load_dwordx4 v3, s[4:7], s54 offen offset:1024 sc1 lds
    buffer_load_dwordx4 v3, s[4:7], s54 offen offset:2048 sc1 lds
    s_add_u32 m0, s41, 147456
    s_add_u32 s54, s39, 139264
    buffer_load_dwordx4 v3, s[4:7], s54 offen offset:0 sc1 lds
    buffer_load_dwordx4 v3, s[4:7], s54 offen offset:1024 sc1 lds
    s_waitcnt vmcnt(16)
    s_barrier
    s_add_u32 m0, s43, 49152
    s_add_u32 s54, s33, 2064384
    buffer_load_dwordx4 v3, s[4:7], s54 offen offset:0 sc1 lds
    buffer_load_dwordx4 v3, s[4:7], s54 offen offset:1024 sc1 lds
    buffer_load_dwordx4 v3, s[4:7], s54 offen offset:2048 sc1 lds
    buffer_load_dwordx4 v3, s[4:7], s54 offen offset:3072 sc1 lds
    s_add_u32 m0, s41, 155648
    s_add_u32 s54, s39, 147456
    buffer_load_dwordx4 v3, s[4:7], s54 offen offset:0 sc1 lds
    buffer_load_dwordx4 v3, s[4:7], s54 offen offset:1024 sc1 lds
    s_waitcnt vmcnt(17)
    s_barrier
    s_add_u32 m0, s43, 63488
    s_add_u32 s54, s33, 2179072
    buffer_load_dwordx4 v3, s[4:7], s54 offen offset:0 sc1 lds
    buffer_load_dwordx4 v3, s[4:7], s54 offen offset:1024 sc1 lds
    buffer_load_dwordx4 v3, s[4:7], s54 offen offset:2048 sc1 lds
    s_add_u32 m0, s41, 114688
    s_add_u32 s54, s39, 155648
    buffer_load_dwordx4 v3, s[4:7], s54 offen offset:0 sc1 lds
    buffer_load_dwordx4 v3, s[4:7], s54 offen offset:1024 sc1 lds
    s_waitcnt vmcnt(16)
    s_barrier
    s_add_u32 m0, s43, 77824
    s_add_u32 s54, s33, 2293760
    buffer_load_dwordx4 v3, s[4:7], s54 offen offset:0 sc1 lds
    buffer_load_dwordx4 v3, s[4:7], s54 offen offset:1024 sc1 lds
    buffer_load_dwordx4 v3, s[4:7], s54 offen offset:2048 sc1 lds
    buffer_load_dwordx4 v3, s[4:7], s54 offen offset:3072 sc1 lds
    s_add_u32 m0, s41, 122880
    s_add_u32 s54, s39, 163840
    buffer_load_dwordx4 v3, s[4:7], s54 offen offset:0 sc1 lds
    buffer_load_dwordx4 v3, s[4:7], s54 offen offset:1024 sc1 lds
    s_waitcnt vmcnt(17)
    s_barrier
    s_add_u32 m0, s43, 92160
    s_add_u32 s54, s33, 2408448
    buffer_load_dwordx4 v3, s[4:7], s54 offen offset:0 sc1 lds
    buffer_load_dwordx4 v3, s[4:7], s54 offen offset:1024 sc1 lds
    buffer_load_dwordx4 v3, s[4:7], s54 offen offset:2048 sc1 lds
    s_add_u32 m0, s41, 131072
    s_add_u32 s54, s39, 172032
    buffer_load_dwordx4 v3, s[4:7], s54 offen offset:0 sc1 lds
    buffer_load_dwordx4 v3, s[4:7], s54 offen offset:1024 sc1 lds
    s_waitcnt vmcnt(16)
    s_barrier
    s_add_u32 m0, s43, 20480
    s_add_u32 s54, s33, 2523136
    buffer_load_dwordx4 v3, s[4:7], s54 offen offset:0 sc1 lds
    buffer_load_dwordx4 v3, s[4:7], s54 offen offset:1024 sc1 lds
    buffer_load_dwordx4 v3, s[4:7], s54 offen offset:2048 sc1 lds
    buffer_load_dwordx4 v3, s[4:7], s54 offen offset:3072 sc1 lds
    s_add_u32 m0, s41, 139264
    s_add_u32 s54, s39, 180224
    buffer_load_dwordx4 v3, s[4:7], s54 offen offset:0 sc1 lds
    buffer_load_dwordx4 v3, s[4:7], s54 offen offset:1024 sc1 lds
    s_waitcnt vmcnt(17)
    s_barrier
    s_add_u32 m0, s43, 34816
    s_add_u32 s54, s33, 2637824
    buffer_load_dwordx4 v3, s[4:7], s54 offen offset:0 sc1 lds
    buffer_load_dwordx4 v3, s[4:7], s54 offen offset:1024 sc1 lds
    buffer_load_dwordx4 v3, s[4:7], s54 offen offset:2048 sc1 lds
    s_add_u32 m0, s41, 147456
    s_add_u32 s54, s39, 188416
    buffer_load_dwordx4 v3, s[4:7], s54 offen offset:0 sc1 lds
    buffer_load_dwordx4 v3, s[4:7], s54 offen offset:1024 sc1 lds
    s_waitcnt vmcnt(16)
    s_barrier
    s_add_u32 m0, s43, 49152
    s_add_u32 s54, s33, 2752512
    buffer_load_dwordx4 v3, s[4:7], s54 offen offset:0 sc1 lds
    buffer_load_dwordx4 v3, s[4:7], s54 offen offset:1024 sc1 lds
    buffer_load_dwordx4 v3, s[4:7], s54 offen offset:2048 sc1 lds
    buffer_load_dwordx4 v3, s[4:7], s54 offen offset:3072 sc1 lds
    s_add_u32 m0, s41, 155648
    s_add_u32 s54, s39, 196608
    buffer_load_dwordx4 v3, s[4:7], s54 offen offset:0 sc1 lds
    buffer_load_dwordx4 v3, s[4:7], s54 offen offset:1024 sc1 lds
    s_waitcnt vmcnt(17)
    s_barrier
    s_add_u32 m0, s43, 63488
    s_add_u32 s54, s33, 2867200
    buffer_load_dwordx4 v3, s[4:7], s54 offen offset:0 sc1 lds
    buffer_load_dwordx4 v3, s[4:7], s54 offen offset:1024 sc1 lds
    buffer_load_dwordx4 v3, s[4:7], s54 offen offset:2048 sc1 lds
    s_add_u32 m0, s41, 114688
    s_add_u32 s54, s39, 204800
    buffer_load_dwordx4 v3, s[4:7], s54 offen offset:0 sc1 lds
    buffer_load_dwordx4 v3, s[4:7], s54 offen offset:1024 sc1 lds
    s_waitcnt vmcnt(16)
    s_barrier
    s_add_u32 m0, s43, 77824
    s_add_u32 s54, s33, 2981888
    buffer_load_dwordx4 v3, s[4:7], s54 offen offset:0 sc1 lds
    buffer_load_dwordx4 v3, s[4:7], s54 offen offset:1024 sc1 lds
    buffer_load_dwordx4 v3, s[4:7], s54 offen offset:2048 sc1 lds
    buffer_load_dwordx4 v3, s[4:7], s54 offen offset:3072 sc1 lds
    s_add_u32 m0, s41, 122880
    s_add_u32 s54, s39, 212992
    buffer_load_dwordx4 v3, s[4:7], s54 offen offset:0 sc1 lds
    buffer_load_dwordx4 v3, s[4:7], s54 offen offset:1024 sc1 lds
    s_waitcnt vmcnt(17)
    s_barrier
    s_add_u32 m0, s43, 92160
    s_add_u32 s54, s33, 3096576
    buffer_load_dwordx4 v3, s[4:7], s54 offen offset:0 sc1 lds
    buffer_load_dwordx4 v3, s[4:7], s54 offen offset:1024 sc1 lds
    buffer_load_dwordx4 v3, s[4:7], s54 offen offset:2048 sc1 lds
    s_add_u32 m0, s41, 131072
    s_add_u32 s54, s39, 221184
    buffer_load_dwordx4 v3, s[4:7], s54 offen offset:0 sc1 lds
    buffer_load_dwordx4 v3, s[4:7], s54 offen offset:1024 sc1 lds
    s_waitcnt vmcnt(16)
    s_barrier
    s_add_u32 m0, s43, 20480
    s_add_u32 s54, s33, 3211264
    buffer_load_dwordx4 v3, s[4:7], s54 offen offset:0 sc1 lds
    buffer_load_dwordx4 v3, s[4:7], s54 offen offset:1024 sc1 lds
    buffer_load_dwordx4 v3, s[4:7], s54 offen offset:2048 sc1 lds
    buffer_load_dwordx4 v3, s[4:7], s54 offen offset:3072 sc1 lds
    s_add_u32 m0, s41, 139264
    s_add_u32 s54, s39, 229376
    buffer_load_dwordx4 v3, s[4:7], s54 offen offset:0 sc1 lds
    buffer_load_dwordx4 v3, s[4:7], s54 offen offset:1024 sc1 lds
    s_waitcnt vmcnt(17)
    s_barrier
    s_add_u32 m0, s43, 34816
    s_add_u32 s54, s33, 3325952
    buffer_load_dwordx4 v3, s[4:7], s54 offen offset:0 sc1 lds
    buffer_load_dwordx4 v3, s[4:7], s54 offen offset:1024 sc1 lds
    buffer_load_dwordx4 v3, s[4:7], s54 offen offset:2048 sc1 lds
    s_add_u32 m0, s41, 147456
    s_add_u32 s54, s39, 237568
    buffer_load_dwordx4 v3, s[4:7], s54 offen offset:0 sc1 lds
    buffer_load_dwordx4 v3, s[4:7], s54 offen offset:1024 sc1 lds
    s_waitcnt vmcnt(16)
    s_barrier
    s_add_u32 m0, s43, 49152
    s_add_u32 s54, s33, 3440640
    buffer_load_dwordx4 v3, s[4:7], s54 offen offset:0 sc1 lds
    buffer_load_dwordx4 v3, s[4:7], s54 offen offset:1024 sc1 lds
    buffer_load_dwordx4 v3, s[4:7], s54 offen offset:2048 sc1 lds
    buffer_load_dwordx4 v3, s[4:7], s54 offen offset:3072 sc1 lds
    s_add_u32 m0, s41, 155648
    s_add_u32 s54, s39, 245760
    buffer_load_dwordx4 v3, s[4:7], s54 offen offset:0 sc1 lds
    buffer_load_dwordx4 v3, s[4:7], s54 offen offset:1024 sc1 lds
    s_waitcnt vmcnt(17)
    s_barrier
    s_add_u32 m0, s43, 63488
    s_add_u32 s54, s33, 3555328
    buffer_load_dwordx4 v3, s[4:7], s54 offen offset:0 sc1 lds
    buffer_load_dwordx4 v3, s[4:7], s54 offen offset:1024 sc1 lds
    buffer_load_dwordx4 v3, s[4:7], s54 offen offset:2048 sc1 lds
    s_add_u32 m0, s41, 114688
    s_add_u32 s54, s39, 253952
    buffer_load_dwordx4 v3, s[4:7], s54 offen offset:0 sc1 lds
    buffer_load_dwordx4 v3, s[4:7], s54 offen offset:1024 sc1 lds
    s_waitcnt vmcnt(16)
    s_barrier
    s_add_u32 m0, s42, 81920
    s_add_u32 s54, s40, 0
    buffer_load_dwordx4 v3, s[4:7], s54 offen offset:0 lds
    buffer_load_dwordx4 v3, s[4:7], s54 offen offset:1024 lds
    s_waitcnt vmcnt(13)
    s_barrier
    s_add_u32 m0, s42, 92160
    s_add_u32 s54, s40, 10240
    buffer_load_dwordx4 v3, s[4:7], s54 offen offset:0 lds
    buffer_load_dwordx4 v3, s[4:7], s54 offen offset:1024 lds
    s_add_u32 m0, s42, 102400
    s_add_u32 s54, s40, 20480
    buffer_load_dwordx4 v3, s[4:7], s54 offen offset:0 lds
    buffer_load_dwordx4 v3, s[4:7], s54 offen offset:1024 lds
    s_waitcnt vmcnt(11)
    s_barrier
    s_waitcnt vmcnt(6)
    s_barrier
    s_barrier
    s_barrier
    s_add_u32 m0, s42, 112640
    s_add_u32 s54, s40, 30720
    buffer_load_dwordx4 v3, s[4:7], s54 offen offset:0 lds
    buffer_load_dwordx4 v3, s[4:7], s54 offen offset:1024 lds
    s_add_u32 m0, s42, 122880
    s_add_u32 s54, s40, 40960
    buffer_load_dwordx4 v3, s[4:7], s54 offen offset:0 lds
    buffer_load_dwordx4 v3, s[4:7], s54 offen offset:1024 lds
    s_add_u32 m0, s42, 133120
    s_add_u32 s54, s40, 51200
    buffer_load_dwordx4 v3, s[4:7], s54 offen offset:0 lds
    buffer_load_dwordx4 v3, s[4:7], s54 offen offset:1024 lds
    s_add_u32 m0, s42, 143360
    s_add_u32 s54, s40, 61440
    buffer_load_dwordx4 v3, s[4:7], s54 offen offset:0 lds
    buffer_load_dwordx4 v3, s[4:7], s54 offen offset:1024 lds
    s_add_u32 m0, s42, 153600
    s_add_u32 s54, s40, 71680
    buffer_load_dwordx4 v3, s[4:7], s54 offen offset:0 lds
    buffer_load_dwordx4 v3, s[4:7], s54 offen offset:1024 lds
    s_barrier
    s_add_u32 m0, s41, 20480
    s_add_u32 s54, s34, 0
    buffer_load_dwordx4 v3, s[4:7], s54 offen offset:0 sc1 lds
    buffer_load_dwordx4 v3, s[4:7], s54 offen offset:1024 sc1 lds
    s_add_u32 m0, s41, 28672
    s_add_u32 s54, s34, 262144
    buffer_load_dwordx4 v3, s[4:7], s54 offen offset:0 sc1 lds
    buffer_load_dwordx4 v3, s[4:7], s54 offen offset:1024 sc1 lds
    s_add_u32 m0, s41, 36864
    s_add_u32 s54, s34, 524288
    buffer_load_dwordx4 v3, s[4:7], s54 offen offset:0 sc1 lds
    buffer_load_dwordx4 v3, s[4:7], s54 offen offset:1024 sc1 lds
    s_add_u32 m0, s41, 45056
    s_add_u32 s54, s34, 786432
    buffer_load_dwordx4 v3, s[4:7], s54 offen offset:0 sc1 lds
    buffer_load_dwordx4 v3, s[4:7], s54 offen offset:1024 sc1 lds
    s_add_u32 m0, s41, 53248
    s_add_u32 s54, s34, 1048576
    buffer_load_dwordx4 v3, s[4:7], s54 offen offset:0 sc1 lds
    buffer_load_dwordx4 v3, s[4:7], s54 offen offset:1024 sc1 lds
    s_add_u32 m0, s41, 61440
    s_add_u32 s54, s34, 1310720
    buffer_load_dwordx4 v3, s[4:7], s54 offen offset:0 sc1 lds
    buffer_load_dwordx4 v3, s[4:7], s54 offen offset:1024 sc1 lds
    s_add_u32 m0, s41, 69632
    s_add_u32 s54, s34, 1572864
    buffer_load_dwordx4 v3, s[4:7], s54 offen offset:0 sc1 lds
    buffer_load_dwordx4 v3, s[4:7], s54 offen offset:1024 sc1 lds
    s_waitcnt vmcnt(12)
    s_barrier
    s_waitcnt vmcnt(10)
    s_barrier
    s_waitcnt vmcnt(8)
    s_barrier
    s_add_u32 m0, s41, 20480
    s_add_u32 s54, s34, 1835008
    buffer_load_dwordx4 v3, s[4:7], s54 offen offset:0 sc1 lds
    buffer_load_dwordx4 v3, s[4:7], s54 offen offset:1024 sc1 lds
    s_add_u32 m0, s42, 81920
    s_add_u32 s54, s40, 81920
    buffer_load_dwordx4 v3, s[4:7], s54 offen offset:0 lds
    buffer_load_dwordx4 v3, s[4:7], s54 offen offset:1024 lds
    s_waitcnt vmcnt(10)
    s_barrier
    s_add_u32 m0, s41, 28672
    s_add_u32 s54, s34, 2097152
    buffer_load_dwordx4 v3, s[4:7], s54 offen offset:0 sc1 lds
    buffer_load_dwordx4 v3, s[4:7], s54 offen offset:1024 sc1 lds
    s_add_u32 m0, s42, 92160
    s_add_u32 s54, s40, 92160
    buffer_load_dwordx4 v3, s[4:7], s54 offen offset:0 lds
    buffer_load_dwordx4 v3, s[4:7], s54 offen offset:1024 lds
    s_waitcnt vmcnt(12)
    s_barrier
    s_add_u32 m0, s41, 36864
    s_add_u32 s54, s34, 2359296
    buffer_load_dwordx4 v3, s[4:7], s54 offen offset:0 sc1 lds
    buffer_load_dwordx4 v3, s[4:7], s54 offen offset:1024 sc1 lds
    s_add_u32 m0, s42, 102400
    s_add_u32 s54, s40, 102400
    buffer_load_dwordx4 v3, s[4:7], s54 offen offset:0 lds
    buffer_load_dwordx4 v3, s[4:7], s54 offen offset:1024 lds
    s_waitcnt vmcnt(14)
    s_barrier
    s_add_u32 m0, s41, 45056
    s_add_u32 s54, s34, 2621440
    buffer_load_dwordx4 v3, s[4:7], s54 offen offset:0 sc1 lds
    buffer_load_dwordx4 v3, s[4:7], s54 offen offset:1024 sc1 lds
    s_add_u32 m0, s42, 112640
    s_add_u32 s54, s40, 112640
    buffer_load_dwordx4 v3, s[4:7], s54 offen offset:0 lds
    buffer_load_dwordx4 v3, s[4:7], s54 offen offset:1024 lds
    s_waitcnt vmcnt(16)
    s_barrier
    s_add_u32 m0, s41, 53248
    s_add_u32 s54, s34, 2883584
    buffer_load_dwordx4 v3, s[4:7], s54 offen offset:0 sc1 lds
    buffer_load_dwordx4 v3, s[4:7], s54 offen offset:1024 sc1 lds
    s_add_u32 m0, s42, 122880
    s_add_u32 s54, s40, 122880
    buffer_load_dwordx4 v3, s[4:7], s54 offen offset:0 lds
    buffer_load_dwordx4 v3, s[4:7], s54 offen offset:1024 lds
    s_waitcnt vmcnt(18)
    s_barrier
    s_add_u32 m0, s41, 61440
    s_add_u32 s54, s34, 3145728
    buffer_load_dwordx4 v3, s[4:7], s54 offen offset:0 sc1 lds
    buffer_load_dwordx4 v3, s[4:7], s54 offen offset:1024 sc1 lds
    s_add_u32 m0, s42, 133120
    s_add_u32 s54, s40, 133120
    s_mul_i32 s55, s19, 5120
    s_sub_u32 s54, s54, s55
    buffer_load_dwordx4 v3, s[4:7], s54 offen offset:0 lds
    buffer_load_dwordx4 v3, s[4:7], s54 offen offset:1024 lds
    s_waitcnt vmcnt(18)
    s_barrier
    s_add_u32 m0, s41, 69632
    s_add_u32 s54, s34, 3407872
    s_mul_i32 s55, s19, 131072
    s_sub_u32 s54, s54, s55
    buffer_load_dwordx4 v3, s[4:7], s54 offen offset:0 sc1 lds
    buffer_load_dwordx4 v3, s[4:7], s54 offen offset:1024 sc1 lds
    s_waitcnt vmcnt(16)
    s_barrier
    s_waitcnt vmcnt(12)
    s_barrier
    s_waitcnt vmcnt(8)
    s_barrier
    s_waitcnt vmcnt(4)
    s_barrier
    s_waitcnt vmcnt(0)
    s_barrier
    s_barrier
    s_cmp_eq_u32 s14, 1
    s_cbranch_scc1 FINL
    s_barrier
    s_cmp_eq_u32 s14, 1
    s_cbranch_scc1 SK_10
    s_add_u32 m0, s44, 131072
    s_add_u32 s54, s35, 0
    buffer_load_dwordx4 v3, s[4:7], s54 offen offset:0 lds
    buffer_load_dwordx4 v3, s[4:7], s54 offen offset:1024 lds
    buffer_load_dwordx4 v3, s[4:7], s54 offen offset:2048 lds
    buffer_load_dwordx4 v3, s[4:7], s54 offen offset:3072 lds
SK_10:
    s_cmp_eq_u32 s14, 1
    s_cbranch_scc1 SK_11
    s_add_u32 m0, s44, 147456
    s_add_u32 s54, s35, 16384
    buffer_load_dwordx4 v3, s[4:7], s54 offen offset:0 lds
    buffer_load_dwordx4 v3, s[4:7], s54 offen offset:1024 lds
    buffer_load_dwordx4 v3, s[4:7], s54 offen offset:2048 lds
    buffer_load_dwordx4 v3, s[4:7], s54 offen offset:3072 lds
SK_11:
    s_cmp_eq_u32 s14, 1
    s_cbranch_scc1 SK_12
    s_add_u32 m0, s44, 98304
    s_add_u32 s54, s35, 32768
    buffer_load_dwordx4 v3, s[4:7], s54 offen offset:0 lds
    buffer_load_dwordx4 v3, s[4:7], s54 offen offset:1024 lds
    buffer_load_dwordx4 v3, s[4:7], s54 offen offset:2048 lds
    buffer_load_dwordx4 v3, s[4:7], s54 offen offset:3072 lds
SK_12:
    s_cmp_eq_u32 s14, 1
    s_cbranch_scc1 SK_13
    s_add_u32 m0, s44, 114688
    s_add_u32 s54, s35, 49152
    buffer_load_dwordx4 v3, s[4:7], s54 offen offset:0 lds
    buffer_load_dwordx4 v3, s[4:7], s54 offen offset:1024 lds
    buffer_load_dwordx4 v3, s[4:7], s54 offen offset:2048 lds
    buffer_load_dwordx4 v3, s[4:7], s54 offen offset:3072 lds
SK_13:
    s_barrier
    s_cmp_eq_u32 s14, 1
    s_cbranch_scc1 FINL
    s_mov_b32 s14, 1
    s_add_u32 s47, s47, 19677184
    s_add_u32 s12, s12, 19677184
    s_add_u32 s52, s52, 32768
    s_add_u32 s30, s30, 19677184
    s_add_u32 s31, s31, 19677184
    s_add_u32 s32, s32, 19677184
    s_add_u32 s33, s33, 19677184
    s_add_u32 s34, s34, 19677184
    s_branch LDA_loop
LDB:
    s_and_b32 s19, s13, 1
    s_mul_i32 s41, s19, 4096
    s_mul_i32 s42, s19, 5120
    s_mul_i32 s43, s19, 7168
    s_mul_i32 s44, s19, 8192
    s_mul_i32 s45, s19, 9216
    s_cmp_eq_u32 s48, 0
    s_cselect_b32 s56, 0, 1024
    v_and_b32 v9, 0xffffff7f, v3
    s_and_b32 s66, s51, 3
    s_cmp_eq_u32 s66, 3
    s_cselect_b32 s66, 1024, 0
    s_mul_i32 s35, s49, 163840
    s_add_u32 s35, s35, 0
    s_mul_i32 s46, s19, 8192
    s_add_u32 s35, s35, s46
    s_add_u32 m0, s44, 135168
    s_add_u32 s54, s35, 4096
    buffer_load_dwordx4 v3, s[4:7], s54 offen offset:0 lds
    buffer_load_dwordx4 v3, s[4:7], s54 offen offset:1024 lds
    buffer_load_dwordx4 v3, s[4:7], s54 offen offset:2048 lds
    buffer_load_dwordx4 v9, s[4:7], s54 offen offset:3072 lds
    s_add_u32 m0, s44, 151552
    s_add_u32 s54, s35, 20480
    buffer_load_dwordx4 v3, s[4:7], s54 offen offset:0 lds
    buffer_load_dwordx4 v3, s[4:7], s54 offen offset:1024 lds
    buffer_load_dwordx4 v3, s[4:7], s54 offen offset:2048 lds
    buffer_load_dwordx4 v9, s[4:7], s54 offen offset:3072 lds
    s_add_u32 m0, s44, 102400
    s_add_u32 s54, s35, 36864
    buffer_load_dwordx4 v3, s[4:7], s54 offen offset:0 lds
    buffer_load_dwordx4 v3, s[4:7], s54 offen offset:1024 lds
    buffer_load_dwordx4 v3, s[4:7], s54 offen offset:2048 lds
    buffer_load_dwordx4 v9, s[4:7], s54 offen offset:3072 lds
    s_add_u32 m0, s44, 118784
    s_add_u32 s54, s35, 53248
    buffer_load_dwordx4 v3, s[4:7], s54 offen offset:0 lds
    buffer_load_dwordx4 v3, s[4:7], s54 offen offset:1024 lds
    buffer_load_dwordx4 v3, s[4:7], s54 offen offset:2048 lds
    buffer_load_dwordx4 v9, s[4:7], s54 offen offset:3072 lds
    s_lshl_b32 s30, s48, 13
    s_add_u32 s30, s30, 0
    s_mul_i32 s46, s19, 131072
    s_add_u32 s30, s30, s46
    s_add_u32 s30, s30, s12
    s_lshl_b32 s31, s50, 12
    s_add_u32 s31, s31, 2752512
    s_mul_i32 s46, s19, 131072
    s_add_u32 s31, s31, s46
    s_add_u32 s31, s31, s12
    s_lshl_b32 s32, s50, 12
    s_add_u32 s32, s32, 5373952
    s_mul_i32 s46, s19, 131072
    s_add_u32 s32, s32, s46
    s_add_u32 s32, s32, s12
    s_mul_i32 s33, s51, 7168
    s_add_u32 s33, s33, 12320768
    s_mul_i32 s46, s19, 57344
    s_add_u32 s33, s33, s46
    s_add_u32 s33, s33, s12
    s_lshl_b32 s34, s50, 12
    s_add_u32 s34, s34, 16007168
    s_mul_i32 s46, s19, 131072
    s_add_u32 s34, s34, s46
    s_add_u32 s34, s34, s12
    s_mul_i32 s36, s51, 102400
    s_add_u32 s36, s36, 2621440
    s_mul_i32 s46, s19, 5120
    s_add_u32 s36, s36, s46
    s_mul_i32 s37, s51, 143360
    s_add_u32 s37, s37, 4587520
    s_mul_i32 s46, s19, 7168
    s_add_u32 s37, s37, s46
    s_mul_i32 s38, s51, 143360
    s_add_u32 s38, s38, 3440640
    s_mul_i32 s46, s19, 7168
    s_add_u32 s38, s38, s46
    s_lshl_b32 s39, s50, 18
    s_add_u32 s39, s39, 6950912
    s_mul_i32 s46, s19, 4096
    s_add_u32 s39, s39, s46
    s_mul_i32 s40, s51, 138240
    s_add_u32 s40, s40, 5734400
    s_mul_i32 s46, s19, 5120
    s_add_u32 s40, s40, s46
    v_and_b32 v20, 31, v0
    v_lshlrev_b32 v20, 7, v20
    v_add_u32 v20, 6144, v20
    v_mov_b32 v13, 1
    v_min_u32 v21, 2, v0
    s_lshl_b32 s46, s48, 1
    v_add_u32 v21, s46, v21
    v_max_u32 v21, 1, v21
    v_lshlrev_b32 v21, 7, v21
    v_add_u32 v21, 6895488, v21
    v_bfe_u32 v18, v0, 1, 2
    v_lshlrev_b32 v17, 4, v18
    v_bfe_u32 v18, v0, 3, 1
    v_lshl_add_u32 v17, v18, 3, v17
    v_and_b32 v18, 1, v0
    v_lshl_add_u32 v17, v18, 2, v17
    s_sub_u32 s46, s13, 4
    s_lshl_b32 s47, s46, 10
    s_add_u32 s47, s47, 31330304
    s_lshl_b32 s54, s46, 2
    v_add_u32 v18, s54, v1
    v_lshl_add_u32 v16, v18, 6, v17
    v_lshl_add_u32 v17, v18, 7, v17
    s_mov_b32 s8, s20
    s_and_b32 s9, s21, 0xffff
    s_mov_b32 s10, 8388608
    s_mov_b32 s11, 0x00020000
    v_lshrrev_b32 v10, 3, v0
    v_and_b32 v7, 7, v0
    v_lshlrev_b32 v7, 4, v7
    v_lshl_add_u32 v4, v10, 12, v7
    v_lshlrev_b32 v5, 4, v10
    v_and_b32 v11, 1, v0
    v_lshl_add_u32 v5, v11, 9, v5
    v_and_b32 v11, 4, v0
    v_lshl_add_u32 v5, v11, 10, v5
    v_and_b32 v11, 2, v0
    v_lshl_add_u32 v5, v11, 2, v5
    s_lshl_b32 s57, s50, 18
    s_lshl_b32 s54, s46, 13
    s_add_u32 s59, s57, s54
    s_lshr_b32 s54, s51, 1
    s_lshl_b32 s54, s54, 10
    s_add_u32 s59, s59, s54
    s_and_b32 s54, s51, 1
    s_lshl_b32 s54, s54, 7
    s_add_u32 s59, s59, s54
    s_add_u32 s59, s59, 6950912
    s_lshl_b32 s54, s46, 7
    s_add_u32 s57, s57, s54
    s_lshl_b32 s54, s51, 15
    s_add_u32 s57, s57, s54
    s_mov_b32 s67, 0x4280
    s_mov_b32 s68, 0x42800000
    v_lshlrev_b32 v6, 15, v1
    v_lshl_add_u32 v6, v2, 3, v6
    s_lshl_b32 s54, s46, 6
    v_lshlrev_b32 v18, 2, v2
    v_add_u32 v18, s54, v18
    v_and_b32 v7, 1, v1
    v_lshl_add_u32 v7, v7, 8, v18
    v_lshlrev_b32 v10, 2, v2
    v_add_u32 v10, 512, v10
    v_cmp_eq_u32 vcc, 2, v1
    s_nop 1
    v_cndmask_b32 v7, v7, v10, vcc
    s_lshl_b32 s71, s48, 10
    s_lshl_b32 s54, s46, 7
    s_add_u32 s69, s71, s54
    s_add_u32 s70, s69, 2621824
    s_max_u32 s69, s69, 128
    s_add_u32 s69, s69, 2621312
    s_add_u32 s71, s71, 2622336
    s_lshl_b32 s58, s50, 9
    s_add_u32 s58, s58, s54
    s_add_u32 s58, s58, 7995392
LDB_loop:
    s_add_u32 m0, s45, 44032
    s_add_u32 s54, s30, 4096
    buffer_load_dwordx4 v3, s[4:7], s54 offen offset:0 sc1 lds
    buffer_load_dwordx4 v3, s[4:7], s54 offen offset:1024 sc1 lds
    buffer_load_dwordx4 v3, s[4:7], s54 offen offset:2048 sc1 lds
    buffer_load_dwordx4 v3, s[4:7], s54 offen offset:3072 sc1 lds
    s_add_u32 m0, s45, 62464
    s_add_u32 s54, s30, 266240
    buffer_load_dwordx4 v3, s[4:7], s54 offen offset:0 sc1 lds
    buffer_load_dwordx4 v3, s[4:7], s54 offen offset:1024 sc1 lds
    buffer_load_dwordx4 v3, s[4:7], s54 offen offset:2048 sc1 lds
    buffer_load_dwordx4 v3, s[4:7], s54 offen offset:3072 sc1 lds
    s_add_u32 m0, s45, 80896
    s_add_u32 s54, s30, 528384
    buffer_load_dwordx4 v3, s[4:7], s54 offen offset:0 sc1 lds
    buffer_load_dwordx4 v3, s[4:7], s54 offen offset:1024 sc1 lds
    buffer_load_dwordx4 v3, s[4:7], s54 offen offset:2048 sc1 lds
    buffer_load_dwordx4 v3, s[4:7], s54 offen offset:3072 sc1 lds
    s_add_u32 m0, s45, 25600
    s_add_u32 s54, s30, 790528
    buffer_load_dwordx4 v3, s[4:7], s54 offen offset:0 sc1 lds
    buffer_load_dwordx4 v3, s[4:7], s54 offen offset:1024 sc1 lds
    buffer_load_dwordx4 v3, s[4:7], s54 offen offset:2048 sc1 lds
    buffer_load_dwordx4 v3, s[4:7], s54 offen offset:3072 sc1 lds
    s_waitcnt vmcnt(12)
    s_barrier
    s_cmp_eq_u32 s14, 1
    s_cbranch_scc1 WLB0
    buffer_load_dwordx4 v[64:67], v4, s[8:11], s57 offen offset:0
    buffer_load_dwordx4 v[68:71], v4, s[8:11], s57 offen offset:512
    buffer_load_dwordx4 v[72:75], v4, s[8:11], s57 offen offset:1024
    buffer_load_dwordx4 v[76:79], v4, s[8:11], s57 offen offset:1536
    buffer_load_dwordx4 v[80:83], v4, s[8:11], s57 offen offset:2048
    buffer_load_dwordx4 v[84:87], v4, s[8:11], s57 offen offset:2560
    buffer_load_dwordx4 v[88:91], v4, s[8:11], s57 offen offset:3072
    buffer_load_dwordx4 v[92:95], v4, s[8:11], s57 offen offset:3584
WLB0:
    s_cmp_eq_u32 s14, 0
    s_cbranch_scc1 WW_14
    s_waitcnt vmcnt(8)
WW_14:
    s_waitcnt vmcnt(16)
    s_barrier
    s_add_u32 m0, s45, 44032
    s_add_u32 s54, s30, 1052672
    buffer_load_dwordx4 v3, s[4:7], s54 offen offset:0 sc1 lds
    buffer_load_dwordx4 v3, s[4:7], s54 offen offset:1024 sc1 lds
    buffer_load_dwordx4 v3, s[4:7], s54 offen offset:2048 sc1 lds
    buffer_load_dwordx4 v3, s[4:7], s54 offen offset:3072 sc1 lds
    s_add_u32 m0, s44, 135168
    s_add_u32 s54, s35, 69632
    buffer_load_dwordx4 v3, s[4:7], s54 offen offset:0 lds
    buffer_load_dwordx4 v3, s[4:7], s54 offen offset:1024 lds
    buffer_load_dwordx4 v3, s[4:7], s54 offen offset:2048 lds
    buffer_load_dwordx4 v9, s[4:7], s54 offen offset:3072 lds
    s_cmp_eq_u32 s14, 0
    s_cbranch_scc1 WW_15
    s_waitcnt vmcnt(12)
WW_15:
    s_waitcnt vmcnt(20)
    s_barrier
    s_add_u32 m0, s45, 62464
    s_add_u32 s54, s30, 1314816
    buffer_load_dwordx4 v3, s[4:7], s54 offen offset:0 sc1 lds
    buffer_load_dwordx4 v3, s[4:7], s54 offen offset:1024 sc1 lds
    buffer_load_dwordx4 v3, s[4:7], s54 offen offset:2048 sc1 lds
    buffer_load_dwordx4 v3, s[4:7], s54 offen offset:3072 sc1 lds
    s_add_u32 m0, s44, 151552
    s_add_u32 s54, s35, 86016
    buffer_load_dwordx4 v3, s[4:7], s54 offen offset:0 lds
    buffer_load_dwordx4 v3, s[4:7], s54 offen offset:1024 lds
    buffer_load_dwordx4 v3, s[4:7], s54 offen offset:2048 lds
    buffer_load_dwordx4 v9, s[4:7], s54 offen offset:3072 lds
    s_cmp_eq_u32 s14, 0
    s_cbranch_scc1 WW_16
    s_waitcnt vmcnt(16)
WW_16:
    s_waitcnt vmcnt(24)
    s_barrier
    s_add_u32 m0, s45, 80896
    s_add_u32 s54, s30, 1576960
    buffer_load_dwordx4 v3, s[4:7], s54 offen offset:0 sc1 lds
    buffer_load_dwordx4 v3, s[4:7], s54 offen offset:1024 sc1 lds
    buffer_load_dwordx4 v3, s[4:7], s54 offen offset:2048 sc1 lds
    buffer_load_dwordx4 v3, s[4:7], s54 offen offset:3072 sc1 lds
    s_add_u32 m0, s44, 102400
    s_add_u32 s54, s35, 102400
    buffer_load_dwordx4 v3, s[4:7], s54 offen offset:0 lds
    buffer_load_dwordx4 v3, s[4:7], s54 offen offset:1024 lds
    buffer_load_dwordx4 v3, s[4:7], s54 offen offset:2048 lds
    buffer_load_dwordx4 v9, s[4:7], s54 offen offset:3072 lds
    s_waitcnt vmcnt(16)
    s_barrier
    s_add_u32 m0, s45, 25600
    s_add_u32 s54, s30, 1839104
    buffer_load_dwordx4 v3, s[4:7], s54 offen offset:0 sc1 lds
    buffer_load_dwordx4 v3, s[4:7], s54 offen offset:1024 sc1 lds
    buffer_load_dwordx4 v3, s[4:7], s54 offen offset:2048 sc1 lds
    buffer_load_dwordx4 v3, s[4:7], s54 offen offset:3072 sc1 lds
    s_add_u32 m0, s44, 118784
    s_add_u32 s54, s35, 118784
    buffer_load_dwordx4 v3, s[4:7], s54 offen offset:0 lds
    buffer_load_dwordx4 v3, s[4:7], s54 offen offset:1024 lds
    buffer_load_dwordx4 v3, s[4:7], s54 offen offset:2048 lds
    buffer_load_dwordx4 v9, s[4:7], s54 offen offset:3072 lds
    s_waitcnt vmcnt(16)
    s_barrier
    s_add_u32 m0, s45, 44032
    s_add_u32 s54, s30, 2101248
    buffer_load_dwordx4 v3, s[4:7], s54 offen offset:0 sc1 lds
    buffer_load_dwordx4 v3, s[4:7], s54 offen offset:1024 sc1 lds
    buffer_load_dwordx4 v3, s[4:7], s54 offen offset:2048 sc1 lds
    buffer_load_dwordx4 v3, s[4:7], s54 offen offset:3072 sc1 lds
    s_add_u32 m0, s44, 135168
    s_add_u32 s54, s35, 135168
    buffer_load_dwordx4 v3, s[4:7], s54 offen offset:0 lds
    buffer_load_dwordx4 v3, s[4:7], s54 offen offset:1024 lds
    buffer_load_dwordx4 v3, s[4:7], s54 offen offset:2048 lds
    buffer_load_dwordx4 v9, s[4:7], s54 offen offset:3072 lds
    s_add_u32 s54, s12, s69
    s_add_u32 s55, s54, 16384
    buffer_load_dwordx2 v[40:41], v6, s[4:7], s54 offen sc1
    buffer_load_dwordx2 v[42:43], v6, s[4:7], s55 offen sc1
    s_add_u32 s54, s12, s70
    s_add_u32 s55, s54, 16384
    buffer_load_dwordx2 v[44:45], v6, s[4:7], s54 offen sc1
    buffer_load_dwordx2 v[46:47], v6, s[4:7], s55 offen sc1
    s_add_u32 s54, s12, s71
    s_add_u32 s55, s54, 16384
    buffer_load_dwordx2 v[48:49], v6, s[4:7], s54 offen sc1
    buffer_load_dwordx2 v[50:51], v6, s[4:7], s55 offen sc1
    s_waitcnt vmcnt(22)
    s_barrier
    s_add_u32 m0, s45, 62464
    s_add_u32 s54, s30, 2363392
    buffer_load_dwordx4 v3, s[4:7], s54 offen offset:0 sc1 lds
    buffer_load_dwordx4 v3, s[4:7], s54 offen offset:1024 sc1 lds
    buffer_load_dwordx4 v3, s[4:7], s54 offen offset:2048 sc1 lds
    buffer_load_dwordx4 v3, s[4:7], s54 offen offset:3072 sc1 lds
    s_add_u32 m0, s44, 151552
    s_add_u32 s54, s35, 151552
    buffer_load_dwordx4 v3, s[4:7], s54 offen offset:0 lds
    buffer_load_dwordx4 v3, s[4:7], s54 offen offset:1024 lds
    buffer_load_dwordx4 v3, s[4:7], s54 offen offset:2048 lds
    buffer_load_dwordx4 v9, s[4:7], s54 offen offset:3072 lds
    s_cmp_eq_u32 s14, 1
    s_cbranch_scc1 WCB0
    s_waitcnt vmcnt(61)
    v_dot2_f32_bf16 v96, v64, s67, 0
    v_dot2_f32_bf16 v97, v64, s68, 0
    v_dot2_f32_bf16 v98, v65, s67, 0
    v_dot2_f32_bf16 v99, v65, s68, 0
    v_dot2_f32_bf16 v100, v66, s67, 0
    v_dot2_f32_bf16 v101, v66, s68, 0
    v_dot2_f32_bf16 v102, v67, s67, 0
    v_dot2_f32_bf16 v103, v67, s68, 0
    v_cvt_pk_f16_f32 v64, v96, v97
    v_cvt_pk_f16_f32 v65, v98, v99
    v_cvt_pk_f16_f32 v66, v100, v101
    v_cvt_pk_f16_f32 v67, v102, v103
    s_add_u32 s54, s59, 0
    buffer_store_dwordx2 v[64:65], v5, s[4:7], s54 offen offset:0 sc1
    buffer_store_dwordx2 v[66:67], v5, s[4:7], s54 offen offset:256 sc1
    s_waitcnt vmcnt(60)
    v_dot2_f32_bf16 v104, v68, s67, 0
    v_dot2_f32_bf16 v105, v68, s68, 0
    v_dot2_f32_bf16 v106, v69, s67, 0
    v_dot2_f32_bf16 v107, v69, s68, 0
    v_dot2_f32_bf16 v108, v70, s67, 0
    v_dot2_f32_bf16 v109, v70, s68, 0
    v_dot2_f32_bf16 v110, v71, s67, 0
    v_dot2_f32_bf16 v111, v71, s68, 0
    v_cvt_pk_f16_f32 v68, v104, v105
    v_cvt_pk_f16_f32 v69, v106, v107
    v_cvt_pk_f16_f32 v70, v108, v109
    v_cvt_pk_f16_f32 v71, v110, v111
    s_add_u32 s54, s59, 32768
    buffer_store_dwordx2 v[68:69], v5, s[4:7], s54 offen offset:0 sc1
    buffer_store_dwordx2 v[70:71], v5, s[4:7], s54 offen offset:256 sc1
WCB0:
    s_waitcnt vmcnt(22)
    s_barrier
    s_add_u32 m0, s42, 83968
    s_add_u32 s54, s36, 2048
    buffer_load_dwordx4 v3, s[4:7], s54 offen offset:0 lds
    buffer_load_dwordx4 v3, s[4:7], s54 offen offset:1024 lds
    buffer_load_dwordx4 v3, s[4:7], s54 offen offset:2048 lds
    s_add_u32 m0, s42, 94208
    s_add_u32 s54, s36, 12288
    buffer_load_dwordx4 v3, s[4:7], s54 offen offset:0 lds
    buffer_load_dwordx4 v3, s[4:7], s54 offen offset:1024 lds
    buffer_load_dwordx4 v3, s[4:7], s54 offen offset:2048 lds
    s_cmp_eq_u32 s14, 1
    s_cbranch_scc1 WCB2
    s_waitcnt vmcnt(62)
    v_dot2_f32_bf16 v96, v72, s67, 0
    v_dot2_f32_bf16 v97, v72, s68, 0
    v_dot2_f32_bf16 v98, v73, s67, 0
    v_dot2_f32_bf16 v99, v73, s68, 0
    v_dot2_f32_bf16 v100, v74, s67, 0
    v_dot2_f32_bf16 v101, v74, s68, 0
    v_dot2_f32_bf16 v102, v75, s67, 0
    v_dot2_f32_bf16 v103, v75, s68, 0
    v_cvt_pk_f16_f32 v72, v96, v97
    v_cvt_pk_f16_f32 v73, v98, v99
    v_cvt_pk_f16_f32 v74, v100, v101
    v_cvt_pk_f16_f32 v75, v102, v103
    s_add_u32 s54, s59, 65536
    buffer_store_dwordx2 v[72:73], v5, s[4:7], s54 offen offset:0 sc1
    buffer_store_dwordx2 v[74:75], v5, s[4:7], s54 offen offset:256 sc1
    s_waitcnt vmcnt(62)
    v_dot2_f32_bf16 v104, v76, s67, 0
    v_dot2_f32_bf16 v105, v76, s68, 0
    v_dot2_f32_bf16 v106, v77, s67, 0
    v_dot2_f32_bf16 v107, v77, s68, 0
    v_dot2_f32_bf16 v108, v78, s67, 0
    v_dot2_f32_bf16 v109, v78, s68, 0
    v_dot2_f32_bf16 v110, v79, s67, 0
    v_dot2_f32_bf16 v111, v79, s68, 0
    v_cvt_pk_f16_f32 v76, v104, v105
    v_cvt_pk_f16_f32 v77, v106, v107
    v_cvt_pk_f16_f32 v78, v108, v109
    v_cvt_pk_f16_f32 v79, v110, v111
    s_add_u32 s54, s59, 98304
    buffer_store_dwordx2 v[76:77], v5, s[4:7], s54 offen offset:0 sc1
    buffer_store_dwordx2 v[78:79], v5, s[4:7], s54 offen offset:256 sc1
WCB2:
    s_waitcnt vmcnt(20)
    s_barrier
    s_add_u32 m0, s42, 104448
    s_add_u32 s54, s36, 22528
    buffer_load_dwordx4 v3, s[4:7], s54 offen offset:0 lds
    buffer_load_dwordx4 v3, s[4:7], s54 offen offset:1024 lds
    buffer_load_dwordx4 v3, s[4:7], s54 offen offset:2048 lds
    s_add_u32 m0, s42, 114688
    s_add_u32 s54, s36, 32768
    buffer_load_dwordx4 v3, s[4:7], s54 offen offset:0 lds
    buffer_load_dwordx4 v3, s[4:7], s54 offen offset:1024 lds
    buffer_load_dwordx4 v3, s[4:7], s54 offen offset:2048 lds
    s_waitcnt vmcnt(20)
    v_pk_add_f32 v[40:41], v[40:41], v[42:43]
    v_pk_add_f32 v[44:45], v[44:45], v[46:47]
    v_pk_add_f32 v[48:49], v[48:49], v[50:51]
    v_mov_b32 v46, v44
    v_mov_b32 v47, v45
    v_permlane32_swap_b32 v40, v48
    v_permlane32_swap_b32 v41, v49
    v_permlane32_swap_b32 v44, v46
    v_permlane32_swap_b32 v45, v47
    v_pk_add_f32 v[40:41], v[40:41], v[48:49]
    v_pk_add_f32 v[42:43], v[44:45], v[46:47]
    s_nop 1
    v_permlane16_swap_b32 v40, v42
    v_permlane16_swap_b32 v41, v43
    v_pk_add_f32 v[40:41], v[40:41], v[42:43]
    v_mul_f32 v42, 0x3acccccd, v40
    v_mul_f32 v41, 0x3acccccd, v41
    v_fma_f32 v41, -v42, v42, v41
    v_max_f32 v41, 0, v41
    v_add_f32 v41, 0x3727c5ac, v41
    v_rsq_f32 v40, v41
    s_nop 0
    v_mul_f32 v41, -v42, v40
    ds_write2_b32 v7, v40, v41 offset0:0 offset1:192
    s_waitcnt lgkmcnt(0)
    s_waitcnt vmcnt(12)
    s_barrier
    s_add_u32 m0, s42, 124928
    s_add_u32 s54, s36, 43008
    buffer_load_dwordx4 v3, s[4:7], s54 offen offset:0 lds
    buffer_load_dwordx4 v3, s[4:7], s54 offen offset:1024 lds
    buffer_load_dwordx4 v3, s[4:7], s54 offen offset:2048 lds
    s_add_u32 m0, s42, 135168
    s_add_u32 s54, s36, 53248
    buffer_load_dwordx4 v3, s[4:7], s54 offen offset:0 lds
    buffer_load_dwordx4 v3, s[4:7], s54 offen offset:1024 lds
    buffer_load_dwordx4 v3, s[4:7], s54 offen offset:2048 lds
    s_cmp_eq_u32 s14, 1
    s_cbranch_scc1 WCB4
    s_waitcnt vmcnt(62)
    v_dot2_f32_bf16 v96, v80, s67, 0
    v_dot2_f32_bf16 v97, v80, s68, 0
    v_dot2_f32_bf16 v98, v81, s67, 0
    v_dot2_f32_bf16 v99, v81, s68, 0
    v_dot2_f32_bf16 v100, v82, s67, 0
    v_dot2_f32_bf16 v101, v82, s68, 0
    v_dot2_f32_bf16 v102, v83, s67, 0
    v_dot2_f32_bf16 v103, v83, s68, 0
    v_cvt_pk_f16_f32 v80, v96, v97
    v_cvt_pk_f16_f32 v81, v98, v99
    v_cvt_pk_f16_f32 v82, v100, v101
    v_cvt_pk_f16_f32 v83, v102, v103
    s_add_u32 s54, s59, 131072
    buffer_store_dwordx2 v[80:81], v5, s[4:7], s54 offen offset:0 sc1
    buffer_store_dwordx2 v[82:83], v5, s[4:7], s54 offen offset:256 sc1
    s_waitcnt vmcnt(62)
    v_dot2_f32_bf16 v104, v84, s67, 0
    v_dot2_f32_bf16 v105, v84, s68, 0
    v_dot2_f32_bf16 v106, v85, s67, 0
    v_dot2_f32_bf16 v107, v85, s68, 0
    v_dot2_f32_bf16 v108, v86, s67, 0
    v_dot2_f32_bf16 v109, v86, s68, 0
    v_dot2_f32_bf16 v110, v87, s67, 0
    v_dot2_f32_bf16 v111, v87, s68, 0
    v_cvt_pk_f16_f32 v84, v104, v105
    v_cvt_pk_f16_f32 v85, v106, v107
    v_cvt_pk_f16_f32 v86, v108, v109
    v_cvt_pk_f16_f32 v87, v110, v111
    s_add_u32 s54, s59, 163840
    buffer_store_dwordx2 v[84:85], v5, s[4:7], s54 offen offset:0 sc1
    buffer_store_dwordx2 v[86:87], v5, s[4:7], s54 offen offset:256 sc1
WCB4:
    s_barrier
    s_cmp_eq_u32 s14, 1
    s_cbranch_scc1 WCB6
    s_waitcnt vmcnt(62)
    v_dot2_f32_bf16 v96, v88, s67, 0
    v_dot2_f32_bf16 v97, v88, s68, 0
    v_dot2_f32_bf16 v98, v89, s67, 0
    v_dot2_f32_bf16 v99, v89, s68, 0
    v_dot2_f32_bf16 v100, v90, s67, 0
    v_dot2_f32_bf16 v101, v90, s68, 0
    v_dot2_f32_bf16 v102, v91, s67, 0
    v_dot2_f32_bf16 v103, v91, s68, 0
    v_cvt_pk_f16_f32 v88, v96, v97
    v_cvt_pk_f16_f32 v89, v98, v99
    v_cvt_pk_f16_f32 v90, v100, v101
    v_cvt_pk_f16_f32 v91, v102, v103
    s_add_u32 s54, s59, 196608
    buffer_store_dwordx2 v[88:89], v5, s[4:7], s54 offen offset:0 sc1
    buffer_store_dwordx2 v[90:91], v5, s[4:7], s54 offen offset:256 sc1
    s_waitcnt vmcnt(62)
    v_dot2_f32_bf16 v104, v92, s67, 0
    v_dot2_f32_bf16 v105, v92, s68, 0
    v_dot2_f32_bf16 v106, v93, s67, 0
    v_dot2_f32_bf16 v107, v93, s68, 0
    v_dot2_f32_bf16 v108, v94, s67, 0
    v_dot2_f32_bf16 v109, v94, s68, 0
    v_dot2_f32_bf16 v110, v95, s67, 0
    v_dot2_f32_bf16 v111, v95, s68, 0
    v_cvt_pk_f16_f32 v92, v104, v105
    v_cvt_pk_f16_f32 v93, v106, v107
    v_cvt_pk_f16_f32 v94, v108, v109
    v_cvt_pk_f16_f32 v95, v110, v111
    s_add_u32 s54, s59, 229376
    buffer_store_dwordx2 v[92:93], v5, s[4:7], s54 offen offset:0 sc1
    buffer_store_dwordx2 v[94:95], v5, s[4:7], s54 offen offset:256 sc1
WCB6:
    s_barrier
    s_barrier
    s_cmp_lg_u32 s19, 0
    s_cbranch_scc1 SG1
    s_lshl_b32 s54, s48, 7
    s_add_u32 s54, s54, s52
    s_add_u32 s54, s54, 0
    s_mov_b64 exec, 1
    buffer_atomic_add v13, off, s[4:7], s54 sc1
    s_mov_b64 exec, -1
SG1:
    s_add_u32 m0, s42, 145408
    s_add_u32 s54, s36, 63488
    buffer_load_dwordx4 v3, s[4:7], s54 offen offset:0 lds
    buffer_load_dwordx4 v3, s[4:7], s54 offen offset:1024 lds
    buffer_load_dwordx4 v3, s[4:7], s54 offen offset:2048 lds
    s_add_u32 m0, s42, 155648
    s_add_u32 s54, s36, 73728
    buffer_load_dwordx4 v3, s[4:7], s54 offen offset:0 lds
    buffer_load_dwordx4 v3, s[4:7], s54 offen offset:1024 lds
    buffer_load_dwordx4 v3, s[4:7], s54 offen offset:2048 lds
    s_barrier
    s_add_u32 m0, s41, 22528
    s_add_u32 s54, s31, 2048
    buffer_load_dwordx4 v3, s[4:7], s54 offen offset:0 sc1 lds
    buffer_load_dwordx4 v3, s[4:7], s54 offen offset:1024 sc1 lds
    s_add_u32 m0, s41, 30720
    s_add_u32 s54, s31, 264192
    buffer_load_dwordx4 v3, s[4:7], s54 offen offset:0 sc1 lds
    buffer_load_dwordx4 v3, s[4:7], s54 offen offset:1024 sc1 lds
    s_add_u32 m0, s41, 38912
    s_add_u32 s54, s31, 526336
    buffer_load_dwordx4 v3, s[4:7], s54 offen offset:0 sc1 lds
    buffer_load_dwordx4 v3, s[4:7], s54 offen offset:1024 sc1 lds
    s_add_u32 m0, s41, 47104
    s_add_u32 s54, s31, 788480
    buffer_load_dwordx4 v3, s[4:7], s54 offen offset:0 sc1 lds
    buffer_load_dwordx4 v3, s[4:7], s54 offen offset:1024 sc1 lds
    s_add_u32 m0, s41, 55296
    s_add_u32 s54, s31, 1050624
    buffer_load_dwordx4 v3, s[4:7], s54 offen offset:0 sc1 lds
    buffer_load_dwordx4 v3, s[4:7], s54 offen offset:1024 sc1 lds
    s_add_u32 m0, s41, 63488
    s_add_u32 s54, s31, 1312768
    buffer_load_dwordx4 v3, s[4:7], s54 offen offset:0 sc1 lds
    buffer_load_dwordx4 v3, s[4:7], s54 offen offset:1024 sc1 lds
    s_add_u32 m0, s41, 71680
    s_add_u32 s54, s31, 1574912
    buffer_load_dwordx4 v3, s[4:7], s54 offen offset:0 sc1 lds
    buffer_load_dwordx4 v3, s[4:7], s54 offen offset:1024 sc1 lds
    s_waitcnt vmcnt(12)
    s_barrier
    s_waitcnt vmcnt(10)
    s_barrier
    s_waitcnt vmcnt(8)
    s_barrier
    s_add_u32 m0, s41, 22528
    s_add_u32 s54, s31, 1837056
    buffer_load_dwordx4 v3, s[4:7], s54 offen offset:0 sc1 lds
    buffer_load_dwordx4 v3, s[4:7], s54 offen offset:1024 sc1 lds
    s_add_u32 m0, s42, 83968
    s_add_u32 s54, s36, 83968
    buffer_load_dwordx4 v3, s[4:7], s54 offen offset:0 lds
    buffer_load_dwordx4 v3, s[4:7], s54 offen offset:1024 lds
    buffer_load_dwordx4 v3, s[4:7], s54 offen offset:2048 lds
    s_waitcnt vmcnt(11)
    s_barrier
    s_add_u32 m0, s41, 30720
    s_add_u32 s54, s31, 2099200
    buffer_load_dwordx4 v3, s[4:7], s54 offen offset:0 sc1 lds
    buffer_load_dwordx4 v3, s[4:7], s54 offen offset:1024 sc1 lds
    s_add_u32 m0, s42, 94208
    s_add_u32 s54, s36, 94208
    buffer_load_dwordx4 v3, s[4:7], s54 offen offset:0 lds
    buffer_load_dwordx4 v3, s[4:7], s54 offen offset:1024 lds
    buffer_load_dwordx4 v3, s[4:7], s54 offen offset:2048 lds
    s_waitcnt vmcnt(14)
    s_barrier
    s_add_u32 m0, s41, 38912
    s_add_u32 s54, s31, 2361344
    buffer_load_dwordx4 v3, s[4:7], s54 offen offset:0 sc1 lds
    buffer_load_dwordx4 v3, s[4:7], s54 offen offset:1024 sc1 lds
    s_waitcnt vmcnt(14)
    s_barrier
    s_add_u32 m0, s43, 109568
    s_add_u32 s54, s37, 3072
    buffer_load_dwordx4 v3, s[4:7], s54 offen offset:0 lds
    buffer_load_dwordx4 v3, s[4:7], s54 offen offset:1024 lds
    buffer_load_dwordx4 v3, s[4:7], s54 offen offset:2048 lds
    s_sub_u32 s54, s54, s66
    buffer_load_dwordx4 v3, s[4:7], s54 offen offset:3072 lds
    s_waitcnt vmcnt(16)
    s_barrier
    s_waitcnt vmcnt(14)
    s_barrier
    s_add_u32 m0, s43, 123904
    s_add_u32 s54, s37, 17408
    buffer_load_dwordx4 v3, s[4:7], s54 offen offset:0 lds
    buffer_load_dwordx4 v3, s[4:7], s54 offen offset:1024 lds
    buffer_load_dwordx4 v3, s[4:7], s54 offen offset:2048 lds
    s_sub_u32 s54, s54, s66
    buffer_load_dwordx4 v3, s[4:7], s54 offen offset:3072 lds
    s_waitcnt vmcnt(13)
    s_barrier
    s_add_u32 m0, s43, 138240
    s_add_u32 s54, s37, 31744
    buffer_load_dwordx4 v3, s[4:7], s54 offen offset:0 lds
    buffer_load_dwordx4 v3, s[4:7], s54 offen offset:1024 lds
    buffer_load_dwordx4 v3, s[4:7], s54 offen offset:2048 lds
    s_sub_u32 s54, s54, s66
    buffer_load_dwordx4 v3, s[4:7], s54 offen offset:3072 lds
    s_waitcnt vmcnt(12)
    s_barrier
    s_add_u32 m0, s43, 152576
    s_add_u32 s54, s37, 46080
    buffer_load_dwordx4 v3, s[4:7], s54 offen offset:0 lds
    buffer_load_dwordx4 v3, s[4:7], s54 offen offset:1024 lds
    buffer_load_dwordx4 v3, s[4:7], s54 offen offset:2048 lds
    s_sub_u32 s54, s54, s66
    buffer_load_dwordx4 v3, s[4:7], s54 offen offset:3072 lds
    s_barrier
    s_waitcnt vmcnt(0)
    s_barrier
    s_cmp_lg_u32 s19, 0
    s_cbranch_scc1 SG2
    s_lshl_b32 s54, s50, 7
    s_add_u32 s54, s54, s52
    s_add_u32 s54, s54, 2048
    s_mov_b64 exec, 1
    buffer_atomic_add v13, off, s[4:7], s54 sc1
    s_mov_b64 exec, -1
SG2:
    s_barrier
    s_add_u32 m0, s41, 22528
    s_add_u32 s54, s32, 2048
    buffer_load_dwordx4 v3, s[4:7], s54 offen offset:0 sc1 lds
    buffer_load_dwordx4 v3, s[4:7], s54 offen offset:1024 sc1 lds
    s_add_u32 m0, s41, 30720
    s_add_u32 s54, s32, 264192
    buffer_load_dwordx4 v3, s[4:7], s54 offen offset:0 sc1 lds
    buffer_load_dwordx4 v3, s[4:7], s54 offen offset:1024 sc1 lds
    s_add_u32 m0, s41, 38912
    s_add_u32 s54, s32, 526336
    buffer_load_dwordx4 v3, s[4:7], s54 offen offset:0 sc1 lds
    buffer_load_dwordx4 v3, s[4:7], s54 offen offset:1024 sc1 lds
    s_add_u32 m0, s41, 47104
    s_add_u32 s54, s32, 788480
    buffer_load_dwordx4 v3, s[4:7], s54 offen offset:0 sc1 lds
    buffer_load_dwordx4 v3, s[4:7], s54 offen offset:1024 sc1 lds
    s_add_u32 m0, s41, 55296
    s_add_u32 s54, s32, 1050624
    buffer_load_dwordx4 v3, s[4:7], s54 offen offset:0 sc1 lds
    buffer_load_dwordx4 v3, s[4:7], s54 offen offset:1024 sc1 lds
    s_add_u32 m0, s41, 63488
    s_add_u32 s54, s32, 1312768
    buffer_load_dwordx4 v3, s[4:7], s54 offen offset:0 sc1 lds
    buffer_load_dwordx4 v3, s[4:7], s54 offen offset:1024 sc1 lds
    s_add_u32 m0, s41, 71680
    s_add_u32 s54, s32, 1574912
    buffer_load_dwordx4 v3, s[4:7], s54 offen offset:0 sc1 lds
    buffer_load_dwordx4 v3, s[4:7], s54 offen offset:1024 sc1 lds
    s_waitcnt vmcnt(12)
    s_barrier
    s_add_u32 m0, s41, 79872
    s_add_u32 s54, s32, 1837056
    buffer_load_dwordx4 v3, s[4:7], s54 offen offset:0 sc1 lds
    buffer_load_dwordx4 v3, s[4:7], s54 offen offset:1024 sc1 lds
    s_add_u32 m0, s41, 88064
    s_add_u32 s54, s32, 2099200
    buffer_load_dwordx4 v3, s[4:7], s54 offen offset:0 sc1 lds
    buffer_load_dwordx4 v3, s[4:7], s54 offen offset:1024 sc1 lds
    s_waitcnt vmcnt(14)
    s_barrier
    s_add_u32 m0, s43, 109568
    s_add_u32 s54, s37, 60416
    buffer_load_dwordx4 v3, s[4:7], s54 offen offset:0 lds
    buffer_load_dwordx4 v3, s[4:7], s54 offen offset:1024 lds
    buffer_load_dwordx4 v3, s[4:7], s54 offen offset:2048 lds
    s_sub_u32 s54, s54, s66
    buffer_load_dwordx4 v3, s[4:7], s54 offen offset:3072 lds
    s_add_u32 m0, s41, 96256
    s_add_u32 s54, s32, 2361344
    buffer_load_dwordx4 v3, s[4:7], s54 offen offset:0 sc1 lds
    buffer_load_dwordx4 v3, s[4:7], s54 offen offset:1024 sc1 lds
    s_waitcnt vmcnt(18)
    s_barrier
    s_add_u32 m0, s43, 123904
    s_add_u32 s54, s37, 74752
    buffer_load_dwordx4 v3, s[4:7], s54 offen offset:0 lds
    buffer_load_dwordx4 v3, s[4:7], s54 offen offset:1024 lds
    buffer_load_dwordx4 v3, s[4:7], s54 offen offset:2048 lds
    s_sub_u32 s54, s54, s66
    buffer_load_dwordx4 v3, s[4:7], s54 offen offset:3072 lds
    s_waitcnt vmcnt(20)
    s_barrier
    s_add_u32 m0, s43, 138240
    s_add_u32 s54, s37, 89088
    buffer_load_dwordx4 v3, s[4:7], s54 offen offset:0 lds
    buffer_load_dwordx4 v3, s[4:7], s54 offen offset:1024 lds
    buffer_load_dwordx4 v3, s[4:7], s54 offen offset:2048 lds
    s_sub_u32 s54, s54, s66
    buffer_load_dwordx4 v3, s[4:7], s54 offen offset:3072 lds
    s_waitcnt vmcnt(10)
    s_barrier
    s_add_u32 m0, s43, 152576
    s_add_u32 s54, s37, 103424
    buffer_load_dwordx4 v3, s[4:7], s54 offen offset:0 lds
    buffer_load_dwordx4 v3, s[4:7], s54 offen offset:1024 lds
    buffer_load_dwordx4 v3, s[4:7], s54 offen offset:2048 lds
    s_sub_u32 s54, s54, s66
    buffer_load_dwordx4 v3, s[4:7], s54 offen offset:3072 lds
    s_waitcnt vmcnt(8)
    s_barrier
    s_add_u32 m0, s43, 109568
    s_add_u32 s54, s37, 117760
    buffer_load_dwordx4 v3, s[4:7], s54 offen offset:0 lds
    buffer_load_dwordx4 v3, s[4:7], s54 offen offset:1024 lds
    buffer_load_dwordx4 v3, s[4:7], s54 offen offset:2048 lds
    s_sub_u32 s54, s54, s66
    buffer_load_dwordx4 v3, s[4:7], s54 offen offset:3072 lds
    s_add_u32 s54, s12, s58
    s_add_u32 s55, s54, 16384
    buffer_load_dwordx2 v[40:41], v6, s[4:7], s54 offen sc1
    buffer_load_dwordx2 v[42:43], v6, s[4:7], s55 offen sc1
    s_waitcnt vmcnt(10)
    s_barrier
    s_add_u32 m0, s43, 123904
    s_add_u32 s54, s37, 132096
    buffer_load_dwordx4 v3, s[4:7], s54 offen offset:0 lds
    buffer_load_dwordx4 v3, s[4:7], s54 offen offset:1024 lds
    buffer_load_dwordx4 v3, s[4:7], s54 offen offset:2048 lds
    s_sub_u32 s54, s54, s66
    buffer_load_dwordx4 v3, s[4:7], s54 offen offset:3072 lds
    s_waitcnt vmcnt(10)
    s_barrier
    s_add_u32 m0, s43, 139264
    s_add_u32 s54, s38, 4096
    buffer_load_dwordx4 v3, s[4:7], s54 offen offset:0 lds
    buffer_load_dwordx4 v3, s[4:7], s54 offen offset:1024 lds
    s_sub_u32 s54, s54, s66
    buffer_load_dwordx4 v3, s[4:7], s54 offen offset:2048 lds
    s_waitcnt vmcnt(9)
    s_barrier
    s_add_u32 m0, s43, 152576
    s_add_u32 s54, s38, 17408
    buffer_load_dwordx4 v3, s[4:7], s54 offen offset:0 lds
    buffer_load_dwordx4 v3, s[4:7], s54 offen offset:1024 lds
    buffer_load_dwordx4 v3, s[4:7], s54 offen offset:2048 lds
    s_sub_u32 s54, s54, s66
    buffer_load_dwordx4 v3, s[4:7], s54 offen offset:3072 lds
    s_waitcnt vmcnt(11)
    v_pk_add_f32 v[40:41], v[40:41], v[42:43]
    v_mov_b32 v42, v40
    v_mov_b32 v43, v41
    s_nop 0
    v_permlane32_swap_b32 v40, v42
    v_permlane32_swap_b32 v41, v43
    v_pk_add_f32 v[40:41], v[40:41], v[42:43]
    v_mov_b32 v42, v40
    v_mov_b32 v43, v41
    s_nop 0
    v_permlane16_swap_b32 v40, v42
    v_permlane16_swap_b32 v41, v43
    v_pk_add_f32 v[40:41], v[40:41], v[42:43]
    v_mul_f32 v42, 0x3acccccd, v40
    v_mul_f32 v41, 0x3acccccd, v41
    v_fma_f32 v41, -v42, v42, v41
    v_max_f32 v41, 0, v41
    v_add_f32 v41, 0x3727c5ac, v41
    v_rsq_f32 v40, v41
    s_nop 0
    v_mul_f32 v41, -v42, v40
    ds_write2_b32 v18, v40, v41 offset0:0 offset1:192
    s_waitcnt lgkmcnt(0)
    s_waitcnt vmcnt(7)
    s_barrier
    s_add_u32 m0, s43, 110592
    s_add_u32 s54, s38, 32768
    buffer_load_dwordx4 v3, s[4:7], s54 offen offset:0 lds
    buffer_load_dwordx4 v3, s[4:7], s54 offen offset:1024 lds
    s_sub_u32 s54, s54, s66
    buffer_load_dwordx4 v3, s[4:7], s54 offen offset:2048 lds
    s_barrier
    s_add_u32 m0, s43, 123904
    s_add_u32 s54, s38, 46080
    buffer_load_dwordx4 v3, s[4:7], s54 offen offset:0 lds
    buffer_load_dwordx4 v3, s[4:7], s54 offen offset:1024 lds
    buffer_load_dwordx4 v3, s[4:7], s54 offen offset:2048 lds
    s_sub_u32 s54, s54, s66
    buffer_load_dwordx4 v3, s[4:7], s54 offen offset:3072 lds
    s_waitcnt vmcnt(11)
    s_barrier
    s_waitcnt vmcnt(7)
    s_barrier
    s_add_u32 m0, s43, 139264
    s_add_u32 s54, s38, 61440
    buffer_load_dwordx4 v3, s[4:7], s54 offen offset:0 lds
    buffer_load_dwordx4 v3, s[4:7], s54 offen offset:1024 lds
    s_sub_u32 s54, s54, s66
    buffer_load_dwordx4 v3, s[4:7], s54 offen offset:2048 lds
    s_waitcnt vmcnt(8)
    s_waitcnt vmcnt(7)
    s_barrier
    s_cmp_lg_u32 s19, 0
    s_cbranch_scc1 SG3a
    s_lshl_b32 s54, s50, 7
    s_add_u32 s54, s54, s52
    s_add_u32 s54, s54, 6144
    s_mov_b64 exec, 1
    buffer_atomic_add v13, off, s[4:7], s54 sc1
    s_mov_b64 exec, -1
SG3a:
    s_add_u32 m0, s43, 152576
    s_add_u32 s54, s38, 74752
    buffer_load_dwordx4 v3, s[4:7], s54 offen offset:0 lds
    buffer_load_dwordx4 v3, s[4:7], s54 offen offset:1024 lds
    buffer_load_dwordx4 v3, s[4:7], s54 offen offset:2048 lds
    s_sub_u32 s54, s54, s66
    buffer_load_dwordx4 v3, s[4:7], s54 offen offset:3072 lds
    s_waitcnt vmcnt(7)
    s_barrier
    s_add_u32 m0, s43, 110592
    s_add_u32 s54, s38, 90112
    buffer_load_dwordx4 v3, s[4:7], s54 offen offset:0 lds
    buffer_load_dwordx4 v3, s[4:7], s54 offen offset:1024 lds
    s_sub_u32 s54, s54, s66
    buffer_load_dwordx4 v3, s[4:7], s54 offen offset:2048 lds
    s_waitcnt vmcnt(7)
    s_barrier
    s_add_u32 m0, s43, 123904
    s_add_u32 s54, s38, 103424
    buffer_load_dwordx4 v3, s[4:7], s54 offen offset:0 lds
    buffer_load_dwordx4 v3, s[4:7], s54 offen offset:1024 lds
    buffer_load_dwordx4 v3, s[4:7], s54 offen offset:2048 lds
    s_sub_u32 s54, s54, s66
    buffer_load_dwordx4 v3, s[4:7], s54 offen offset:3072 lds
    s_waitcnt vmcnt(7)
    s_barrier
    s_add_u32 m0, s43, 139264
    s_add_u32 s54, s38, 118784
    buffer_load_dwordx4 v3, s[4:7], s54 offen offset:0 lds
    buffer_load_dwordx4 v3, s[4:7], s54 offen offset:1024 lds
    s_sub_u32 s54, s54, s66
    buffer_load_dwordx4 v3, s[4:7], s54 offen offset:2048 lds
    s_waitcnt vmcnt(7)
    s_barrier
    s_add_u32 m0, s43, 152576
    s_add_u32 s54, s38, 132096
    buffer_load_dwordx4 v3, s[4:7], s54 offen offset:0 lds
    buffer_load_dwordx4 v3, s[4:7], s54 offen offset:1024 lds
    buffer_load_dwordx4 v3, s[4:7], s54 offen offset:2048 lds
    s_sub_u32 s54, s54, s66
    buffer_load_dwordx4 v3, s[4:7], s54 offen offset:3072 lds
    s_waitcnt vmcnt(7)
    s_barrier
    s_add_u32 m0, s41, 108544
    s_add_u32 s54, s39, 2048
    buffer_load_dwordx4 v3, s[4:7], s54 offen offset:0 sc1 lds
    buffer_load_dwordx4 v3, s[4:7], s54 offen offset:1024 sc1 lds
    s_waitcnt vmcnt(6)
    s_barrier
    s_add_u32 m0, s41, 116736
    s_add_u32 s54, s39, 10240
    buffer_load_dwordx4 v3, s[4:7], s54 offen offset:0 sc1 lds
    buffer_load_dwordx4 v3, s[4:7], s54 offen offset:1024 sc1 lds
    s_add_u32 m0, s41, 124928
    s_add_u32 s54, s39, 18432
    buffer_load_dwordx4 v3, s[4:7], s54 offen offset:0 sc1 lds
    buffer_load_dwordx4 v3, s[4:7], s54 offen offset:1024 sc1 lds
    s_waitcnt vmcnt(6)
    s_barrier
    s_add_u32 m0, s41, 133120
    s_add_u32 s54, s39, 26624
    buffer_load_dwordx4 v3, s[4:7], s54 offen offset:0 sc1 lds
    buffer_load_dwordx4 v3, s[4:7], s54 offen offset:1024 sc1 lds
    s_add_u32 m0, s41, 141312
    s_add_u32 s54, s39, 34816
    buffer_load_dwordx4 v3, s[4:7], s54 offen offset:0 sc1 lds
    buffer_load_dwordx4 v3, s[4:7], s54 offen offset:1024 sc1 lds
    s_barrier
    buffer_load_dwordx4 v[24:27], v3, s[4:7], s47 offen sc1
    s_add_u32 m0, s43, 53248
    s_add_u32 s54, s33, 4096
    buffer_load_dwordx4 v3, s[4:7], s54 offen offset:0 sc1 lds
    buffer_load_dwordx4 v3, s[4:7], s54 offen offset:1024 sc1 lds
    s_sub_u32 s54, s54, s66
    buffer_load_dwordx4 v3, s[4:7], s54 offen offset:2048 sc1 lds
    s_add_u32 m0, s43, 66560
    s_add_u32 s54, s33, 117760
    buffer_load_dwordx4 v3, s[4:7], s54 offen offset:0 sc1 lds
    buffer_load_dwordx4 v3, s[4:7], s54 offen offset:1024 sc1 lds
    buffer_load_dwordx4 v3, s[4:7], s54 offen offset:2048 sc1 lds
    s_sub_u32 s54, s54, s66
    buffer_load_dwordx4 v3, s[4:7], s54 offen offset:3072 sc1 lds
    s_add_u32 m0, s43, 81920
    s_add_u32 s54, s33, 233472
    buffer_load_dwordx4 v3, s[4:7], s54 offen offset:0 sc1 lds
    buffer_load_dwordx4 v3, s[4:7], s54 offen offset:1024 sc1 lds
    s_sub_u32 s54, s54, s66
    buffer_load_dwordx4 v3, s[4:7], s54 offen offset:2048 sc1 lds
    s_add_u32 m0, s43, 95232
    s_add_u32 s54, s33, 347136
    buffer_load_dwordx4 v3, s[4:7], s54 offen offset:0 sc1 lds
    buffer_load_dwordx4 v3, s[4:7], s54 offen offset:1024 sc1 lds
    buffer_load_dwordx4 v3, s[4:7], s54 offen offset:2048 sc1 lds
    s_sub_u32 s54, s54, s66
    buffer_load_dwordx4 v3, s[4:7], s54 offen offset:3072 sc1 lds
    s_add_u32 m0, s41, 149504
    s_add_u32 s54, s39, 43008
    buffer_load_dwordx4 v3, s[4:7], s54 offen offset:0 sc1 lds
    buffer_load_dwordx4 v3, s[4:7], s54 offen offset:1024 sc1 lds
    s_add_u32 m0, s41, 157696
    s_add_u32 s54, s39, 51200
    buffer_load_dwordx4 v3, s[4:7], s54 offen offset:0 sc1 lds
    buffer_load_dwordx4 v3, s[4:7], s54 offen offset:1024 sc1 lds
    s_add_u32 s54, s47, 4096
    buffer_load_dwordx4 v[28:31], v3, s[4:7], s54 offen sc1
    s_add_u32 s54, s47, 8192
    buffer_load_dwordx4 v[32:35], v3, s[4:7], s54 offen sc1
    s_add_u32 s54, s47, 12288
    buffer_load_dwordx4 v[36:39], v3, s[4:7], s54 offen sc1
    s_waitcnt vmcnt(21)
    v_mul_f32 v24, 0x3a97b426, v24
    v_mul_f32 v25, 0x3a97b426, v25
    v_mul_f32 v26, 0x3a97b426, v26
    v_mul_f32 v27, 0x3a97b426, v27
    v_fma_f32 v25, -v24, v24, v25
    v_fma_f32 v27, -v26, v26, v27
    v_max_f32 v25, 0, v25
    v_max_f32 v27, 0, v27
    v_add_f32 v25, 0x3727c5ac, v25
    v_add_f32 v27, 0x3727c5ac, v27
    v_rsq_f32 v25, v25
    v_rsq_f32 v27, v27
    v_cvt_pk_f16_f32 v14, v24, v26
    v_cvt_pk_f16_f32 v25, v25, v27
    v_cvt_f32_f16 v15, v14
    v_cvt_f32_f16_sdwa v23, v14 dst_sel:DWORD dst_unused:UNUSED_PAD src0_sel:WORD_1
    ds_write_b32 v16, v25 offset:4096
    ds_write_b32 v17, v14 offset:8192
    v_sub_f32 v15, v24, v15
    v_sub_f32 v23, v26, v23
    v_cvt_pk_f16_f32 v15, v15, v23
    ds_write_b32 v17, v15 offset:8256
    s_waitcnt lgkmcnt(0)
    s_waitcnt vmcnt(18)
    s_barrier
    s_add_u32 m0, s43, 24576
    s_add_u32 s54, s33, 462848
    buffer_load_dwordx4 v3, s[4:7], s54 offen offset:0 sc1 lds
    buffer_load_dwordx4 v3, s[4:7], s54 offen offset:1024 sc1 lds
    s_sub_u32 s54, s54, s66
    buffer_load_dwordx4 v3, s[4:7], s54 offen offset:2048 sc1 lds
    s_add_u32 m0, s43, 37888
    s_add_u32 s54, s33, 576512
    buffer_load_dwordx4 v3, s[4:7], s54 offen offset:0 sc1 lds
    buffer_load_dwordx4 v3, s[4:7], s54 offen offset:1024 sc1 lds
    buffer_load_dwordx4 v3, s[4:7], s54 offen offset:2048 sc1 lds
    s_sub_u32 s54, s54, s66
    buffer_load_dwordx4 v3, s[4:7], s54 offen offset:3072 sc1 lds
    s_waitcnt vmcnt(21)
    s_barrier
    s_waitcnt vmcnt(18)
    s_barrier
    s_add_u32 m0, s43, 53248
    s_add_u32 s54, s33, 692224
    buffer_load_dwordx4 v3, s[4:7], s54 offen offset:0 sc1 lds
    buffer_load_dwordx4 v3, s[4:7], s54 offen offset:1024 sc1 lds
    s_sub_u32 s54, s54, s66
    buffer_load_dwordx4 v3, s[4:7], s54 offen offset:2048 sc1 lds
    s_waitcnt vmcnt(12)
    v_mul_f32 v28, 0x3a97b426, v28
    v_mul_f32 v29, 0x3a97b426, v29
    v_mul_f32 v30, 0x3a97b426, v30
    v_mul_f32 v31, 0x3a97b426, v31
    v_fma_f32 v29, -v28, v28, v29
    v_fma_f32 v31, -v30, v30, v31
    v_max_f32 v29, 0, v29
    v_max_f32 v31, 0, v31
    v_add_f32 v29, 0x3727c5ac, v29
    v_add_f32 v31, 0x3727c5ac, v31
    v_rsq_f32 v29, v29
    v_rsq_f32 v31, v31
    v_cvt_pk_f16_f32 v10, v28, v30
    v_cvt_pk_f16_f32 v29, v29, v31
    v_cvt_f32_f16 v11, v10
    v_cvt_f32_f16_sdwa v12, v10 dst_sel:DWORD dst_unused:UNUSED_PAD src0_sel:WORD_1
    ds_write_b32 v16, v29 offset:5120
    ds_write_b32 v17, v10 offset:10240
    v_sub_f32 v11, v28, v11
    v_sub_f32 v12, v30, v12
    v_cvt_pk_f16_f32 v11, v11, v12
    ds_write_b32 v17, v11 offset:10304
    s_waitcnt lgkmcnt(0)
    s_waitcnt vmcnt(17)
    s_barrier
    s_add_u32 m0, s43, 66560
    s_add_u32 s54, s33, 805888
    buffer_load_dwordx4 v3, s[4:7], s54 offen offset:0 sc1 lds
    buffer_load_dwordx4 v3, s[4:7], s54 offen offset:1024 sc1 lds
    buffer_load_dwordx4 v3, s[4:7], s54 offen offset:2048 sc1 lds
    s_sub_u32 s54, s54, s66
    buffer_load_dwordx4 v3, s[4:7], s54 offen offset:3072 sc1 lds
    s_add_u32 m0, s41, 116736
    s_add_u32 s54, s39, 59392
    buffer_load_dwordx4 v3, s[4:7], s54 offen offset:0 sc1 lds
    buffer_load_dwordx4 v3, s[4:7], s54 offen offset:1024 sc1 lds
    s_waitcnt vmcnt(13)
    s_barrier
    s_add_u32 m0, s43, 81920
    s_add_u32 s54, s33, 921600
    buffer_load_dwordx4 v3, s[4:7], s54 offen offset:0 sc1 lds
    buffer_load_dwordx4 v3, s[4:7], s54 offen offset:1024 sc1 lds
    s_sub_u32 s54, s54, s66
    buffer_load_dwordx4 v3, s[4:7], s54 offen offset:2048 sc1 lds
    s_add_u32 m0, s41, 124928
    s_add_u32 s54, s39, 67584
    buffer_load_dwordx4 v3, s[4:7], s54 offen offset:0 sc1 lds
    buffer_load_dwordx4 v3, s[4:7], s54 offen offset:1024 sc1 lds
    s_waitcnt vmcnt(22)
    v_mul_f32 v32, 0x3a97b426, v32
    v_mul_f32 v33, 0x3a97b426, v33
    v_mul_f32 v34, 0x3a97b426, v34
    v_mul_f32 v35, 0x3a97b426, v35
    v_fma_f32 v33, -v32, v32, v33
    v_fma_f32 v35, -v34, v34, v35
    v_max_f32 v33, 0, v33
    v_max_f32 v35, 0, v35
    v_add_f32 v33, 0x3727c5ac, v33
    v_add_f32 v35, 0x3727c5ac, v35
    v_rsq_f32 v33, v33
    v_rsq_f32 v35, v35
    v_cvt_pk_f16_f32 v14, v32, v34
    v_cvt_pk_f16_f32 v33, v33, v35
    v_cvt_f32_f16 v15, v14
    v_cvt_f32_f16_sdwa v23, v14 dst_sel:DWORD dst_unused:UNUSED_PAD src0_sel:WORD_1
    ds_write_b32 v16, v33 offset:6144
    ds_write_b32 v17, v14 offset:12288
    v_sub_f32 v15, v32, v15
    v_sub_f32 v23, v34, v23
    v_cvt_pk_f16_f32 v15, v15, v23
    ds_write_b32 v17, v15 offset:12352
    s_waitcnt lgkmcnt(0)
    s_waitcnt vmcnt(14)
    s_barrier
    s_add_u32 m0, s43, 95232
    s_add_u32 s54, s33, 1035264
    buffer_load_dwordx4 v3, s[4:7], s54 offen offset:0 sc1 lds
    buffer_load_dwordx4 v3, s[4:7], s54 offen offset:1024 sc1 lds
    buffer_load_dwordx4 v3, s[4:7], s54 offen offset:2048 sc1 lds
    s_sub_u32 s54, s54, s66
    buffer_load_dwordx4 v3, s[4:7], s54 offen offset:3072 sc1 lds
    s_add_u32 m0, s41, 133120
    s_add_u32 s54, s39, 75776
    buffer_load_dwordx4 v3, s[4:7], s54 offen offset:0 sc1 lds
    buffer_load_dwordx4 v3, s[4:7], s54 offen offset:1024 sc1 lds
    s_waitcnt vmcnt(17)
    s_barrier
    s_add_u32 m0, s43, 24576
    s_add_u32 s54, s33, 1150976
    buffer_load_dwordx4 v3, s[4:7], s54 offen offset:0 sc1 lds
    buffer_load_dwordx4 v3, s[4:7], s54 offen offset:1024 sc1 lds
    s_sub_u32 s54, s54, s66
    buffer_load_dwordx4 v3, s[4:7], s54 offen offset:2048 sc1 lds
    s_add_u32 m0, s41, 141312
    s_add_u32 s54, s39, 83968
    buffer_load_dwordx4 v3, s[4:7], s54 offen offset:0 sc1 lds
    buffer_load_dwordx4 v3, s[4:7], s54 offen offset:1024 sc1 lds
    s_waitcnt vmcnt(32)
    v_mul_f32 v36, 0x3a97b426, v36
    v_mul_f32 v37, 0x3a97b426, v37
    v_mul_f32 v38, 0x3a97b426, v38
    v_mul_f32 v39, 0x3a97b426, v39
    v_fma_f32 v37, -v36, v36, v37
    v_fma_f32 v39, -v38, v38, v39
    v_max_f32 v37, 0, v37
    v_max_f32 v39, 0, v39
    v_add_f32 v37, 0x3727c5ac, v37
    v_add_f32 v39, 0x3727c5ac, v39
    v_rsq_f32 v37, v37
    v_rsq_f32 v39, v39
    v_cvt_pk_f16_f32 v10, v36, v38
    v_cvt_pk_f16_f32 v37, v37, v39
    v_cvt_f32_f16 v11, v10
    v_cvt_f32_f16_sdwa v12, v10 dst_sel:DWORD dst_unused:UNUSED_PAD src0_sel:WORD_1
    ds_write_b32 v16, v37 offset:7168
    ds_write_b32 v17, v10 offset:14336
    v_sub_f32 v11, v36, v11
    v_sub_f32 v12, v38, v12
    v_cvt_pk_f16_f32 v11, v11, v12
    ds_write_b32 v17, v11 offset:14400
    s_waitcnt lgkmcnt(0)
    s_waitcnt vmcnt(16)
    s_barrier
    s_add_u32 m0, s43, 37888
    s_add_u32 s54, s33, 1264640
    buffer_load_dwordx4 v3, s[4:7], s54 offen offset:0 sc1 lds
    buffer_load_dwordx4 v3, s[4:7], s54 offen offset:1024 sc1 lds
    buffer_load_dwordx4 v3, s[4:7], s54 offen offset:2048 sc1 lds
    s_sub_u32 s54, s54, s66
    buffer_load_dwordx4 v3, s[4:7], s54 offen offset:3072 sc1 lds
    s_add_u32 m0, s41, 149504
    s_add_u32 s54, s39, 92160
    buffer_load_dwordx4 v3, s[4:7], s54 offen offset:0 sc1 lds
    buffer_load_dwordx4 v3, s[4:7], s54 offen offset:1024 sc1 lds
    s_waitcnt vmcnt(17)
    s_barrier
    s_add_u32 m0, s43, 53248
    s_add_u32 s54, s33, 1380352
    buffer_load_dwordx4 v3, s[4:7], s54 offen offset:0 sc1 lds
    buffer_load_dwordx4 v3, s[4:7], s54 offen offset:1024 sc1 lds
    s_sub_u32 s54, s54, s66
    buffer_load_dwordx4 v3, s[4:7], s54 offen offset:2048 sc1 lds
    s_add_u32 m0, s41, 157696
    s_add_u32 s54, s39, 100352
    buffer_load_dwordx4 v3, s[4:7], s54 offen offset:0 sc1 lds
    buffer_load_dwordx4 v3, s[4:7], s54 offen offset:1024 sc1 lds
    s_waitcnt vmcnt(16)
    s_barrier
    s_add_u32 m0, s43, 66560
    s_add_u32 s54, s33, 1494016
    buffer_load_dwordx4 v3, s[4:7], s54 offen offset:0 sc1 lds
    buffer_load_dwordx4 v3, s[4:7], s54 offen offset:1024 sc1 lds
    buffer_load_dwordx4 v3, s[4:7], s54 offen offset:2048 sc1 lds
    s_sub_u32 s54, s54, s66
    buffer_load_dwordx4 v3, s[4:7], s54 offen offset:3072 sc1 lds
    s_add_u32 m0, s41, 116736
    s_add_u32 s54, s39, 108544
    buffer_load_dwordx4 v3, s[4:7], s54 offen offset:0 sc1 lds
    buffer_load_dwordx4 v3, s[4:7], s54 offen offset:1024 sc1 lds
    s_waitcnt vmcnt(17)
    s_barrier
    s_add_u32 m0, s43, 81920
    s_add_u32 s54, s33, 1609728
    buffer_load_dwordx4 v3, s[4:7], s54 offen offset:0 sc1 lds
    buffer_load_dwordx4 v3, s[4:7], s54 offen offset:1024 sc1 lds
    s_sub_u32 s54, s54, s66
    buffer_load_dwordx4 v3, s[4:7], s54 offen offset:2048 sc1 lds
    s_add_u32 m0, s41, 124928
    s_add_u32 s54, s39, 116736
    buffer_load_dwordx4 v3, s[4:7], s54 offen offset:0 sc1 lds
    buffer_load_dwordx4 v3, s[4:7], s54 offen offset:1024 sc1 lds
    s_waitcnt vmcnt(16)
    s_barrier
    s_add_u32 m0, s43, 95232
    s_add_u32 s54, s33, 1723392
    buffer_load_dwordx4 v3, s[4:7], s54 offen offset:0 sc1 lds
    buffer_load_dwordx4 v3, s[4:7], s54 offen offset:1024 sc1 lds
    buffer_load_dwordx4 v3, s[4:7], s54 offen offset:2048 sc1 lds
    s_sub_u32 s54, s54, s66
    buffer_load_dwordx4 v3, s[4:7], s54 offen offset:3072 sc1 lds
    s_add_u32 m0, s41, 133120
    s_add_u32 s54, s39, 124928
    buffer_load_dwordx4 v3, s[4:7], s54 offen offset:0 sc1 lds
    buffer_load_dwordx4 v3, s[4:7], s54 offen offset:1024 sc1 lds
    s_waitcnt vmcnt(17)
    s_barrier
    s_add_u32 m0, s43, 24576
    s_add_u32 s54, s33, 1839104
    buffer_load_dwordx4 v3, s[4:7], s54 offen offset:0 sc1 lds
    buffer_load_dwordx4 v3, s[4:7], s54 offen offset:1024 sc1 lds
    s_sub_u32 s54, s54, s66
    buffer_load_dwordx4 v3, s[4:7], s54 offen offset:2048 sc1 lds
    s_add_u32 m0, s41, 141312
    s_add_u32 s54, s39, 133120
    buffer_load_dwordx4 v3, s[4:7], s54 offen offset:0 sc1 lds
    buffer_load_dwordx4 v3, s[4:7], s54 offen offset:1024 sc1 lds
    s_waitcnt vmcnt(16)
    s_barrier
    s_add_u32 m0, s43, 37888
    s_add_u32 s54, s33, 1952768
    buffer_load_dwordx4 v3, s[4:7], s54 offen offset:0 sc1 lds
    buffer_load_dwordx4 v3, s[4:7], s54 offen offset:1024 sc1 lds
    buffer_load_dwordx4 v3, s[4:7], s54 offen offset:2048 sc1 lds
    s_sub_u32 s54, s54, s66
    buffer_load_dwordx4 v3, s[4:7], s54 offen offset:3072 sc1 lds
    s_add_u32 m0, s41, 149504
    s_add_u32 s54, s39, 141312
    buffer_load_dwordx4 v3, s[4:7], s54 offen offset:0 sc1 lds
    buffer_load_dwordx4 v3, s[4:7], s54 offen offset:1024 sc1 lds
    s_waitcnt vmcnt(17)
    s_barrier
    s_add_u32 m0, s43, 53248
    s_add_u32 s54, s33, 2068480
    buffer_load_dwordx4 v3, s[4:7], s54 offen offset:0 sc1 lds
    buffer_load_dwordx4 v3, s[4:7], s54 offen offset:1024 sc1 lds
    s_sub_u32 s54, s54, s66
    buffer_load_dwordx4 v3, s[4:7], s54 offen offset:2048 sc1 lds
    s_add_u32 m0, s41, 157696
    s_add_u32 s54, s39, 149504
    buffer_load_dwordx4 v3, s[4:7], s54 offen offset:0 sc1 lds
    buffer_load_dwordx4 v3, s[4:7], s54 offen offset:1024 sc1 lds
    s_waitcnt vmcnt(16)
    s_barrier
    s_add_u32 m0, s43, 66560
    s_add_u32 s54, s33, 2182144
    buffer_load_dwordx4 v3, s[4:7], s54 offen offset:0 sc1 lds
    buffer_load_dwordx4 v3, s[4:7], s54 offen offset:1024 sc1 lds
    buffer_load_dwordx4 v3, s[4:7], s54 offen offset:2048 sc1 lds
    s_sub_u32 s54, s54, s66
    buffer_load_dwordx4 v3, s[4:7], s54 offen offset:3072 sc1 lds
    s_add_u32 m0, s41, 116736
    s_add_u32 s54, s39, 157696
    buffer_load_dwordx4 v3, s[4:7], s54 offen offset:0 sc1 lds
    buffer_load_dwordx4 v3, s[4:7], s54 offen offset:1024 sc1 lds
    s_waitcnt vmcnt(17)
    s_barrier
    s_add_u32 m0, s43, 81920
    s_add_u32 s54, s33, 2297856
    buffer_load_dwordx4 v3, s[4:7], s54 offen offset:0 sc1 lds
    buffer_load_dwordx4 v3, s[4:7], s54 offen offset:1024 sc1 lds
    s_sub_u32 s54, s54, s66
    buffer_load_dwordx4 v3, s[4:7], s54 offen offset:2048 sc1 lds
    s_add_u32 m0, s41, 124928
    s_add_u32 s54, s39, 165888
    buffer_load_dwordx4 v3, s[4:7], s54 offen offset:0 sc1 lds
    buffer_load_dwordx4 v3, s[4:7], s54 offen offset:1024 sc1 lds
    s_waitcnt vmcnt(16)
    s_barrier
    s_add_u32 m0, s43, 95232
    s_add_u32 s54, s33, 2411520
    buffer_load_dwordx4 v3, s[4:7], s54 offen offset:0 sc1 lds
    buffer_load_dwordx4 v3, s[4:7], s54 offen offset:1024 sc1 lds
    buffer_load_dwordx4 v3, s[4:7], s54 offen offset:2048 sc1 lds
    s_sub_u32 s54, s54, s66
    buffer_load_dwordx4 v3, s[4:7], s54 offen offset:3072 sc1 lds
    s_add_u32 m0, s41, 133120
    s_add_u32 s54, s39, 174080
    buffer_load_dwordx4 v3, s[4:7], s54 offen offset:0 sc1 lds
    buffer_load_dwordx4 v3, s[4:7], s54 offen offset:1024 sc1 lds
    s_waitcnt vmcnt(17)
    s_barrier
    s_add_u32 m0, s43, 24576
    s_add_u32 s54, s33, 2527232
    buffer_load_dwordx4 v3, s[4:7], s54 offen offset:0 sc1 lds
    buffer_load_dwordx4 v3, s[4:7], s54 offen offset:1024 sc1 lds
    s_sub_u32 s54, s54, s66
    buffer_load_dwordx4 v3, s[4:7], s54 offen offset:2048 sc1 lds
    s_add_u32 m0, s41, 141312
    s_add_u32 s54, s39, 182272
    buffer_load_dwordx4 v3, s[4:7], s54 offen offset:0 sc1 lds
    buffer_load_dwordx4 v3, s[4:7], s54 offen offset:1024 sc1 lds
    s_waitcnt vmcnt(16)
    s_barrier
    s_add_u32 m0, s43, 37888
    s_add_u32 s54, s33, 2640896
    buffer_load_dwordx4 v3, s[4:7], s54 offen offset:0 sc1 lds
    buffer_load_dwordx4 v3, s[4:7], s54 offen offset:1024 sc1 lds
    buffer_load_dwordx4 v3, s[4:7], s54 offen offset:2048 sc1 lds
    s_sub_u32 s54, s54, s66
    buffer_load_dwordx4 v3, s[4:7], s54 offen offset:3072 sc1 lds
    s_add_u32 m0, s41, 149504
    s_add_u32 s54, s39, 190464
    buffer_load_dwordx4 v3, s[4:7], s54 offen offset:0 sc1 lds
    buffer_load_dwordx4 v3, s[4:7], s54 offen offset:1024 sc1 lds
    s_waitcnt vmcnt(17)
    s_barrier
    s_add_u32 m0, s43, 53248
    s_add_u32 s54, s33, 2756608
    buffer_load_dwordx4 v3, s[4:7], s54 offen offset:0 sc1 lds
    buffer_load_dwordx4 v3, s[4:7], s54 offen offset:1024 sc1 lds
    s_sub_u32 s54, s54, s66
    buffer_load_dwordx4 v3, s[4:7], s54 offen offset:2048 sc1 lds
    s_add_u32 m0, s41, 157696
    s_add_u32 s54, s39, 198656
    buffer_load_dwordx4 v3, s[4:7], s54 offen offset:0 sc1 lds
    buffer_load_dwordx4 v3, s[4:7], s54 offen offset:1024 sc1 lds
    s_waitcnt vmcnt(16)
    s_barrier
    s_add_u32 m0, s43, 66560
    s_add_u32 s54, s33, 2870272
    buffer_load_dwordx4 v3, s[4:7], s54 offen offset:0 sc1 lds
    buffer_load_dwordx4 v3, s[4:7], s54 offen offset:1024 sc1 lds
    buffer_load_dwordx4 v3, s[4:7], s54 offen offset:2048 sc1 lds
    s_sub_u32 s54, s54, s66
    buffer_load_dwordx4 v3, s[4:7], s54 offen offset:3072 sc1 lds
    s_add_u32 m0, s41, 116736
    s_add_u32 s54, s39, 206848
    buffer_load_dwordx4 v3, s[4:7], s54 offen offset:0 sc1 lds
    buffer_load_dwordx4 v3, s[4:7], s54 offen offset:1024 sc1 lds
    s_waitcnt vmcnt(17)
    s_barrier
    s_add_u32 m0, s43, 81920
    s_add_u32 s54, s33, 2985984
    buffer_load_dwordx4 v3, s[4:7], s54 offen offset:0 sc1 lds
    buffer_load_dwordx4 v3, s[4:7], s54 offen offset:1024 sc1 lds
    s_sub_u32 s54, s54, s66
    buffer_load_dwordx4 v3, s[4:7], s54 offen offset:2048 sc1 lds
    s_add_u32 m0, s41, 124928
    s_add_u32 s54, s39, 215040
    buffer_load_dwordx4 v3, s[4:7], s54 offen offset:0 sc1 lds
    buffer_load_dwordx4 v3, s[4:7], s54 offen offset:1024 sc1 lds
    s_waitcnt vmcnt(16)
    s_barrier
    s_add_u32 m0, s43, 95232
    s_add_u32 s54, s33, 3099648
    buffer_load_dwordx4 v3, s[4:7], s54 offen offset:0 sc1 lds
    buffer_load_dwordx4 v3, s[4:7], s54 offen offset:1024 sc1 lds
    buffer_load_dwordx4 v3, s[4:7], s54 offen offset:2048 sc1 lds
    s_sub_u32 s54, s54, s66
    buffer_load_dwordx4 v3, s[4:7], s54 offen offset:3072 sc1 lds
    s_add_u32 m0, s41, 133120
    s_add_u32 s54, s39, 223232
    buffer_load_dwordx4 v3, s[4:7], s54 offen offset:0 sc1 lds
    buffer_load_dwordx4 v3, s[4:7], s54 offen offset:1024 sc1 lds
    s_waitcnt vmcnt(17)
    s_barrier
    s_add_u32 m0, s43, 24576
    s_add_u32 s54, s33, 3215360
    buffer_load_dwordx4 v3, s[4:7], s54 offen offset:0 sc1 lds
    buffer_load_dwordx4 v3, s[4:7], s54 offen offset:1024 sc1 lds
    s_sub_u32 s54, s54, s66
    buffer_load_dwordx4 v3, s[4:7], s54 offen offset:2048 sc1 lds
    s_add_u32 m0, s41, 141312
    s_add_u32 s54, s39, 231424
    buffer_load_dwordx4 v3, s[4:7], s54 offen offset:0 sc1 lds
    buffer_load_dwordx4 v3, s[4:7], s54 offen offset:1024 sc1 lds
    s_waitcnt vmcnt(16)
    s_barrier
    s_add_u32 m0, s43, 37888
    s_add_u32 s54, s33, 3329024
    buffer_load_dwordx4 v3, s[4:7], s54 offen offset:0 sc1 lds
    buffer_load_dwordx4 v3, s[4:7], s54 offen offset:1024 sc1 lds
    buffer_load_dwordx4 v3, s[4:7], s54 offen offset:2048 sc1 lds
    s_sub_u32 s54, s54, s66
    buffer_load_dwordx4 v3, s[4:7], s54 offen offset:3072 sc1 lds
    s_add_u32 m0, s41, 149504
    s_add_u32 s54, s39, 239616
    buffer_load_dwordx4 v3, s[4:7], s54 offen offset:0 sc1 lds
    buffer_load_dwordx4 v3, s[4:7], s54 offen offset:1024 sc1 lds
    s_waitcnt vmcnt(17)
    s_barrier
    s_add_u32 m0, s43, 53248
    s_add_u32 s54, s33, 3444736
    buffer_load_dwordx4 v3, s[4:7], s54 offen offset:0 sc1 lds
    buffer_load_dwordx4 v3, s[4:7], s54 offen offset:1024 sc1 lds
    s_sub_u32 s54, s54, s66
    buffer_load_dwordx4 v3, s[4:7], s54 offen offset:2048 sc1 lds
    s_add_u32 m0, s41, 157696
    s_add_u32 s54, s39, 247808
    buffer_load_dwordx4 v3, s[4:7], s54 offen offset:0 sc1 lds
    buffer_load_dwordx4 v3, s[4:7], s54 offen offset:1024 sc1 lds
    s_waitcnt vmcnt(16)
    s_barrier
    s_add_u32 m0, s43, 66560
    s_add_u32 s54, s33, 3558400
    buffer_load_dwordx4 v3, s[4:7], s54 offen offset:0 sc1 lds
    buffer_load_dwordx4 v3, s[4:7], s54 offen offset:1024 sc1 lds
    buffer_load_dwordx4 v3, s[4:7], s54 offen offset:2048 sc1 lds
    s_sub_u32 s54, s54, s66
    buffer_load_dwordx4 v3, s[4:7], s54 offen offset:3072 sc1 lds
    s_add_u32 m0, s41, 116736
    s_add_u32 s54, s39, 256000
    buffer_load_dwordx4 v3, s[4:7], s54 offen offset:0 sc1 lds
    buffer_load_dwordx4 v3, s[4:7], s54 offen offset:1024 sc1 lds
    s_waitcnt vmcnt(17)
    s_barrier
    s_add_u32 m0, s42, 83968
    s_add_u32 s54, s40, 2048
    buffer_load_dwordx4 v3, s[4:7], s54 offen offset:0 lds
    buffer_load_dwordx4 v3, s[4:7], s54 offen offset:1024 lds
    buffer_load_dwordx4 v3, s[4:7], s54 offen offset:2048 lds
    s_waitcnt vmcnt(14)
    s_barrier
    s_add_u32 m0, s42, 94208
    s_add_u32 s54, s40, 12288
    buffer_load_dwordx4 v3, s[4:7], s54 offen offset:0 lds
    buffer_load_dwordx4 v3, s[4:7], s54 offen offset:1024 lds
    buffer_load_dwordx4 v3, s[4:7], s54 offen offset:2048 lds
    s_add_u32 m0, s42, 104448
    s_add_u32 s54, s40, 22528
    buffer_load_dwordx4 v3, s[4:7], s54 offen offset:0 lds
    buffer_load_dwordx4 v3, s[4:7], s54 offen offset:1024 lds
    buffer_load_dwordx4 v3, s[4:7], s54 offen offset:2048 lds
    s_waitcnt vmcnt(15)
    s_barrier
    s_waitcnt vmcnt(9)
    s_barrier
    s_barrier
    s_barrier
    s_cmp_lg_u32 s19, 0
    s_cbranch_scc1 SG4
    s_lshl_b32 s54, s50, 7
    s_add_u32 s54, s54, s52
    s_add_u32 s54, s54, 10240
    s_mov_b64 exec, 1
    buffer_atomic_add v13, off, s[4:7], s54 sc1
    s_mov_b64 exec, -1
SG4:
    s_add_u32 m0, s42, 114688
    s_add_u32 s54, s40, 32768
    buffer_load_dwordx4 v3, s[4:7], s54 offen offset:0 lds
    buffer_load_dwordx4 v3, s[4:7], s54 offen offset:1024 lds
    buffer_load_dwordx4 v3, s[4:7], s54 offen offset:2048 lds
    s_add_u32 m0, s42, 124928
    s_add_u32 s54, s40, 43008
    buffer_load_dwordx4 v3, s[4:7], s54 offen offset:0 lds
    buffer_load_dwordx4 v3, s[4:7], s54 offen offset:1024 lds
    buffer_load_dwordx4 v3, s[4:7], s54 offen offset:2048 lds
    s_add_u32 m0, s42, 135168
    s_add_u32 s54, s40, 53248
    buffer_load_dwordx4 v3, s[4:7], s54 offen offset:0 lds
    buffer_load_dwordx4 v3, s[4:7], s54 offen offset:1024 lds
    buffer_load_dwordx4 v3, s[4:7], s54 offen offset:2048 lds
    s_add_u32 m0, s42, 145408
    s_add_u32 s54, s40, 63488
    buffer_load_dwordx4 v3, s[4:7], s54 offen offset:0 lds
    buffer_load_dwordx4 v3, s[4:7], s54 offen offset:1024 lds
    buffer_load_dwordx4 v3, s[4:7], s54 offen offset:2048 lds
    s_add_u32 m0, s42, 155648
    s_add_u32 s54, s40, 73728
    buffer_load_dwordx4 v3, s[4:7], s54 offen offset:0 lds
    buffer_load_dwordx4 v3, s[4:7], s54 offen offset:1024 lds
    buffer_load_dwordx4 v3, s[4:7], s54 offen offset:2048 lds
    s_barrier
    s_add_u32 m0, s41, 22528
    s_add_u32 s54, s34, 2048
    buffer_load_dwordx4 v3, s[4:7], s54 offen offset:0 sc1 lds
    buffer_load_dwordx4 v3, s[4:7], s54 offen offset:1024 sc1 lds
    s_add_u32 m0, s41, 30720
    s_add_u32 s54, s34, 264192
    buffer_load_dwordx4 v3, s[4:7], s54 offen offset:0 sc1 lds
    buffer_load_dwordx4 v3, s[4:7], s54 offen offset:1024 sc1 lds
    s_add_u32 m0, s41, 38912
    s_add_u32 s54, s34, 526336
    buffer_load_dwordx4 v3, s[4:7], s54 offen offset:0 sc1 lds
    buffer_load_dwordx4 v3, s[4:7], s54 offen offset:1024 sc1 lds
    s_add_u32 m0, s41, 47104
    s_add_u32 s54, s34, 788480
    buffer_load_dwordx4 v3, s[4:7], s54 offen offset:0 sc1 lds
    buffer_load_dwordx4 v3, s[4:7], s54 offen offset:1024 sc1 lds
    s_add_u32 m0, s41, 55296
    s_add_u32 s54, s34, 1050624
    buffer_load_dwordx4 v3, s[4:7], s54 offen offset:0 sc1 lds
    buffer_load_dwordx4 v3, s[4:7], s54 offen offset:1024 sc1 lds
    s_add_u32 m0, s41, 63488
    s_add_u32 s54, s34, 1312768
    buffer_load_dwordx4 v3, s[4:7], s54 offen offset:0 sc1 lds
    buffer_load_dwordx4 v3, s[4:7], s54 offen offset:1024 sc1 lds
    s_add_u32 m0, s41, 71680
    s_add_u32 s54, s34, 1574912
    buffer_load_dwordx4 v3, s[4:7], s54 offen offset:0 sc1 lds
    buffer_load_dwordx4 v3, s[4:7], s54 offen offset:1024 sc1 lds
    s_waitcnt vmcnt(12)
    s_barrier
    s_waitcnt vmcnt(10)
    s_barrier
    s_waitcnt vmcnt(8)
    s_barrier
    s_add_u32 m0, s41, 22528
    s_add_u32 s54, s34, 1837056
    buffer_load_dwordx4 v3, s[4:7], s54 offen offset:0 sc1 lds
    buffer_load_dwordx4 v3, s[4:7], s54 offen offset:1024 sc1 lds
    s_add_u32 m0, s42, 83968
    s_add_u32 s54, s40, 83968
    buffer_load_dwordx4 v3, s[4:7], s54 offen offset:0 lds
    buffer_load_dwordx4 v3, s[4:7], s54 offen offset:1024 lds
    buffer_load_dwordx4 v3, s[4:7], s54 offen offset:2048 lds
    s_waitcnt vmcnt(11)
    s_barrier
    s_add_u32 m0, s41, 30720
    s_add_u32 s54, s34, 2099200
    buffer_load_dwordx4 v3, s[4:7], s54 offen offset:0 sc1 lds
    buffer_load_dwordx4 v3, s[4:7], s54 offen offset:1024 sc1 lds
    s_add_u32 m0, s42, 94208
    s_add_u32 s54, s40, 94208
    buffer_load_dwordx4 v3, s[4:7], s54 offen offset:0 lds
    buffer_load_dwordx4 v3, s[4:7], s54 offen offset:1024 lds
    buffer_load_dwordx4 v3, s[4:7], s54 offen offset:2048 lds
    s_waitcnt vmcnt(14)
    s_barrier
    s_add_u32 m0, s41, 38912
    s_add_u32 s54, s34, 2361344
    buffer_load_dwordx4 v3, s[4:7], s54 offen offset:0 sc1 lds
    buffer_load_dwordx4 v3, s[4:7], s54 offen offset:1024 sc1 lds
    s_add_u32 m0, s42, 104448
    s_add_u32 s54, s40, 104448
    buffer_load_dwordx4 v3, s[4:7], s54 offen offset:0 lds
    buffer_load_dwordx4 v3, s[4:7], s54 offen offset:1024 lds
    buffer_load_dwordx4 v3, s[4:7], s54 offen offset:2048 lds
    s_waitcnt vmcnt(17)
    s_barrier
    s_add_u32 m0, s41, 47104
    s_add_u32 s54, s34, 2623488
    buffer_load_dwordx4 v3, s[4:7], s54 offen offset:0 sc1 lds
    buffer_load_dwordx4 v3, s[4:7], s54 offen offset:1024 sc1 lds
    s_add_u32 m0, s42, 114688
    s_add_u32 s54, s40, 114688
    buffer_load_dwordx4 v3, s[4:7], s54 offen offset:0 lds
    buffer_load_dwordx4 v3, s[4:7], s54 offen offset:1024 lds
    buffer_load_dwordx4 v3, s[4:7], s54 offen offset:2048 lds
    s_waitcnt vmcnt(20)
    s_barrier
    s_add_u32 m0, s41, 55296
    s_add_u32 s54, s34, 2885632
    buffer_load_dwordx4 v3, s[4:7], s54 offen offset:0 sc1 lds
    buffer_load_dwordx4 v3, s[4:7], s54 offen offset:1024 sc1 lds
    s_add_u32 m0, s42, 124928
    s_add_u32 s54, s40, 124928
    buffer_load_dwordx4 v3, s[4:7], s54 offen offset:0 lds
    buffer_load_dwordx4 v3, s[4:7], s54 offen offset:1024 lds
    buffer_load_dwordx4 v3, s[4:7], s54 offen offset:2048 lds
    s_waitcnt vmcnt(23)
    s_barrier
    s_add_u32 m0, s41, 63488
    s_add_u32 s54, s34, 3147776
    buffer_load_dwordx4 v3, s[4:7], s54 offen offset:0 sc1 lds
    buffer_load_dwordx4 v3, s[4:7], s54 offen offset:1024 sc1 lds
    s_add_u32 m0, s42, 135168
    s_add_u32 s54, s40, 135168
    s_mul_i32 s55, s19, 5120
    s_sub_u32 s54, s54, s55
    buffer_load_dwordx4 v3, s[4:7], s54 offen offset:0 lds
    buffer_load_dwordx4 v3, s[4:7], s54 offen offset:1024 lds
    buffer_load_dwordx4 v3, s[4:7], s54 offen offset:2048 lds
    s_waitcnt vmcnt(23)
    s_barrier
    s_add_u32 m0, s41, 71680
    s_add_u32 s54, s34, 3409920
    s_mul_i32 s55, s19, 131072
    s_sub_u32 s54, s54, s55
    buffer_load_dwordx4 v3, s[4:7], s54 offen offset:0 sc1 lds
    buffer_load_dwordx4 v3, s[4:7], s54 offen offset:1024 sc1 lds
    s_waitcnt vmcnt(20)
    s_barrier
    s_waitcnt vmcnt(15)
    s_barrier
    s_waitcnt vmcnt(10)
    s_barrier
    s_waitcnt vmcnt(5)
    s_barrier
    s_waitcnt vmcnt(0)
    s_barrier
    s_barrier
    s_cmp_eq_u32 s14, 1
    s_cbranch_scc1 FINL
    s_barrier
    s_cmp_lg_u32 s19, 0
    s_cbranch_scc1 SG5
    s_lshl_b32 s54, s50, 7
    s_add_u32 s54, s54, s52
    s_add_u32 s54, s54, 14336
    s_mov_b64 exec, 1
    buffer_atomic_add v13, off, s[4:7], s54 sc1
    s_mov_b64 exec, -1
SG5:
    s_cmp_eq_u32 s14, 1
    s_cbranch_scc1 SK_17
    s_add_u32 m0, s44, 135168
    s_add_u32 s54, s35, 4096
    buffer_load_dwordx4 v3, s[4:7], s54 offen offset:0 lds
    buffer_load_dwordx4 v3, s[4:7], s54 offen offset:1024 lds
    buffer_load_dwordx4 v3, s[4:7], s54 offen offset:2048 lds
    buffer_load_dwordx4 v9, s[4:7], s54 offen offset:3072 lds
SK_17:
    s_cmp_eq_u32 s14, 1
    s_cbranch_scc1 SK_18
    s_add_u32 m0, s44, 151552
    s_add_u32 s54, s35, 20480
    buffer_load_dwordx4 v3, s[4:7], s54 offen offset:0 lds
    buffer_load_dwordx4 v3, s[4:7], s54 offen offset:1024 lds
    buffer_load_dwordx4 v3, s[4:7], s54 offen offset:2048 lds
    buffer_load_dwordx4 v9, s[4:7], s54 offen offset:3072 lds
SK_18:
    s_cmp_eq_u32 s14, 1
    s_cbranch_scc1 SK_19
    s_add_u32 m0, s44, 102400
    s_add_u32 s54, s35, 36864
    buffer_load_dwordx4 v3, s[4:7], s54 offen offset:0 lds
    buffer_load_dwordx4 v3, s[4:7], s54 offen offset:1024 lds
    buffer_load_dwordx4 v3, s[4:7], s54 offen offset:2048 lds
    buffer_load_dwordx4 v9, s[4:7], s54 offen offset:3072 lds
SK_19:
    s_cmp_eq_u32 s14, 1
    s_cbranch_scc1 SK_20
    s_add_u32 m0, s44, 118784
    s_add_u32 s54, s35, 53248
    buffer_load_dwordx4 v3, s[4:7], s54 offen offset:0 lds
    buffer_load_dwordx4 v3, s[4:7], s54 offen offset:1024 lds
    buffer_load_dwordx4 v3, s[4:7], s54 offen offset:2048 lds
    buffer_load_dwordx4 v9, s[4:7], s54 offen offset:3072 lds
SK_20:
    s_barrier
    s_cmp_eq_u32 s14, 1
    s_cbranch_scc1 FINL
    s_mov_b32 s14, 1
    s_add_u32 s47, s47, 19677184
    s_add_u32 s12, s12, 19677184
    s_add_u32 s52, s52, 32768
    s_add_u32 s30, s30, 19677184
    s_add_u32 s31, s31, 19677184
    s_add_u32 s32, s32, 19677184
    s_add_u32 s33, s33, 19677184
    s_add_u32 s34, s34, 19677184
    s_branch LDB_loop
FINL:
FIN:
    s_nop 3
END:
    s_endpgm
MAIN_END:
.section .rodata,"a"
.p2align 6
.amdhsa_kernel k0_kernel
  .amdhsa_next_free_vgpr 96
  .amdhsa_next_free_sgpr 72
  .amdhsa_accum_offset 96
  .amdhsa_group_segment_fixed_size 0
  .amdhsa_kernarg_size 88
  .amdhsa_user_sgpr_count 2
  .amdhsa_user_sgpr_kernarg_segment_ptr 1
  .amdhsa_system_sgpr_workgroup_id_x 1
  .amdhsa_float_denorm_mode_32 3
.end_amdhsa_kernel
.p2align 6
.amdhsa_kernel main_kernel
  .amdhsa_next_free_vgpr 256
  .amdhsa_next_free_sgpr 80
  .amdhsa_accum_offset 256
  .amdhsa_group_segment_fixed_size 0
  .amdhsa_kernarg_size 88
  .amdhsa_user_sgpr_count 2
  .amdhsa_user_sgpr_kernarg_segment_ptr 1
  .amdhsa_system_sgpr_workgroup_id_x 1
  .amdhsa_float_denorm_mode_32 3
.end_amdhsa_kernel
```
